```python
import torch

def _softmax(x, axis=-1):
    return torch.softmax(x, dim=axis)
def _gelu(x):
    return torch.nn.functional.gelu(x, approximate="tanh")
def _silu(x):
    return torch.nn.functional.silu(x)
def _sigmoid(x):
    return torch.sigmoid(x)
def _layernorm(x, axis=-1, eps=1e-5):
    m = x.mean(dim=axis, keepdim=True)
    v = x.var(dim=axis, keepdim=True, unbiased=False)
    return (x - m) / torch.sqrt(v + eps)
def _scatter_add(tgt, idx, src, axis=0):
    return tgt.clone().index_add_(axis, idx, src)
def _segment_sum(src, seg, n):
    out = torch.zeros((n,) + src.shape[1:], dtype=src.dtype)
    return out.index_add_(0, seg, src)
def _pad(x, pw):
    flat = tuple(v for pair in reversed(pw) for v in pair)
    return torch.nn.functional.pad(x, flat)

kernel_name = 'concat_heads__mha_block__spectral_gfnet__prompt'

def setup_inputs():

    _w = (lambda a: (lambda t: t.to(torch.bfloat16) if t.is_floating_point() else t)(torch.as_tensor(a)))
    def _A_setup():
        B, S, D, H = 1, 2048, 448, 16
        return {
            "x": _w((lambda *s: torch.randn(*s, dtype=torch.bfloat16) * 0.2)(B, S, D)),
            "wqkv": _w((lambda *s: torch.randn(*s, dtype=torch.bfloat16) * 0.2)(D, 3 * D)),
            "wo": _w((lambda *s: torch.randn(*s, dtype=torch.bfloat16) * 0.05)(D, D)),
        }
    _A_in = _A_setup()

    def _B_setup():
        B, S, D = 1, 2048, 448
        Df = D // 2 + 1
        return {
            "x": _w((lambda *s: torch.randn(*s, dtype=torch.bfloat16) * 0.05)(B, S, D)),
            "w_r": _w((lambda *s: torch.randn(*s, dtype=torch.bfloat16) * 6.4)(S, Df) * 0.02),
            "w_i": _w((lambda *s: torch.randn(*s, dtype=torch.bfloat16) * 6.4)(S, Df) * 0.02),
        }
    _B_in = _B_setup()

    return {
        "A_x": _A_in["x"],
        "A_wqkv": _A_in["wqkv"],
        "A_wo": _A_in["wo"],
        "B_x": _B_in["x"],
        "B_w_r": _B_in["w_r"],
        "B_w_i": _B_in["w_i"],
    }

def reference(A_x, A_wqkv, A_wo, B_x, B_w_r, B_w_i):
    def _A_ref(x, wqkv, wo):
        B, S, D = x.shape
        H = 16
        Dh = D // H
        qkv = (lambda x, *d: x.permute(*d))((x @ wqkv).reshape(B, S, 3, H, Dh), 2, 0, 3, 1, 4)
        q, k, v = qkv[0], qkv[1], qkv[2]
        scores = torch.einsum("bhqd,bhkd->bhqk", q, k) * (Dh ** -0.5)
        p = _softmax(scores, axis=-1)
        o = torch.einsum("bhqk,bhkd->bhqd", p, v)
        return (lambda x, *d: x.permute(*d))(o, 0, 2, 1, 3).reshape(B, S, D) @ wo

    def _B_ref(x, w_r, w_i):
        B, S, D = x.shape
        X = (lambda x, axes=(-2,-1): torch.fft.rfft2(x.float(), dim=axes))(x, axes=(-2, -1))
        W = w_r + 1j * w_i
        X = X * W
        y = (lambda x, s, axes=(-2,-1): torch.fft.irfft2(x, s=s, dim=axes).to(torch.bfloat16))(X, (S, D), axes=(-2, -1))
        return y

    a = _A_ref(A_x, A_wqkv, A_wo)
    b = _B_ref(B_x, B_w_r, B_w_i)
    return torch.concatenate([a, b], axis=-1)
```

```asm
; @launch grid=(256,1,1) block=(512,1,1) lds=149760
.amdgcn_target "amdgcn-amd-amdhsa--gfx950"
.text
.globl concat_heads__mha_block__spectral_gfnet__prompt_kernel
.p2align 8
.type concat_heads__mha_block__spectral_gfnet__prompt_kernel,@function
concat_heads__mha_block__spectral_gfnet__prompt_kernel:
    s_load_dwordx16 s[64:79], s[0:1], 0
    s_cmp_ge_u32 s2, 256
    s_cbranch_scc1 fk_end
    v_lshrrev_b32 v1, 6, v0
    s_load_dwordx2 s[16:17], s[0:1], 64
    v_and_b32 v0, 63, v0
    s_and_b32 s29, s2, 7
    v_readfirstlane_b32 s3, v1
    s_lshr_b32 s30, s2, 3
    v_lshlrev_b32 v1, 4, v0
    s_and_b32 s28, s3, 3
    s_mov_b32 s18, 16777216
    s_mov_b32 s19, 0x20000
    s_cmp_lt_u32 s30, 8
    s_cbranch_scc1 fk_bwg
    s_sub_u32 s56, s30, 8
    s_mul_i32 s33, s56, 43
    s_lshr_b32 s33, s33, 8
    s_mul_i32 s34, s33, 6
    s_sub_u32 s34, s56, s34
    s_lshr_b32 s31, s29, 1
    s_lshl_b32 s31, s31, 2
    s_add_u32 s31, s31, s33
    s_and_b32 s32, s29, 1
    s_mul_i32 s32, s32, 6
    s_add_u32 s32, s32, s34
    s_and_b32 s48, s32, 1
    s_lshl_b32 s48, s48, 5
    s_mov_b32 s10, 1835008
    s_mov_b32 s11, 0x20000
    s_mov_b32 s14, 1204224
    s_mov_b32 s15, 0x20000
    s_cmp_lt_u32 s3, 4
    s_cbranch_scc1 fk_t1c
    v_lshrrev_b32 v5, 3, v0
    v_mul_u32_u24 v2, 896, v5
    v_and_b32 v5, 7, v0
    v_lshrrev_b32 v6, 4, v0
    v_xor_b32 v5, v5, v6
    v_xor_b32 v7, 4, v5
    v_lshl_add_u32 v3, v7, 4, v2
    v_lshl_add_u32 v2, v5, 4, v2
    v_mul_u32_u24 v4, 2688, v6
    v_lshrrev_b32 v5, 2, v0
    v_sub_u32 v5, v5, v6
    v_and_b32 v5, 3, v5
    v_lshl_add_u32 v4, v5, 6, v4
    v_and_b32 v5, 3, v0
    v_lshl_add_u32 v4, v5, 4, v4
    s_lshl_b32 s33, s31, 2
    s_add_u32 s33, s33, s28
    s_mul_i32 s38, s33, 28672
    s_mul_i32 s39, s28, 43008
    s_mul_i32 s33, s32, 224
    s_add_u32 s39, s39, s33
    s_sub_u32 s39, s39, s48
    s_lshl_b32 s37, s28, 12
    s_waitcnt lgkmcnt(0)
    s_mov_b32 s8, s64
    s_mov_b32 s9, s65
    s_mov_b32 s12, s66
    s_mov_b32 s13, s67
    v_mov_b32 v254, 16384000
    buffer_load_dword v255, v254, s[16:19], 0 offen
    s_add_u32 m0, s37, 0
    s_add_u32 s33, s38, 0
    buffer_load_dwordx4 v2, s[8:11], s33 offen lds
    s_add_u32 m0, s37, 16384
    s_add_u32 s33, s39, 0
    buffer_load_dwordx4 v4, s[12:15], s33 offen lds
    s_add_u32 m0, s37, 1024
    s_add_u32 s33, s38, 7168
    buffer_load_dwordx4 v3, s[8:11], s33 offen lds
    s_add_u32 m0, s37, 17408
    s_add_u32 s33, s39, 10752
    buffer_load_dwordx4 v4, s[12:15], s33 offen lds
    s_add_u32 m0, s37, 2048
    s_add_u32 s33, s38, 14336
    buffer_load_dwordx4 v2, s[8:11], s33 offen lds
    s_add_u32 m0, s37, 18432
    s_add_u32 s33, s39, 21504
    buffer_load_dwordx4 v4, s[12:15], s33 offen lds
    s_add_u32 m0, s37, 3072
    s_add_u32 s33, s38, 21504
    buffer_load_dwordx4 v3, s[8:11], s33 offen lds
    s_add_u32 m0, s37, 19456
    s_add_u32 s33, s39, 32256
    buffer_load_dwordx4 v4, s[12:15], s33 offen lds
    s_add_u32 m0, s37, 32768
    s_add_u32 s33, s38, 128
    buffer_load_dwordx4 v2, s[8:11], s33 offen lds
    s_add_u32 m0, s37, 49152
    s_add_u32 s33, s39, 172032
    buffer_load_dwordx4 v4, s[12:15], s33 offen lds
    s_add_u32 m0, s37, 33792
    s_add_u32 s33, s38, 7296
    buffer_load_dwordx4 v3, s[8:11], s33 offen lds
    s_add_u32 m0, s37, 50176
    s_add_u32 s33, s39, 182784
    buffer_load_dwordx4 v4, s[12:15], s33 offen lds
    s_add_u32 m0, s37, 34816
    s_add_u32 s33, s38, 14464
    buffer_load_dwordx4 v2, s[8:11], s33 offen lds
    s_add_u32 m0, s37, 51200
    s_add_u32 s33, s39, 193536
    buffer_load_dwordx4 v4, s[12:15], s33 offen lds
    s_add_u32 m0, s37, 35840
    s_add_u32 s33, s38, 21632
    buffer_load_dwordx4 v3, s[8:11], s33 offen lds
    s_add_u32 m0, s37, 52224
    s_add_u32 s33, s39, 204288
    buffer_load_dwordx4 v4, s[12:15], s33 offen lds
    s_waitcnt vmcnt(8)
    s_barrier
    s_add_u32 m0, s37, 65536
    s_add_u32 s33, s38, 256
    buffer_load_dwordx4 v2, s[8:11], s33 offen lds
    s_add_u32 m0, s37, 81920
    s_add_u32 s33, s39, 344064
    buffer_load_dwordx4 v4, s[12:15], s33 offen lds
    s_add_u32 m0, s37, 66560
    s_add_u32 s33, s38, 7424
    buffer_load_dwordx4 v3, s[8:11], s33 offen lds
    s_add_u32 m0, s37, 82944
    s_add_u32 s33, s39, 354816
    buffer_load_dwordx4 v4, s[12:15], s33 offen lds
    s_add_u32 m0, s37, 67584
    s_add_u32 s33, s38, 14592
    buffer_load_dwordx4 v2, s[8:11], s33 offen lds
    s_add_u32 m0, s37, 83968
    s_add_u32 s33, s39, 365568
    buffer_load_dwordx4 v4, s[12:15], s33 offen lds
    s_add_u32 m0, s37, 68608
    s_add_u32 s33, s38, 21760
    buffer_load_dwordx4 v3, s[8:11], s33 offen lds
    s_add_u32 m0, s37, 84992
    s_add_u32 s33, s39, 376320
    buffer_load_dwordx4 v4, s[12:15], s33 offen lds
    s_waitcnt vmcnt(8)
    s_barrier
    s_add_u32 m0, s37, 98304
    s_add_u32 s33, s38, 384
    buffer_load_dwordx4 v2, s[8:11], s33 offen lds
    s_add_u32 m0, s37, 114688
    s_add_u32 s33, s39, 516096
    buffer_load_dwordx4 v4, s[12:15], s33 offen lds
    s_add_u32 m0, s37, 99328
    s_add_u32 s33, s38, 7552
    buffer_load_dwordx4 v3, s[8:11], s33 offen lds
    s_add_u32 m0, s37, 115712
    s_add_u32 s33, s39, 526848
    buffer_load_dwordx4 v4, s[12:15], s33 offen lds
    s_add_u32 m0, s37, 100352
    s_add_u32 s33, s38, 14720
    buffer_load_dwordx4 v2, s[8:11], s33 offen lds
    s_add_u32 m0, s37, 116736
    s_add_u32 s33, s39, 537600
    buffer_load_dwordx4 v4, s[12:15], s33 offen lds
    s_add_u32 m0, s37, 101376
    s_add_u32 s33, s38, 21888
    buffer_load_dwordx4 v3, s[8:11], s33 offen lds
    s_add_u32 m0, s37, 117760
    s_add_u32 s33, s39, 548352
    buffer_load_dwordx4 v4, s[12:15], s33 offen lds
    s_waitcnt vmcnt(8)
    s_barrier
    s_add_u32 m0, s37, 0
    s_add_u32 s33, s38, 512
    buffer_load_dwordx4 v2, s[8:11], s33 offen lds
    s_add_u32 m0, s37, 16384
    s_add_u32 s33, s39, 688128
    buffer_load_dwordx4 v4, s[12:15], s33 offen lds
    s_add_u32 m0, s37, 1024
    s_add_u32 s33, s38, 7680
    buffer_load_dwordx4 v3, s[8:11], s33 offen lds
    s_add_u32 m0, s37, 17408
    s_add_u32 s33, s39, 698880
    buffer_load_dwordx4 v4, s[12:15], s33 offen lds
    s_add_u32 m0, s37, 2048
    s_add_u32 s33, s38, 14848
    buffer_load_dwordx4 v2, s[8:11], s33 offen lds
    s_add_u32 m0, s37, 18432
    s_add_u32 s33, s39, 709632
    buffer_load_dwordx4 v4, s[12:15], s33 offen lds
    s_add_u32 m0, s37, 3072
    s_add_u32 s33, s38, 22016
    buffer_load_dwordx4 v3, s[8:11], s33 offen lds
    s_add_u32 m0, s37, 19456
    s_add_u32 s33, s39, 720384
    buffer_load_dwordx4 v4, s[12:15], s33 offen lds
    s_waitcnt vmcnt(8)
    s_barrier
    s_add_u32 m0, s37, 32768
    s_add_u32 s33, s38, 640
    buffer_load_dwordx4 v2, s[8:11], s33 offen lds
    s_add_u32 m0, s37, 49152
    s_add_u32 s33, s39, 860160
    buffer_load_dwordx4 v4, s[12:15], s33 offen lds
    s_add_u32 m0, s37, 33792
    s_add_u32 s33, s38, 7808
    buffer_load_dwordx4 v3, s[8:11], s33 offen lds
    s_add_u32 m0, s37, 50176
    s_add_u32 s33, s39, 870912
    buffer_load_dwordx4 v4, s[12:15], s33 offen lds
    s_add_u32 m0, s37, 34816
    s_add_u32 s33, s38, 14976
    buffer_load_dwordx4 v2, s[8:11], s33 offen lds
    s_add_u32 m0, s37, 51200
    s_add_u32 s33, s39, 881664
    buffer_load_dwordx4 v4, s[12:15], s33 offen lds
    s_add_u32 m0, s37, 35840
    s_add_u32 s33, s38, 22144
    buffer_load_dwordx4 v3, s[8:11], s33 offen lds
    s_add_u32 m0, s37, 52224
    s_add_u32 s33, s39, 892416
    buffer_load_dwordx4 v4, s[12:15], s33 offen lds
    s_waitcnt vmcnt(8)
    s_barrier
    s_add_u32 m0, s37, 65536
    s_add_u32 s33, s38, 768
    buffer_load_dwordx4 v2, s[8:11], s33 offen lds
    s_add_u32 m0, s37, 81920
    s_add_u32 s33, s39, 1032192
    buffer_load_dwordx4 v4, s[12:15], s33 offen lds
    s_add_u32 m0, s37, 66560
    s_add_u32 s33, s38, 7936
    buffer_load_dwordx4 v3, s[8:11], s33 offen lds
    s_add_u32 m0, s37, 82944
    s_add_u32 s33, s39, 1042944
    buffer_load_dwordx4 v4, s[12:15], s33 offen lds
    s_add_u32 m0, s37, 67584
    s_add_u32 s33, s38, 15104
    buffer_load_dwordx4 v2, s[8:11], s33 offen lds
    s_add_u32 m0, s37, 83968
    s_add_u32 s33, s39, 1053696
    buffer_load_dwordx4 v4, s[12:15], s33 offen lds
    s_add_u32 m0, s37, 68608
    s_add_u32 s33, s38, 22272
    buffer_load_dwordx4 v3, s[8:11], s33 offen lds
    s_add_u32 m0, s37, 84992
    s_add_u32 s33, s39, 1064448
    buffer_load_dwordx4 v4, s[12:15], s33 offen lds
    s_waitcnt vmcnt(8)
    s_barrier
    s_waitcnt vmcnt(0)
    s_barrier
    s_and_b32 s33, s32, 3
    s_lshl_b32 s33, s33, 2
    v_lshrrev_b32 v2, 4, v0
    v_add_u32 v2, s33, v2
    v_and_b32 v3, 15, v0
    s_lshr_b32 s34, s32, 2
    s_cmp_eq_u32 s34, 0
    s_cbranch_scc0 fk_sig_kv
    v_mov_b32 v3, s31
fk_sig_kv:
    v_and_b32 v4, 1, v2
    v_lshl_add_u32 v4, v4, 4, v3
    v_lshrrev_b32 v2, 1, v2
    v_lshl_add_u32 v2, v4, 3, v2
    v_lshlrev_b32 v2, 8, v2
    s_lshl_b32 s33, s34, 4
    s_add_u32 s33, s33, s31
    s_sub_u32 s33, s33, 16
    s_cmp_eq_u32 s34, 0
    s_cselect_b32 s33, 32, s33
    s_lshl_b32 s33, s33, 2
    s_add_u32 s38, s33, 16252928
    s_mov_b32 s39, 0
    s_branch fk_h_p1
fk_t1c:
    s_lshl_b32 s56, s56, 2
    s_add_u32 s56, s56, s28
    s_cmp_lt_u32 s56, 56
    s_cbranch_scc1 fk_pf_x
    s_sub_u32 s58, s56, 56
    s_lshl_b32 s58, s58, 6
    s_and_b32 s59, s29, 1
    s_mul_i32 s59, s59, 1280
    s_add_u32 s59, s59, 344064
    s_waitcnt lgkmcnt(0)
    s_mov_b32 s12, s66
    s_mov_b32 s13, s67
    v_add_u32 v3, s58, v0
    v_mul_u32_u24 v4, 43691, v3
    v_lshrrev_b32 v4, 19, v4
    v_mul_u32_u24 v5, 12, v4
    v_sub_u32 v5, v3, v5
    v_mul_u32_u24 v4, 2688, v4
    v_lshl_add_u32 v4, v5, 7, v4
    buffer_load_dword v6, v4, s[12:15], s59 offen
    s_add_u32 s58, s58, 2560
    v_add_u32 v3, s58, v0
    v_mul_u32_u24 v4, 43691, v3
    v_lshrrev_b32 v4, 19, v4
    v_mul_u32_u24 v5, 12, v4
    v_sub_u32 v5, v3, v5
    v_mul_u32_u24 v4, 2688, v4
    v_lshl_add_u32 v4, v5, 7, v4
    buffer_load_dword v6, v4, s[12:15], s59 offen
    s_add_u32 s58, s58, 2560
    s_branch fk_pf_end
fk_pf_x:
    v_lshlrev_b32 v4, 7, v0
    s_lshr_b32 s59, s29, 1
    s_mul_i32 s59, s59, 458752
    s_lshl_b32 s58, s56, 13
    s_add_u32 s59, s59, s58
    s_waitcnt lgkmcnt(0)
    s_mov_b32 s8, s64
    s_mov_b32 s9, s65
    buffer_load_dword v6, v4, s[8:11], s59 offen
    s_add_u32 s56, s56, 50
fk_pf_end:
    s_sub_u32 s56, s56, 87
    s_cmp_ge_u32 s56, 13
    s_cbranch_scc1 fk_nocp2
    v_lshlrev_b32 v2, 7, v0
    s_cmp_lt_u32 s56, 3
    s_cbranch_scc0 fk_cp2_c
    s_lshl_b32 s33, s56, 13
    s_getpc_b64 s[20:21]
fk_cp2_pc:
    s_sub_u32 s20, s20, fk_cp2_pc-concat_heads__mha_block__spectral_gfnet__prompt_kernel
    s_subb_u32 s21, s21, 0
    s_mov_b32 s22, fk_end-concat_heads__mha_block__spectral_gfnet__prompt_kernel
    s_mov_b32 s23, 0x20000
    buffer_load_dword v7, v2, s[20:23], s33 offen
    s_branch fk_nocp2
fk_cp2_c:
    s_getpc_b64 s[20:21]
    s_add_u32 s20, s20, ctab@rel32@lo+4
    s_addc_u32 s21, s21, ctab@rel32@hi+12
    s_mov_b32 s22, 75776
    s_mov_b32 s23, 0x20000
    s_sub_u32 s33, s56, 3
    s_lshl_b32 s33, s33, 13
    buffer_load_dword v7, v2, s[20:23], s33 offen
fk_nocp2:
    v_and_b32 v116, 31, v0
    v_lshrrev_b32 v117, 5, v0
    v_bfe_u32 v118, v0, 1, 3
    v_xor_b32 v118, v118, v117
    s_lshr_b32 s33, s28, 1
    s_lshl_b32 s33, s33, 13
    v_lshl_add_u32 v119, v116, 7, s33
    v_xor_b32 v120, 0, v118
    v_lshl_add_u32 v104, v120, 4, v119
    v_xor_b32 v120, 2, v118
    v_lshl_add_u32 v105, v120, 4, v119
    v_xor_b32 v120, 4, v118
    v_lshl_add_u32 v106, v120, 4, v119
    v_xor_b32 v120, 6, v118
    v_lshl_add_u32 v107, v120, 4, v119
    v_mov_b32 v122, 0
    v_mov_b32 v120, 0x3f803f80
    v_cmp_eq_u32 vcc, 28, v116
    v_bfe_u32 v116, v0, 2, 2
    v_lshl_add_u32 v118, v117, 3, v116
    v_cndmask_b32 v122, v122, v120, vcc
    v_lshlrev_b32 v118, 8, v118
    v_bfe_u32 v119, v0, 4, 1
    v_lshlrev_b32 v119, 5, v119
    v_lshl_add_u32 v119, v116, 6, v119
    v_and_b32 v120, 3, v0
    v_lshl_add_u32 v119, v120, 3, v119
    s_and_b32 s33, s28, 1
    s_mul_i32 s33, s33, 112
    s_add_u32 s33, s33, s48
    s_add_u32 s34, s33, 0
    v_add_u32 v120, s34, v119
    v_and_b32 v120, 255, v120
    v_add_u32 v108, v120, v118
    s_add_u32 s34, s33, 56
    v_add_u32 v120, s34, v119
    v_and_b32 v120, 255, v120
    v_add_u32 v109, v120, v118
    v_mov_b32 v8, 0
    v_mov_b32 v9, 0
    v_mov_b32 v10, 0
    v_mov_b32 v11, 0
    v_mov_b32 v12, 0
    v_mov_b32 v13, 0
    v_mov_b32 v14, 0
    v_mov_b32 v15, 0
    v_mov_b32 v16, 0
    v_mov_b32 v17, 0
    v_mov_b32 v18, 0
    v_mov_b32 v19, 0
    v_mov_b32 v20, 0
    v_mov_b32 v21, 0
    v_mov_b32 v22, 0
    v_mov_b32 v23, 0
    v_mov_b32 v24, 0
    v_mov_b32 v25, 0
    v_mov_b32 v26, 0
    v_mov_b32 v27, 0
    v_mov_b32 v28, 0
    v_mov_b32 v29, 0
    v_mov_b32 v30, 0
    v_mov_b32 v31, 0
    v_mov_b32 v32, 0
    v_mov_b32 v33, 0
    v_mov_b32 v34, 0
    v_mov_b32 v35, 0
    v_mov_b32 v36, 0
    v_mov_b32 v37, 0
    v_mov_b32 v38, 0
    v_mov_b32 v39, 0
    v_mov_b32 v40, 0
    v_mov_b32 v41, 0
    v_mov_b32 v42, 0
    v_mov_b32 v43, 0
    v_mov_b32 v44, 0
    v_mov_b32 v45, 0
    v_mov_b32 v46, 0
    v_mov_b32 v47, 0
    v_mov_b32 v48, 0
    v_mov_b32 v49, 0
    v_mov_b32 v50, 0
    v_mov_b32 v51, 0
    v_mov_b32 v52, 0
    v_mov_b32 v53, 0
    v_mov_b32 v54, 0
    v_mov_b32 v55, 0
    v_mov_b32 v56, 0
    v_mov_b32 v57, 0
    v_mov_b32 v58, 0
    v_mov_b32 v59, 0
    v_mov_b32 v60, 0
    v_mov_b32 v61, 0
    v_mov_b32 v62, 0
    v_mov_b32 v63, 0
    v_mov_b32 v64, 0
    v_mov_b32 v65, 0
    v_mov_b32 v66, 0
    v_mov_b32 v67, 0
    v_mov_b32 v68, 0
    v_mov_b32 v69, 0
    v_mov_b32 v70, 0
    v_mov_b32 v71, 0
    s_lshr_b32 s33, s32, 2
    s_mul_i32 s38, s33, 2097152
    s_add_u32 s38, s38, 0
    s_and_b32 s33, s32, 3
    s_mul_i32 s33, s33, 524288
    s_add_u32 s38, s38, s33
    s_and_b32 s33, s28, 1
    s_mul_i32 s33, s33, 262144
    s_add_u32 s38, s38, s33
    s_lshl_b32 s33, s31, 13
    s_add_u32 s38, s38, s33
    s_lshr_b32 s33, s28, 1
    s_lshl_b32 s33, s33, 12
    s_add_u32 s38, s38, s33
    s_add_u32 s39, s38, 131072
    s_mov_b32 s50, 0
    s_mov_b32 s51, -1
    s_mov_b32 s52, 0xf0000000
    s_mov_b32 s53, 0xf0000000
    s_cmp_lt_u32 s32, 4
    s_cselect_b32 s60, 0x3e8b97f6, 1.0
    s_cselect_b32 s61, 0x3e8b97f6, 1.0
    s_cselect_b32 s55, 0, 0x3f803f80
    s_mov_b32 s36, 0
    s_cmp_ge_u32 s32, 8
    s_cbranch_scc1 fk_t1v
    s_add_u32 s33, s36, 0
    s_and_b32 s33, s33, 3
    s_lshl_b32 s33, s33, 15
    v_add_u32 v110, s33, v104
    v_add_u32 v111, s33, v105
    v_add_u32 v112, s33, v106
    v_add_u32 v113, s33, v107
    v_add_u32 v114, s33, v108
    v_add_u32 v115, s33, v109
    s_barrier
    ds_read_b128 v[72:75], v110 offset:0
    ds_read_b64_tr_b16 v[88:89], v114 offset:16384
    ds_read_b64_tr_b16 v[90:91], v114 offset:17408
    ds_read_b64_tr_b16 v[92:93], v115 offset:16384
    ds_read_b64_tr_b16 v[94:95], v115 offset:17408
    ds_read_b128 v[76:79], v110 offset:4096
fk_qk_loop:
    s_waitcnt lgkmcnt(0)
    v_mfma_f32_32x32x16_bf16 v[8:23], v[88:91], v[72:75], v[8:23]
    ds_read_b128 v[80:83], v111 offset:0
    ds_read_b64_tr_b16 v[96:97], v114 offset:20480
    v_mfma_f32_32x32x16_bf16 v[24:39], v[92:95], v[72:75], v[24:39]
    ds_read_b64_tr_b16 v[98:99], v114 offset:21504
    ds_read_b64_tr_b16 v[100:101], v115 offset:20480
    v_mfma_f32_32x32x16_bf16 v[40:55], v[88:91], v[76:79], v[40:55]
    ds_read_b64_tr_b16 v[102:103], v115 offset:21504
    ds_read_b128 v[84:87], v111 offset:4096
    v_mfma_f32_32x32x16_bf16 v[56:71], v[92:95], v[76:79], v[56:71]
    s_waitcnt lgkmcnt(0)
    v_mfma_f32_32x32x16_bf16 v[8:23], v[96:99], v[80:83], v[8:23]
    ds_read_b128 v[72:75], v112 offset:0
    ds_read_b64_tr_b16 v[88:89], v114 offset:24576
    v_mfma_f32_32x32x16_bf16 v[24:39], v[100:103], v[80:83], v[24:39]
    ds_read_b64_tr_b16 v[90:91], v114 offset:25600
    ds_read_b64_tr_b16 v[92:93], v115 offset:24576
    v_mfma_f32_32x32x16_bf16 v[40:55], v[96:99], v[84:87], v[40:55]
    ds_read_b64_tr_b16 v[94:95], v115 offset:25600
    ds_read_b128 v[76:79], v112 offset:4096
    v_mfma_f32_32x32x16_bf16 v[56:71], v[100:103], v[84:87], v[56:71]
    s_waitcnt lgkmcnt(0)
    v_mfma_f32_32x32x16_bf16 v[8:23], v[88:91], v[72:75], v[8:23]
    ds_read_b128 v[80:83], v113 offset:0
    ds_read_b64_tr_b16 v[96:97], v114 offset:28672
    v_mfma_f32_32x32x16_bf16 v[24:39], v[92:95], v[72:75], v[24:39]
    ds_read_b64_tr_b16 v[98:99], v114 offset:29696
    ds_read_b64_tr_b16 v[100:101], v115 offset:28672
    v_mfma_f32_32x32x16_bf16 v[40:55], v[88:91], v[76:79], v[40:55]
    ds_read_b64_tr_b16 v[102:103], v115 offset:29696
    ds_read_b128 v[84:87], v113 offset:4096
    v_mfma_f32_32x32x16_bf16 v[56:71], v[92:95], v[76:79], v[56:71]
    s_waitcnt lgkmcnt(0)
    v_mfma_f32_32x32x16_bf16 v[8:23], v[96:99], v[80:83], v[8:23]
    s_cmp_eq_u32 s36, 6
    s_cbranch_scc1 fk_qk_loop_last
    s_add_u32 s33, s36, 1
    s_and_b32 s33, s33, 3
    s_lshl_b32 s33, s33, 15
    v_add_u32 v110, s33, v104
    v_add_u32 v111, s33, v105
    v_add_u32 v112, s33, v106
    v_add_u32 v113, s33, v107
    v_add_u32 v114, s33, v108
    v_add_u32 v115, s33, v109
    v_mfma_f32_32x32x16_bf16 v[24:39], v[100:103], v[80:83], v[24:39]
    s_barrier
    ds_read_b128 v[72:75], v110 offset:0
    ds_read_b64_tr_b16 v[88:89], v114 offset:16384
    ds_read_b64_tr_b16 v[90:91], v114 offset:17408
    v_mfma_f32_32x32x16_bf16 v[40:55], v[96:99], v[84:87], v[40:55]
    ds_read_b64_tr_b16 v[92:93], v115 offset:16384
    ds_read_b64_tr_b16 v[94:95], v115 offset:17408
    ds_read_b128 v[76:79], v110 offset:4096
    v_mfma_f32_32x32x16_bf16 v[56:71], v[100:103], v[84:87], v[56:71]
    s_add_u32 s36, s36, 1
    s_branch fk_qk_loop
fk_qk_loop_last:
    v_mfma_f32_32x32x16_bf16 v[24:39], v[100:103], v[80:83], v[24:39]
    v_mfma_f32_32x32x16_bf16 v[40:55], v[96:99], v[84:87], v[40:55]
    v_mfma_f32_32x32x16_bf16 v[56:71], v[100:103], v[84:87], v[56:71]
    s_nop 7
    s_nop 1
    v_pk_mul_f32 v[8:9], v[8:9], s[60:61]
    v_pk_mul_f32 v[10:11], v[10:11], s[60:61]
    v_pk_mul_f32 v[12:13], v[12:13], s[60:61]
    v_pk_mul_f32 v[14:15], v[14:15], s[60:61]
    v_pk_mul_f32 v[16:17], v[16:17], s[60:61]
    v_pk_mul_f32 v[18:19], v[18:19], s[60:61]
    v_pk_mul_f32 v[20:21], v[20:21], s[60:61]
    v_pk_mul_f32 v[22:23], v[22:23], s[60:61]
    v_cvt_pk_bf16_f32 v8, v8, v9
    v_cvt_pk_bf16_f32 v9, v10, v11
    v_cvt_pk_bf16_f32 v10, v12, v13
    v_cvt_pk_bf16_f32 v11, v14, v15
    v_cvt_pk_bf16_f32 v12, v16, v17
    v_cvt_pk_bf16_f32 v13, v18, v19
    v_cvt_pk_bf16_f32 v14, v20, v21
    v_cvt_pk_bf16_f32 v15, v22, v23
    s_mov_b64 exec, s[50:51]
    v_mov_b32 v14, s55
    v_mov_b32 v15, 0
    s_mov_b64 exec, -1
    buffer_store_dwordx4 v[8:11], v1, s[16:19], s38 offen offset:0 sc1
    buffer_store_dwordx4 v[12:15], v1, s[16:19], s38 offen offset:1024 sc1
    v_pk_mul_f32 v[24:25], v[24:25], s[60:61]
    v_pk_mul_f32 v[26:27], v[26:27], s[60:61]
    v_pk_mul_f32 v[28:29], v[28:29], s[60:61]
    v_pk_mul_f32 v[30:31], v[30:31], s[60:61]
    v_pk_mul_f32 v[32:33], v[32:33], s[60:61]
    v_pk_mul_f32 v[34:35], v[34:35], s[60:61]
    v_pk_mul_f32 v[36:37], v[36:37], s[60:61]
    v_pk_mul_f32 v[38:39], v[38:39], s[60:61]
    v_cvt_pk_bf16_f32 v24, v24, v25
    v_cvt_pk_bf16_f32 v25, v26, v27
    v_cvt_pk_bf16_f32 v26, v28, v29
    v_cvt_pk_bf16_f32 v27, v30, v31
    v_cvt_pk_bf16_f32 v28, v32, v33
    v_cvt_pk_bf16_f32 v29, v34, v35
    v_cvt_pk_bf16_f32 v30, v36, v37
    v_cvt_pk_bf16_f32 v31, v38, v39
    s_mov_b64 exec, s[50:51]
    v_mov_b32 v30, s55
    v_mov_b32 v31, 0
    s_mov_b64 exec, -1
    buffer_store_dwordx4 v[24:27], v1, s[16:19], s39 offen offset:0 sc1
    buffer_store_dwordx4 v[28:31], v1, s[16:19], s39 offen offset:1024 sc1
    v_pk_mul_f32 v[40:41], v[40:41], s[60:61]
    v_pk_mul_f32 v[42:43], v[42:43], s[60:61]
    v_pk_mul_f32 v[44:45], v[44:45], s[60:61]
    v_pk_mul_f32 v[46:47], v[46:47], s[60:61]
    v_pk_mul_f32 v[48:49], v[48:49], s[60:61]
    v_pk_mul_f32 v[50:51], v[50:51], s[60:61]
    v_pk_mul_f32 v[52:53], v[52:53], s[60:61]
    v_pk_mul_f32 v[54:55], v[54:55], s[60:61]
    v_cvt_pk_bf16_f32 v40, v40, v41
    v_cvt_pk_bf16_f32 v41, v42, v43
    v_cvt_pk_bf16_f32 v42, v44, v45
    v_cvt_pk_bf16_f32 v43, v46, v47
    v_cvt_pk_bf16_f32 v44, v48, v49
    v_cvt_pk_bf16_f32 v45, v50, v51
    v_cvt_pk_bf16_f32 v46, v52, v53
    v_cvt_pk_bf16_f32 v47, v54, v55
    s_mov_b64 exec, s[50:51]
    v_mov_b32 v46, s55
    v_mov_b32 v47, 0
    s_mov_b64 exec, -1
    buffer_store_dwordx4 v[40:43], v1, s[16:19], s38 offen offset:2048 sc1
    buffer_store_dwordx4 v[44:47], v1, s[16:19], s38 offen offset:3072 sc1
    v_pk_mul_f32 v[56:57], v[56:57], s[60:61]
    v_pk_mul_f32 v[58:59], v[58:59], s[60:61]
    v_pk_mul_f32 v[60:61], v[60:61], s[60:61]
    v_pk_mul_f32 v[62:63], v[62:63], s[60:61]
    v_pk_mul_f32 v[64:65], v[64:65], s[60:61]
    v_pk_mul_f32 v[66:67], v[66:67], s[60:61]
    v_pk_mul_f32 v[68:69], v[68:69], s[60:61]
    v_pk_mul_f32 v[70:71], v[70:71], s[60:61]
    v_cvt_pk_bf16_f32 v56, v56, v57
    v_cvt_pk_bf16_f32 v57, v58, v59
    v_cvt_pk_bf16_f32 v58, v60, v61
    v_cvt_pk_bf16_f32 v59, v62, v63
    v_cvt_pk_bf16_f32 v60, v64, v65
    v_cvt_pk_bf16_f32 v61, v66, v67
    v_cvt_pk_bf16_f32 v62, v68, v69
    v_cvt_pk_bf16_f32 v63, v70, v71
    s_mov_b64 exec, s[50:51]
    v_mov_b32 v62, s55
    v_mov_b32 v63, 0
    s_mov_b64 exec, -1
    buffer_store_dwordx4 v[56:59], v1, s[16:19], s39 offen offset:2048 sc1
    buffer_store_dwordx4 v[60:63], v1, s[16:19], s39 offen offset:3072 sc1
    s_branch fk_c_p1
fk_t1v:
    s_add_u32 s33, s36, 0
    s_and_b32 s33, s33, 3
    s_lshl_b32 s33, s33, 15
    v_add_u32 v110, s33, v104
    v_add_u32 v111, s33, v105
    v_add_u32 v112, s33, v106
    v_add_u32 v113, s33, v107
    v_add_u32 v114, s33, v108
    v_add_u32 v115, s33, v109
    s_barrier
    ds_read_b128 v[72:75], v110 offset:0
    ds_read_b64_tr_b16 v[88:89], v114 offset:16384
    ds_read_b64_tr_b16 v[90:91], v114 offset:17408
    ds_read_b64_tr_b16 v[92:93], v115 offset:16384
    ds_read_b64_tr_b16 v[94:95], v115 offset:17408
    ds_read_b128 v[76:79], v110 offset:4096
fk_v_loop:
    s_waitcnt lgkmcnt(0)
    v_mfma_f32_32x32x16_bf16 v[8:23], v[72:75], v[88:91], v[8:23]
    ds_read_b128 v[80:83], v111 offset:0
    ds_read_b64_tr_b16 v[96:97], v114 offset:20480
    v_mfma_f32_32x32x16_bf16 v[24:39], v[72:75], v[92:95], v[24:39]
    ds_read_b64_tr_b16 v[98:99], v114 offset:21504
    ds_read_b64_tr_b16 v[100:101], v115 offset:20480
    v_mfma_f32_32x32x16_bf16 v[40:55], v[76:79], v[88:91], v[40:55]
    ds_read_b64_tr_b16 v[102:103], v115 offset:21504
    ds_read_b128 v[84:87], v111 offset:4096
    v_mfma_f32_32x32x16_bf16 v[56:71], v[76:79], v[92:95], v[56:71]
    s_waitcnt lgkmcnt(0)
    v_mfma_f32_32x32x16_bf16 v[8:23], v[80:83], v[96:99], v[8:23]
    ds_read_b128 v[72:75], v112 offset:0
    ds_read_b64_tr_b16 v[88:89], v114 offset:24576
    v_mfma_f32_32x32x16_bf16 v[24:39], v[80:83], v[100:103], v[24:39]
    ds_read_b64_tr_b16 v[90:91], v114 offset:25600
    ds_read_b64_tr_b16 v[92:93], v115 offset:24576
    v_mfma_f32_32x32x16_bf16 v[40:55], v[84:87], v[96:99], v[40:55]
    ds_read_b64_tr_b16 v[94:95], v115 offset:25600
    ds_read_b128 v[76:79], v112 offset:4096
    v_mfma_f32_32x32x16_bf16 v[56:71], v[84:87], v[100:103], v[56:71]
    s_waitcnt lgkmcnt(0)
    v_mfma_f32_32x32x16_bf16 v[8:23], v[72:75], v[88:91], v[8:23]
    ds_read_b128 v[80:83], v113 offset:0
    ds_read_b64_tr_b16 v[96:97], v114 offset:28672
    v_mfma_f32_32x32x16_bf16 v[24:39], v[72:75], v[92:95], v[24:39]
    ds_read_b64_tr_b16 v[98:99], v114 offset:29696
    ds_read_b64_tr_b16 v[100:101], v115 offset:28672
    v_mfma_f32_32x32x16_bf16 v[40:55], v[76:79], v[88:91], v[40:55]
    ds_read_b64_tr_b16 v[102:103], v115 offset:29696
    ds_read_b128 v[84:87], v113 offset:4096
    v_mfma_f32_32x32x16_bf16 v[56:71], v[76:79], v[92:95], v[56:71]
    s_waitcnt lgkmcnt(0)
    v_mfma_f32_32x32x16_bf16 v[8:23], v[80:83], v[96:99], v[8:23]
    s_cmp_eq_u32 s36, 6
    s_cbranch_scc1 fk_v_loop_last
    s_add_u32 s33, s36, 1
    s_and_b32 s33, s33, 3
    s_lshl_b32 s33, s33, 15
    v_add_u32 v110, s33, v104
    v_add_u32 v111, s33, v105
    v_add_u32 v112, s33, v106
    v_add_u32 v113, s33, v107
    v_add_u32 v114, s33, v108
    v_add_u32 v115, s33, v109
    v_mfma_f32_32x32x16_bf16 v[24:39], v[80:83], v[100:103], v[24:39]
    s_barrier
    ds_read_b128 v[72:75], v110 offset:0
    ds_read_b64_tr_b16 v[88:89], v114 offset:16384
    ds_read_b64_tr_b16 v[90:91], v114 offset:17408
    v_mfma_f32_32x32x16_bf16 v[40:55], v[84:87], v[96:99], v[40:55]
    ds_read_b64_tr_b16 v[92:93], v115 offset:16384
    ds_read_b64_tr_b16 v[94:95], v115 offset:17408
    ds_read_b128 v[76:79], v110 offset:4096
    v_mfma_f32_32x32x16_bf16 v[56:71], v[84:87], v[100:103], v[56:71]
    s_add_u32 s36, s36, 1
    s_branch fk_v_loop
fk_v_loop_last:
    v_mfma_f32_32x32x16_bf16 v[24:39], v[80:83], v[100:103], v[24:39]
    v_mfma_f32_32x32x16_bf16 v[40:55], v[84:87], v[96:99], v[40:55]
    v_mfma_f32_32x32x16_bf16 v[56:71], v[84:87], v[100:103], v[56:71]
    s_nop 7
    s_nop 1
    v_cvt_pk_bf16_f32 v8, v8, v9
    v_cvt_pk_bf16_f32 v9, v10, v11
    v_cvt_pk_bf16_f32 v10, v12, v13
    v_cvt_pk_bf16_f32 v11, v14, v15
    v_cvt_pk_bf16_f32 v12, v16, v17
    v_cvt_pk_bf16_f32 v13, v18, v19
    v_cvt_pk_bf16_f32 v14, v20, v21
    v_cvt_pk_bf16_f32 v15, v22, v23
    s_mov_b64 exec, s[52:53]
    v_mov_b32 v8, v122
    v_mov_b32 v9, v122
    v_mov_b32 v10, v122
    v_mov_b32 v11, v122
    v_mov_b32 v12, v122
    v_mov_b32 v13, v122
    v_mov_b32 v14, v122
    v_mov_b32 v15, v122
    s_mov_b64 exec, -1
    buffer_store_dwordx4 v[8:11], v1, s[16:19], s38 offen offset:0 sc1
    buffer_store_dwordx4 v[12:15], v1, s[16:19], s38 offen offset:1024 sc1
    v_cvt_pk_bf16_f32 v24, v24, v25
    v_cvt_pk_bf16_f32 v25, v26, v27
    v_cvt_pk_bf16_f32 v26, v28, v29
    v_cvt_pk_bf16_f32 v27, v30, v31
    v_cvt_pk_bf16_f32 v28, v32, v33
    v_cvt_pk_bf16_f32 v29, v34, v35
    v_cvt_pk_bf16_f32 v30, v36, v37
    v_cvt_pk_bf16_f32 v31, v38, v39
    s_mov_b64 exec, s[52:53]
    v_mov_b32 v24, v122
    v_mov_b32 v25, v122
    v_mov_b32 v26, v122
    v_mov_b32 v27, v122
    v_mov_b32 v28, v122
    v_mov_b32 v29, v122
    v_mov_b32 v30, v122
    v_mov_b32 v31, v122
    s_mov_b64 exec, -1
    buffer_store_dwordx4 v[24:27], v1, s[16:19], s39 offen offset:0 sc1
    buffer_store_dwordx4 v[28:31], v1, s[16:19], s39 offen offset:1024 sc1
    v_cvt_pk_bf16_f32 v40, v40, v41
    v_cvt_pk_bf16_f32 v41, v42, v43
    v_cvt_pk_bf16_f32 v42, v44, v45
    v_cvt_pk_bf16_f32 v43, v46, v47
    v_cvt_pk_bf16_f32 v44, v48, v49
    v_cvt_pk_bf16_f32 v45, v50, v51
    v_cvt_pk_bf16_f32 v46, v52, v53
    v_cvt_pk_bf16_f32 v47, v54, v55
    s_mov_b64 exec, s[52:53]
    v_mov_b32 v40, v122
    v_mov_b32 v41, v122
    v_mov_b32 v42, v122
    v_mov_b32 v43, v122
    v_mov_b32 v44, v122
    v_mov_b32 v45, v122
    v_mov_b32 v46, v122
    v_mov_b32 v47, v122
    s_mov_b64 exec, -1
    buffer_store_dwordx4 v[40:43], v1, s[16:19], s38 offen offset:2048 sc1
    buffer_store_dwordx4 v[44:47], v1, s[16:19], s38 offen offset:3072 sc1
    v_cvt_pk_bf16_f32 v56, v56, v57
    v_cvt_pk_bf16_f32 v57, v58, v59
    v_cvt_pk_bf16_f32 v58, v60, v61
    v_cvt_pk_bf16_f32 v59, v62, v63
    v_cvt_pk_bf16_f32 v60, v64, v65
    v_cvt_pk_bf16_f32 v61, v66, v67
    v_cvt_pk_bf16_f32 v62, v68, v69
    v_cvt_pk_bf16_f32 v63, v70, v71
    s_mov_b64 exec, s[52:53]
    v_mov_b32 v56, v122
    v_mov_b32 v57, v122
    v_mov_b32 v58, v122
    v_mov_b32 v59, v122
    v_mov_b32 v60, v122
    v_mov_b32 v61, v122
    v_mov_b32 v62, v122
    v_mov_b32 v63, v122
    s_mov_b64 exec, -1
    buffer_store_dwordx4 v[56:59], v1, s[16:19], s39 offen offset:2048 sc1
    buffer_store_dwordx4 v[60:63], v1, s[16:19], s39 offen offset:3072 sc1
    s_branch fk_c_p1
fk_bwg:
    s_lshl_b32 s31, s29, 3
    s_add_u32 s31, s31, s30
    s_getpc_b64 s[20:21]
    s_add_u32 s20, s20, ctab@rel32@lo+4
    s_addc_u32 s21, s21, ctab@rel32@hi+12
    s_mov_b32 s22, 75776
    s_mov_b32 s23, 0x20000
    s_cmp_ge_u32 s3, 4
    s_cbranch_scc1 fk_t3
    s_mov_b32 s10, 1835008
    s_mov_b32 s11, 0x20000
    s_lshr_b32 s32, s31, 2
    s_and_b32 s36, s31, 3
    s_and_b32 s34, s28, 1
    s_lshl_b32 s33, s34, 12
    s_add_u32 s33, s33, 55296
    buffer_load_dwordx4 v[164:167], v1, s[20:23], s33 offen offset:0
    buffer_load_dwordx4 v[168:171], v1, s[20:23], s33 offen offset:1024
    buffer_load_dwordx4 v[172:175], v1, s[20:23], s33 offen offset:2048
    buffer_load_dwordx4 v[176:179], v1, s[20:23], s33 offen offset:3072
    v_lshrrev_b32 v241, 4, v0
    v_lshlrev_b32 v242, 8, v241
    s_lshl_b32 s33, s34, 10
    s_add_u32 s33, s33, 73728
    buffer_load_dwordx4 v[180:183], v242, s[20:23], s33 offen offset:0
    buffer_load_dwordx4 v[184:187], v242, s[20:23], s33 offen offset:16
    buffer_load_dwordx4 v[188:191], v242, s[20:23], s33 offen offset:32
    buffer_load_dwordx4 v[192:195], v242, s[20:23], s33 offen offset:48
    buffer_load_dwordx4 v[196:199], v242, s[20:23], s33 offen offset:64
    buffer_load_dwordx4 v[200:203], v242, s[20:23], s33 offen offset:80
    buffer_load_dwordx4 v[204:207], v242, s[20:23], s33 offen offset:96
    buffer_load_dwordx4 v[208:211], v242, s[20:23], s33 offen offset:112
    buffer_load_dwordx4 v[212:215], v242, s[20:23], s33 offen offset:128
    buffer_load_dwordx4 v[216:219], v242, s[20:23], s33 offen offset:144
    buffer_load_dwordx4 v[220:223], v242, s[20:23], s33 offen offset:160
    buffer_load_dwordx4 v[224:227], v242, s[20:23], s33 offen offset:176
    buffer_load_dwordx4 v[228:231], v242, s[20:23], s33 offen offset:192
    buffer_load_dwordx4 v[232:235], v242, s[20:23], s33 offen offset:208
    s_lshr_b32 s35, s28, 1
    s_lshl_b32 s33, s32, 5
    s_lshl_b32 s34, s36, 1
    s_add_u32 s33, s33, s34
    s_add_u32 s33, s33, s35
    s_mul_i32 s38, s33, 3584
    s_mul_i32 s37, s28, 14336
    v_lshrrev_b32 v236, 3, v0
    v_and_b32 v237, 7, v0
    v_add_u32 v238, 0, v236
    v_mul_u32_u24 v239, 147, v238
    v_lshrrev_b32 v239, 10, v239
    v_lshrrev_b32 v240, 2, v239
    v_and_b32 v239, 1, v239
    v_lshl_add_u32 v239, v239, 2, v240
    v_xor_b32 v239, v239, v237
    v_mul_u32_u24 v240, 25088, v240
    v_lshl_add_u32 v240, v238, 7, v240
    v_lshl_add_u32 v36, v239, 4, v240
    v_add_u32 v238, 8, v236
    v_mul_u32_u24 v239, 147, v238
    v_lshrrev_b32 v239, 10, v239
    v_lshrrev_b32 v240, 2, v239
    v_and_b32 v239, 1, v239
    v_lshl_add_u32 v239, v239, 2, v240
    v_xor_b32 v239, v239, v237
    v_mul_u32_u24 v240, 25088, v240
    v_lshl_add_u32 v240, v238, 7, v240
    v_lshl_add_u32 v37, v239, 4, v240
    v_add_u32 v238, 16, v236
    v_mul_u32_u24 v239, 147, v238
    v_lshrrev_b32 v239, 10, v239
    v_lshrrev_b32 v240, 2, v239
    v_and_b32 v239, 1, v239
    v_lshl_add_u32 v239, v239, 2, v240
    v_xor_b32 v239, v239, v237
    v_mul_u32_u24 v240, 25088, v240
    v_lshl_add_u32 v240, v238, 7, v240
    v_lshl_add_u32 v38, v239, 4, v240
    v_add_u32 v238, 24, v236
    v_mul_u32_u24 v239, 147, v238
    v_lshrrev_b32 v239, 10, v239
    v_lshrrev_b32 v240, 2, v239
    v_and_b32 v239, 1, v239
    v_lshl_add_u32 v239, v239, 2, v240
    v_xor_b32 v239, v239, v237
    v_mul_u32_u24 v240, 25088, v240
    v_lshl_add_u32 v240, v238, 7, v240
    v_lshl_add_u32 v39, v239, 4, v240
    v_add_u32 v238, 32, v236
    v_mul_u32_u24 v239, 147, v238
    v_lshrrev_b32 v239, 10, v239
    v_lshrrev_b32 v240, 2, v239
    v_and_b32 v239, 1, v239
    v_lshl_add_u32 v239, v239, 2, v240
    v_xor_b32 v239, v239, v237
    v_mul_u32_u24 v240, 25088, v240
    v_lshl_add_u32 v240, v238, 7, v240
    v_lshl_add_u32 v40, v239, 4, v240
    v_add_u32 v238, 40, v236
    v_mul_u32_u24 v239, 147, v238
    v_lshrrev_b32 v239, 10, v239
    v_lshrrev_b32 v240, 2, v239
    v_and_b32 v239, 1, v239
    v_lshl_add_u32 v239, v239, 2, v240
    v_xor_b32 v239, v239, v237
    v_mul_u32_u24 v240, 25088, v240
    v_lshl_add_u32 v240, v238, 7, v240
    v_lshl_add_u32 v41, v239, 4, v240
    v_add_u32 v238, 48, v236
    v_mul_u32_u24 v239, 147, v238
    v_lshrrev_b32 v239, 10, v239
    v_lshrrev_b32 v240, 2, v239
    v_and_b32 v239, 1, v239
    v_lshl_add_u32 v239, v239, 2, v240
    v_xor_b32 v239, v239, v237
    v_mul_u32_u24 v240, 25088, v240
    v_lshl_add_u32 v240, v238, 7, v240
    v_lshl_add_u32 v42, v239, 4, v240
    v_add_u32 v238, 56, v236
    v_mul_u32_u24 v239, 147, v238
    v_lshrrev_b32 v239, 10, v239
    v_lshrrev_b32 v240, 2, v239
    v_and_b32 v239, 1, v239
    v_lshl_add_u32 v239, v239, 2, v240
    v_xor_b32 v239, v239, v237
    v_mul_u32_u24 v240, 25088, v240
    v_lshl_add_u32 v240, v238, 7, v240
    v_lshl_add_u32 v43, v239, 4, v240
    v_add_u32 v238, 64, v236
    v_mul_u32_u24 v239, 147, v238
    v_lshrrev_b32 v239, 10, v239
    v_lshrrev_b32 v240, 2, v239
    v_and_b32 v239, 1, v239
    v_lshl_add_u32 v239, v239, 2, v240
    v_xor_b32 v239, v239, v237
    v_mul_u32_u24 v240, 25088, v240
    v_lshl_add_u32 v240, v238, 7, v240
    v_lshl_add_u32 v44, v239, 4, v240
    v_add_u32 v238, 72, v236
    v_mul_u32_u24 v239, 147, v238
    v_lshrrev_b32 v239, 10, v239
    v_lshrrev_b32 v240, 2, v239
    v_and_b32 v239, 1, v239
    v_lshl_add_u32 v239, v239, 2, v240
    v_xor_b32 v239, v239, v237
    v_mul_u32_u24 v240, 25088, v240
    v_lshl_add_u32 v240, v238, 7, v240
    v_lshl_add_u32 v45, v239, 4, v240
    v_add_u32 v238, 80, v236
    v_mul_u32_u24 v239, 147, v238
    v_lshrrev_b32 v239, 10, v239
    v_lshrrev_b32 v240, 2, v239
    v_and_b32 v239, 1, v239
    v_lshl_add_u32 v239, v239, 2, v240
    v_xor_b32 v239, v239, v237
    v_mul_u32_u24 v240, 25088, v240
    v_lshl_add_u32 v240, v238, 7, v240
    v_lshl_add_u32 v46, v239, 4, v240
    v_add_u32 v238, 88, v236
    v_mul_u32_u24 v239, 147, v238
    v_lshrrev_b32 v239, 10, v239
    v_lshrrev_b32 v240, 2, v239
    v_and_b32 v239, 1, v239
    v_lshl_add_u32 v239, v239, 2, v240
    v_xor_b32 v239, v239, v237
    v_mul_u32_u24 v240, 25088, v240
    v_lshl_add_u32 v240, v238, 7, v240
    v_lshl_add_u32 v47, v239, 4, v240
    v_add_u32 v238, 96, v236
    v_mul_u32_u24 v239, 147, v238
    v_lshrrev_b32 v239, 10, v239
    v_lshrrev_b32 v240, 2, v239
    v_and_b32 v239, 1, v239
    v_lshl_add_u32 v239, v239, 2, v240
    v_xor_b32 v239, v239, v237
    v_mul_u32_u24 v240, 25088, v240
    v_lshl_add_u32 v240, v238, 7, v240
    v_lshl_add_u32 v48, v239, 4, v240
    v_add_u32 v238, 104, v236
    v_mul_u32_u24 v239, 147, v238
    v_lshrrev_b32 v239, 10, v239
    v_lshrrev_b32 v240, 2, v239
    v_and_b32 v239, 1, v239
    v_lshl_add_u32 v239, v239, 2, v240
    v_xor_b32 v239, v239, v237
    v_mul_u32_u24 v240, 25088, v240
    v_lshl_add_u32 v240, v238, 7, v240
    v_lshl_add_u32 v49, v239, 4, v240
    s_waitcnt lgkmcnt(0)
    s_mov_b32 s8, s70
    s_mov_b32 s9, s71
    s_add_u32 m0, s37, 0
    s_nop 0
    buffer_load_dwordx4 v36, s[8:11], s38 offen lds
    s_add_u32 m0, s37, 1024
    s_nop 0
    buffer_load_dwordx4 v37, s[8:11], s38 offen lds
    s_add_u32 m0, s37, 2048
    s_nop 0
    buffer_load_dwordx4 v38, s[8:11], s38 offen lds
    s_add_u32 m0, s37, 3072
    s_nop 0
    buffer_load_dwordx4 v39, s[8:11], s38 offen lds
    s_add_u32 m0, s37, 4096
    s_nop 0
    buffer_load_dwordx4 v40, s[8:11], s38 offen lds
    s_add_u32 m0, s37, 5120
    s_nop 0
    buffer_load_dwordx4 v41, s[8:11], s38 offen lds
    s_add_u32 m0, s37, 6144
    s_nop 0
    buffer_load_dwordx4 v42, s[8:11], s38 offen lds
    s_add_u32 m0, s37, 7168
    s_nop 0
    buffer_load_dwordx4 v43, s[8:11], s38 offen lds
    s_add_u32 m0, s37, 8192
    s_nop 0
    buffer_load_dwordx4 v44, s[8:11], s38 offen lds
    s_add_u32 m0, s37, 9216
    s_nop 0
    buffer_load_dwordx4 v45, s[8:11], s38 offen lds
    s_add_u32 m0, s37, 10240
    s_nop 0
    buffer_load_dwordx4 v46, s[8:11], s38 offen lds
    s_add_u32 m0, s37, 11264
    s_nop 0
    buffer_load_dwordx4 v47, s[8:11], s38 offen lds
    s_add_u32 m0, s37, 12288
    s_nop 0
    buffer_load_dwordx4 v48, s[8:11], s38 offen lds
    s_add_u32 m0, s37, 13312
    s_nop 0
    buffer_load_dwordx4 v49, s[8:11], s38 offen lds
    s_and_b32 s34, s28, 1
    v_and_b32 v236, 3, v0
    v_bfe_u32 v237, v0, 2, 2
    v_lshl_add_u32 v238, v236, 2, v237
    v_mul_u32_u24 v238, 896, v238
    v_add_u32 v238, s37, v238
    v_and_b32 v237, 1, v237
    v_lshl_add_u32 v239, v237, 2, v236
    v_lshlrev_b32 v239, 4, v239
    v_lshl_add_u32 v252, v241, 7, v238
    v_min_u32 v240, 2, v241
    v_lshl_add_u32 v253, v240, 7, v238
    v_add_u32 v253, 512, v253
    v_and_b32 v236, 15, v0
    v_lshlrev_b32 v236, 2, v236
    s_lshl_b32 s33, s34, 4
    v_lshl_add_u32 v237, v241, 2, s33
    v_mov_b32 v243, 0x7f000000
    s_mov_b32 s58, 8320
    v_add_u32 v238, 0, v237
    v_mad_u32_u24 v244, v238, s58, v236
    v_sub_u32 v240, 28, v238
    v_mad_u32_u24 v248, v240, s58, v236
    v_cmp_lt_u32 vcc, 28, v238
    s_nop 1
    v_cndmask_b32 v244, v244, v243, vcc
    v_cndmask_b32 v248, v248, v243, vcc
    v_add_u32 v238, 1, v237
    v_mad_u32_u24 v245, v238, s58, v236
    v_sub_u32 v240, 28, v238
    v_mad_u32_u24 v249, v240, s58, v236
    v_cmp_lt_u32 vcc, 28, v238
    s_nop 1
    v_cndmask_b32 v245, v245, v243, vcc
    v_cndmask_b32 v249, v249, v243, vcc
    v_add_u32 v238, 2, v237
    v_mad_u32_u24 v246, v238, s58, v236
    v_sub_u32 v240, 28, v238
    v_mad_u32_u24 v250, v240, s58, v236
    v_cmp_lt_u32 vcc, 28, v238
    s_nop 1
    v_cndmask_b32 v246, v246, v243, vcc
    v_cndmask_b32 v250, v250, v243, vcc
    v_add_u32 v238, 3, v237
    v_mad_u32_u24 v247, v238, s58, v236
    v_sub_u32 v240, 28, v238
    v_mad_u32_u24 v251, v240, s58, v236
    v_cmp_lt_u32 vcc, 28, v238
    s_nop 1
    v_cndmask_b32 v247, v247, v243, vcc
    v_cndmask_b32 v251, v251, v243, vcc
    s_lshr_b32 s33, s36, 1
    s_lshl_b32 s33, s33, 12
    s_lshl_b32 s34, s32, 8
    s_add_u32 s33, s33, s34
    s_and_b32 s34, s36, 1
    s_lshl_b32 s34, s34, 7
    s_add_u32 s33, s33, s34
    s_lshl_b32 s34, s35, 6
    s_add_u32 s33, s33, s34
    s_add_u32 s40, s33, 6291456
    s_add_u32 s41, s33, 6757376
    s_add_u32 s42, s33, 7223296
    s_add_u32 s43, s33, 7689216
    s_add_u32 s44, s33, 7922176
    s_add_u32 s45, s33, 7456256
    s_add_u32 s46, s33, 6990336
    s_add_u32 s47, s33, 6524416
    s_mov_b32 s54, 0x3f3504f3
    s_mov_b32 s55, 0x3f3504f3
    s_mov_b32 s52, 0x05040100
    s_mov_b32 s53, 0x07060302
    s_waitcnt vmcnt(0)
    v_xor_b32 v236, 0, v239
    v_add_u32 v236, v236, v252
    ds_read_b128 v[4:7], v236
    v_xor_b32 v237, 16, v239
    v_add_u32 v237, v237, v252
    ds_read_b128 v[8:11], v237
    v_xor_b32 v236, 32, v239
    v_add_u32 v236, v236, v252
    ds_read_b128 v[12:15], v236
    v_xor_b32 v237, 48, v239
    v_add_u32 v237, v237, v252
    ds_read_b128 v[16:19], v237
    v_xor_b32 v236, 64, v239
    v_add_u32 v236, v236, v252
    ds_read_b128 v[20:23], v236
    v_xor_b32 v237, 80, v239
    v_add_u32 v237, v237, v252
    ds_read_b128 v[24:27], v237
    v_xor_b32 v236, 96, v239
    v_add_u32 v236, v236, v252
    ds_read_b128 v[28:31], v236
    v_xor_b32 v237, 112, v239
    v_add_u32 v237, v237, v252
    ds_read_b128 v[32:35], v237
    v_xor_b32 v236, 0, v239
    v_add_u32 v236, v236, v253
    ds_read_b128 v[36:39], v236
    v_xor_b32 v237, 16, v239
    v_add_u32 v237, v237, v253
    ds_read_b128 v[40:43], v237
    v_xor_b32 v236, 32, v239
    v_add_u32 v236, v236, v253
    ds_read_b128 v[44:47], v236
    v_xor_b32 v237, 48, v239
    v_add_u32 v237, v237, v253
    ds_read_b128 v[48:51], v237
    v_xor_b32 v236, 64, v239
    v_add_u32 v236, v236, v253
    ds_read_b128 v[52:55], v236
    v_xor_b32 v237, 80, v239
    v_add_u32 v237, v237, v253
    ds_read_b128 v[56:59], v237
    v_xor_b32 v236, 96, v239
    v_add_u32 v236, v236, v253
    ds_read_b128 v[60:63], v236
    v_xor_b32 v237, 112, v239
    v_add_u32 v237, v237, v253
    ds_read_b128 v[64:67], v237
    s_waitcnt lgkmcnt(8)
    v_perm_b32 v68, v8, v4, s52
    v_perm_b32 v69, v16, v12, s52
    v_perm_b32 v70, v24, v20, s52
    v_perm_b32 v71, v32, v28, s52
    v_perm_b32 v72, v8, v4, s53
    v_perm_b32 v73, v16, v12, s53
    v_perm_b32 v74, v24, v20, s53
    v_perm_b32 v75, v32, v28, s53
    v_mfma_f32_16x16x32_bf16 v[100:103], v[164:167], v[68:71], 0
    v_mfma_f32_16x16x32_bf16 v[104:107], v[172:175], v[68:71], 0
    v_perm_b32 v76, v9, v5, s52
    v_perm_b32 v77, v17, v13, s52
    v_perm_b32 v78, v25, v21, s52
    v_perm_b32 v79, v33, v29, s52
    v_mfma_f32_16x16x32_bf16 v[108:111], v[164:167], v[72:75], 0
    v_mfma_f32_16x16x32_bf16 v[112:115], v[172:175], v[72:75], 0
    v_perm_b32 v80, v9, v5, s53
    v_perm_b32 v81, v17, v13, s53
    v_perm_b32 v82, v25, v21, s53
    v_perm_b32 v83, v33, v29, s53
    v_mfma_f32_16x16x32_bf16 v[116:119], v[164:167], v[76:79], 0
    v_mfma_f32_16x16x32_bf16 v[120:123], v[172:175], v[76:79], 0
    v_perm_b32 v84, v10, v6, s52
    v_perm_b32 v85, v18, v14, s52
    v_perm_b32 v86, v26, v22, s52
    v_perm_b32 v87, v34, v30, s52
    v_mfma_f32_16x16x32_bf16 v[124:127], v[164:167], v[80:83], 0
    v_mfma_f32_16x16x32_bf16 v[128:131], v[172:175], v[80:83], 0
    v_perm_b32 v88, v10, v6, s53
    v_perm_b32 v89, v18, v14, s53
    v_perm_b32 v90, v26, v22, s53
    v_perm_b32 v91, v34, v30, s53
    v_mfma_f32_16x16x32_bf16 v[132:135], v[164:167], v[84:87], 0
    v_mfma_f32_16x16x32_bf16 v[136:139], v[172:175], v[84:87], 0
    v_perm_b32 v92, v11, v7, s52
    v_perm_b32 v93, v19, v15, s52
    v_perm_b32 v94, v27, v23, s52
    v_perm_b32 v95, v35, v31, s52
    v_mfma_f32_16x16x32_bf16 v[140:143], v[164:167], v[88:91], 0
    v_mfma_f32_16x16x32_bf16 v[144:147], v[172:175], v[88:91], 0
    v_perm_b32 v96, v11, v7, s53
    v_perm_b32 v97, v19, v15, s53
    v_perm_b32 v98, v27, v23, s53
    v_perm_b32 v99, v35, v31, s53
    v_mfma_f32_16x16x32_bf16 v[148:151], v[164:167], v[92:95], 0
    v_mfma_f32_16x16x32_bf16 v[152:155], v[172:175], v[92:95], 0
    s_nop 1
    v_mfma_f32_16x16x32_bf16 v[156:159], v[164:167], v[96:99], 0
    v_mfma_f32_16x16x32_bf16 v[160:163], v[172:175], v[96:99], 0
    s_waitcnt lgkmcnt(0)
    v_perm_b32 v68, v40, v36, s52
    v_perm_b32 v69, v48, v44, s52
    v_perm_b32 v70, v56, v52, s52
    v_perm_b32 v71, v64, v60, s52
    v_perm_b32 v72, v40, v36, s53
    v_perm_b32 v73, v48, v44, s53
    v_perm_b32 v74, v56, v52, s53
    v_perm_b32 v75, v64, v60, s53
    v_mfma_f32_16x16x32_bf16 v[100:103], v[168:171], v[68:71], v[100:103]
    v_mfma_f32_16x16x32_bf16 v[104:107], v[176:179], v[68:71], v[104:107]
    v_perm_b32 v76, v41, v37, s52
    v_perm_b32 v77, v49, v45, s52
    v_perm_b32 v78, v57, v53, s52
    v_perm_b32 v79, v65, v61, s52
    v_mfma_f32_16x16x32_bf16 v[108:111], v[168:171], v[72:75], v[108:111]
    v_mfma_f32_16x16x32_bf16 v[112:115], v[176:179], v[72:75], v[112:115]
    v_perm_b32 v80, v41, v37, s53
    v_perm_b32 v81, v49, v45, s53
    v_perm_b32 v82, v57, v53, s53
    v_perm_b32 v83, v65, v61, s53
    v_mfma_f32_16x16x32_bf16 v[116:119], v[168:171], v[76:79], v[116:119]
    v_mfma_f32_16x16x32_bf16 v[120:123], v[176:179], v[76:79], v[120:123]
    v_perm_b32 v84, v42, v38, s52
    v_perm_b32 v85, v50, v46, s52
    v_perm_b32 v86, v58, v54, s52
    v_perm_b32 v87, v66, v62, s52
    v_mfma_f32_16x16x32_bf16 v[124:127], v[168:171], v[80:83], v[124:127]
    v_mfma_f32_16x16x32_bf16 v[128:131], v[176:179], v[80:83], v[128:131]
    v_perm_b32 v88, v42, v38, s53
    v_perm_b32 v89, v50, v46, s53
    v_perm_b32 v90, v58, v54, s53
    v_perm_b32 v91, v66, v62, s53
    v_mfma_f32_16x16x32_bf16 v[132:135], v[168:171], v[84:87], v[132:135]
    v_mfma_f32_16x16x32_bf16 v[136:139], v[176:179], v[84:87], v[136:139]
    v_perm_b32 v92, v43, v39, s52
    v_perm_b32 v93, v51, v47, s52
    v_perm_b32 v94, v59, v55, s52
    v_perm_b32 v95, v67, v63, s52
    v_mfma_f32_16x16x32_bf16 v[140:143], v[168:171], v[88:91], v[140:143]
    v_mfma_f32_16x16x32_bf16 v[144:147], v[176:179], v[88:91], v[144:147]
    v_perm_b32 v96, v43, v39, s53
    v_perm_b32 v97, v51, v47, s53
    v_perm_b32 v98, v59, v55, s53
    v_perm_b32 v99, v67, v63, s53
    v_mfma_f32_16x16x32_bf16 v[148:151], v[168:171], v[92:95], v[148:151]
    v_mfma_f32_16x16x32_bf16 v[152:155], v[176:179], v[92:95], v[152:155]
    s_nop 1
    v_mfma_f32_16x16x32_bf16 v[156:159], v[168:171], v[96:99], v[156:159]
    v_mfma_f32_16x16x32_bf16 v[160:163], v[176:179], v[96:99], v[160:163]
    s_nop 7
    v_pk_mul_f32 v[8:9], v[112:113], v[184:185]
    v_pk_mul_f32 v[10:11], v[112:113], v[180:181]
    v_pk_fma_f32 v[112:113], v[108:109], v[184:185], v[10:11]
    v_pk_fma_f32 v[108:109], v[108:109], v[180:181], v[8:9] neg_lo:[0,0,1] neg_hi:[0,0,1]
    v_pk_mul_f32 v[4:5], v[120:121], v[192:193]
    v_pk_mul_f32 v[6:7], v[120:121], v[188:189]
    v_pk_fma_f32 v[120:121], v[116:117], v[192:193], v[6:7]
    v_pk_fma_f32 v[116:117], v[116:117], v[188:189], v[4:5] neg_lo:[0,0,1] neg_hi:[0,0,1]
    v_pk_mul_f32 v[8:9], v[128:129], v[200:201]
    v_pk_mul_f32 v[10:11], v[128:129], v[196:197]
    v_pk_fma_f32 v[128:129], v[124:125], v[200:201], v[10:11]
    v_pk_fma_f32 v[124:125], v[124:125], v[196:197], v[8:9] neg_lo:[0,0,1] neg_hi:[0,0,1]
    v_pk_mul_f32 v[4:5], v[136:137], v[208:209]
    v_pk_mul_f32 v[6:7], v[136:137], v[204:205]
    v_pk_fma_f32 v[136:137], v[132:133], v[208:209], v[6:7]
    v_pk_fma_f32 v[132:133], v[132:133], v[204:205], v[4:5] neg_lo:[0,0,1] neg_hi:[0,0,1]
    v_pk_mul_f32 v[8:9], v[144:145], v[216:217]
    v_pk_mul_f32 v[10:11], v[144:145], v[212:213]
    v_pk_fma_f32 v[144:145], v[140:141], v[216:217], v[10:11]
    v_pk_fma_f32 v[140:141], v[140:141], v[212:213], v[8:9] neg_lo:[0,0,1] neg_hi:[0,0,1]
    v_pk_mul_f32 v[4:5], v[152:153], v[224:225]
    v_pk_mul_f32 v[6:7], v[152:153], v[220:221]
    v_pk_fma_f32 v[152:153], v[148:149], v[224:225], v[6:7]
    v_pk_fma_f32 v[148:149], v[148:149], v[220:221], v[4:5] neg_lo:[0,0,1] neg_hi:[0,0,1]
    v_pk_mul_f32 v[8:9], v[160:161], v[232:233]
    v_pk_mul_f32 v[10:11], v[160:161], v[228:229]
    v_pk_fma_f32 v[160:161], v[156:157], v[232:233], v[10:11]
    v_pk_fma_f32 v[156:157], v[156:157], v[228:229], v[8:9] neg_lo:[0,0,1] neg_hi:[0,0,1]
    v_pk_add_f32 v[12:13], v[100:101], v[132:133]
    v_pk_add_f32 v[14:15], v[104:105], v[136:137]
    v_pk_add_f32 v[132:133], v[100:101], v[132:133] neg_lo:[0,1] neg_hi:[0,1]
    v_pk_add_f32 v[136:137], v[104:105], v[136:137] neg_lo:[0,1] neg_hi:[0,1]
    v_pk_add_f32 v[16:17], v[108:109], v[140:141]
    v_pk_add_f32 v[18:19], v[112:113], v[144:145]
    v_pk_add_f32 v[140:141], v[108:109], v[140:141] neg_lo:[0,1] neg_hi:[0,1]
    v_pk_add_f32 v[144:145], v[112:113], v[144:145] neg_lo:[0,1] neg_hi:[0,1]
    v_pk_add_f32 v[20:21], v[116:117], v[148:149]
    v_pk_add_f32 v[22:23], v[120:121], v[152:153]
    v_pk_add_f32 v[148:149], v[116:117], v[148:149] neg_lo:[0,1] neg_hi:[0,1]
    v_pk_add_f32 v[152:153], v[120:121], v[152:153] neg_lo:[0,1] neg_hi:[0,1]
    v_pk_add_f32 v[24:25], v[124:125], v[156:157]
    v_pk_add_f32 v[26:27], v[128:129], v[160:161]
    v_pk_add_f32 v[156:157], v[124:125], v[156:157] neg_lo:[0,1] neg_hi:[0,1]
    v_pk_add_f32 v[160:161], v[128:129], v[160:161] neg_lo:[0,1] neg_hi:[0,1]
    v_pk_add_f32 v[100:101], v[140:141], v[144:145]
    v_pk_add_f32 v[144:145], v[144:145], v[140:141] neg_lo:[0,1] neg_hi:[0,1]
    v_pk_mul_f32 v[100:101], v[100:101], s[54:55]
    v_pk_mul_f32 v[144:145], v[144:145], s[54:55]
    v_pk_add_f32 v[104:105], v[156:157], v[160:161]
    v_pk_add_f32 v[160:161], v[160:161], v[156:157] neg_lo:[0,1] neg_hi:[0,1]
    v_pk_mul_f32 v[104:105], v[104:105], s[54:55]
    v_pk_mul_f32 v[160:161], v[160:161], s[54:55]
    v_pk_add_f32 v[108:109], v[12:13], v[20:21]
    v_pk_add_f32 v[112:113], v[14:15], v[22:23]
    v_pk_add_f32 v[20:21], v[12:13], v[20:21] neg_lo:[0,1] neg_hi:[0,1]
    v_pk_add_f32 v[22:23], v[14:15], v[22:23] neg_lo:[0,1] neg_hi:[0,1]
    v_pk_add_f32 v[116:117], v[16:17], v[24:25]
    v_pk_add_f32 v[120:121], v[18:19], v[26:27]
    v_pk_add_f32 v[24:25], v[16:17], v[24:25] neg_lo:[0,1] neg_hi:[0,1]
    v_pk_add_f32 v[26:27], v[18:19], v[26:27] neg_lo:[0,1] neg_hi:[0,1]
    v_pk_add_f32 v[124:125], v[108:109], v[116:117]
    v_pk_add_f32 v[128:129], v[112:113], v[120:121]
    v_pk_add_f32 v[116:117], v[108:109], v[116:117] neg_lo:[0,1] neg_hi:[0,1]
    v_pk_add_f32 v[120:121], v[112:113], v[120:121] neg_lo:[0,1] neg_hi:[0,1]
    v_pk_add_f32 v[140:141], v[20:21], v[26:27]
    v_pk_add_f32 v[156:157], v[22:23], v[24:25] neg_lo:[0,1] neg_hi:[0,1]
    v_pk_add_f32 v[26:27], v[20:21], v[26:27] neg_lo:[0,1] neg_hi:[0,1]
    v_pk_add_f32 v[24:25], v[22:23], v[24:25]
    v_pk_add_f32 v[12:13], v[132:133], v[152:153]
    v_pk_add_f32 v[14:15], v[136:137], v[148:149] neg_lo:[0,1] neg_hi:[0,1]
    v_pk_add_f32 v[152:153], v[132:133], v[152:153] neg_lo:[0,1] neg_hi:[0,1]
    v_pk_add_f32 v[148:149], v[136:137], v[148:149]
    v_pk_add_f32 v[16:17], v[100:101], v[160:161]
    v_pk_add_f32 v[18:19], v[144:145], v[104:105] neg_lo:[0,1] neg_hi:[0,1]
    v_pk_add_f32 v[160:161], v[100:101], v[160:161] neg_lo:[0,1] neg_hi:[0,1]
    v_pk_add_f32 v[104:105], v[144:145], v[104:105]
    v_pk_add_f32 v[108:109], v[12:13], v[16:17]
    v_pk_add_f32 v[112:113], v[14:15], v[18:19]
    v_pk_add_f32 v[16:17], v[12:13], v[16:17] neg_lo:[0,1] neg_hi:[0,1]
    v_pk_add_f32 v[18:19], v[14:15], v[18:19] neg_lo:[0,1] neg_hi:[0,1]
    v_pk_add_f32 v[20:21], v[152:153], v[104:105]
    v_pk_add_f32 v[22:23], v[148:149], v[160:161] neg_lo:[0,1] neg_hi:[0,1]
    v_pk_add_f32 v[104:105], v[152:153], v[104:105] neg_lo:[0,1] neg_hi:[0,1]
    v_pk_add_f32 v[160:161], v[148:149], v[160:161]
    v_cvt_pk_bf16_f32 v36, v124, v128
    buffer_store_dword v36, v244, s[16:19], s40 offen sc1
    v_cvt_pk_bf16_f32 v44, v125, v129
    buffer_store_dword v44, v245, s[16:19], s40 offen sc1
    v_cvt_pk_bf16_f32 v37, v108, v112
    buffer_store_dword v37, v244, s[16:19], s41 offen sc1
    v_cvt_pk_bf16_f32 v45, v109, v113
    buffer_store_dword v45, v245, s[16:19], s41 offen sc1
    v_cvt_pk_bf16_f32 v38, v140, v156
    buffer_store_dword v38, v244, s[16:19], s42 offen sc1
    v_cvt_pk_bf16_f32 v46, v141, v157
    buffer_store_dword v46, v245, s[16:19], s42 offen sc1
    v_cvt_pk_bf16_f32 v39, v20, v22
    buffer_store_dword v39, v244, s[16:19], s43 offen sc1
    v_cvt_pk_bf16_f32 v47, v21, v23
    buffer_store_dword v47, v245, s[16:19], s43 offen sc1
    v_cvt_pk_bf16_f32 v40, v116, -v120
    buffer_store_dword v40, v248, s[16:19], s44 offen sc1
    v_cvt_pk_bf16_f32 v48, v117, -v121
    buffer_store_dword v48, v249, s[16:19], s44 offen sc1
    v_cvt_pk_bf16_f32 v41, v16, -v18
    buffer_store_dword v41, v248, s[16:19], s45 offen sc1
    v_cvt_pk_bf16_f32 v49, v17, -v19
    buffer_store_dword v49, v249, s[16:19], s45 offen sc1
    v_cvt_pk_bf16_f32 v42, v26, -v24
    buffer_store_dword v42, v248, s[16:19], s46 offen sc1
    v_cvt_pk_bf16_f32 v50, v27, -v25
    buffer_store_dword v50, v249, s[16:19], s46 offen sc1
    v_cvt_pk_bf16_f32 v43, v104, -v160
    buffer_store_dword v43, v248, s[16:19], s47 offen sc1
    v_cvt_pk_bf16_f32 v51, v105, -v161
    buffer_store_dword v51, v249, s[16:19], s47 offen sc1
    v_pk_mul_f32 v[8:9], v[114:115], v[186:187]
    v_pk_mul_f32 v[10:11], v[114:115], v[182:183]
    v_pk_fma_f32 v[114:115], v[110:111], v[186:187], v[10:11]
    v_pk_fma_f32 v[110:111], v[110:111], v[182:183], v[8:9] neg_lo:[0,0,1] neg_hi:[0,0,1]
    v_pk_mul_f32 v[4:5], v[122:123], v[194:195]
    v_pk_mul_f32 v[6:7], v[122:123], v[190:191]
    v_pk_fma_f32 v[122:123], v[118:119], v[194:195], v[6:7]
    v_pk_fma_f32 v[118:119], v[118:119], v[190:191], v[4:5] neg_lo:[0,0,1] neg_hi:[0,0,1]
    v_pk_mul_f32 v[8:9], v[130:131], v[202:203]
    v_pk_mul_f32 v[10:11], v[130:131], v[198:199]
    v_pk_fma_f32 v[130:131], v[126:127], v[202:203], v[10:11]
    v_pk_fma_f32 v[126:127], v[126:127], v[198:199], v[8:9] neg_lo:[0,0,1] neg_hi:[0,0,1]
    v_pk_mul_f32 v[4:5], v[138:139], v[210:211]
    v_pk_mul_f32 v[6:7], v[138:139], v[206:207]
    v_pk_fma_f32 v[138:139], v[134:135], v[210:211], v[6:7]
    v_pk_fma_f32 v[134:135], v[134:135], v[206:207], v[4:5] neg_lo:[0,0,1] neg_hi:[0,0,1]
    v_pk_mul_f32 v[8:9], v[146:147], v[218:219]
    v_pk_mul_f32 v[10:11], v[146:147], v[214:215]
    v_pk_fma_f32 v[146:147], v[142:143], v[218:219], v[10:11]
    v_pk_fma_f32 v[142:143], v[142:143], v[214:215], v[8:9] neg_lo:[0,0,1] neg_hi:[0,0,1]
    v_pk_mul_f32 v[4:5], v[154:155], v[226:227]
    v_pk_mul_f32 v[6:7], v[154:155], v[222:223]
    v_pk_fma_f32 v[154:155], v[150:151], v[226:227], v[6:7]
    v_pk_fma_f32 v[150:151], v[150:151], v[222:223], v[4:5] neg_lo:[0,0,1] neg_hi:[0,0,1]
    v_pk_mul_f32 v[8:9], v[162:163], v[234:235]
    v_pk_mul_f32 v[10:11], v[162:163], v[230:231]
    v_pk_fma_f32 v[162:163], v[158:159], v[234:235], v[10:11]
    v_pk_fma_f32 v[158:159], v[158:159], v[230:231], v[8:9] neg_lo:[0,0,1] neg_hi:[0,0,1]
    v_pk_add_f32 v[12:13], v[102:103], v[134:135]
    v_pk_add_f32 v[14:15], v[106:107], v[138:139]
    v_pk_add_f32 v[134:135], v[102:103], v[134:135] neg_lo:[0,1] neg_hi:[0,1]
    v_pk_add_f32 v[138:139], v[106:107], v[138:139] neg_lo:[0,1] neg_hi:[0,1]
    v_pk_add_f32 v[16:17], v[110:111], v[142:143]
    v_pk_add_f32 v[18:19], v[114:115], v[146:147]
    v_pk_add_f32 v[142:143], v[110:111], v[142:143] neg_lo:[0,1] neg_hi:[0,1]
    v_pk_add_f32 v[146:147], v[114:115], v[146:147] neg_lo:[0,1] neg_hi:[0,1]
    v_pk_add_f32 v[20:21], v[118:119], v[150:151]
    v_pk_add_f32 v[22:23], v[122:123], v[154:155]
    v_pk_add_f32 v[150:151], v[118:119], v[150:151] neg_lo:[0,1] neg_hi:[0,1]
    v_pk_add_f32 v[154:155], v[122:123], v[154:155] neg_lo:[0,1] neg_hi:[0,1]
    v_pk_add_f32 v[24:25], v[126:127], v[158:159]
    v_pk_add_f32 v[26:27], v[130:131], v[162:163]
    v_pk_add_f32 v[158:159], v[126:127], v[158:159] neg_lo:[0,1] neg_hi:[0,1]
    v_pk_add_f32 v[162:163], v[130:131], v[162:163] neg_lo:[0,1] neg_hi:[0,1]
    v_pk_add_f32 v[102:103], v[142:143], v[146:147]
    v_pk_add_f32 v[146:147], v[146:147], v[142:143] neg_lo:[0,1] neg_hi:[0,1]
    v_pk_mul_f32 v[102:103], v[102:103], s[54:55]
    v_pk_mul_f32 v[146:147], v[146:147], s[54:55]
    v_pk_add_f32 v[106:107], v[158:159], v[162:163]
    v_pk_add_f32 v[162:163], v[162:163], v[158:159] neg_lo:[0,1] neg_hi:[0,1]
    v_pk_mul_f32 v[106:107], v[106:107], s[54:55]
    v_pk_mul_f32 v[162:163], v[162:163], s[54:55]
    v_pk_add_f32 v[110:111], v[12:13], v[20:21]
    v_pk_add_f32 v[114:115], v[14:15], v[22:23]
    v_pk_add_f32 v[20:21], v[12:13], v[20:21] neg_lo:[0,1] neg_hi:[0,1]
    v_pk_add_f32 v[22:23], v[14:15], v[22:23] neg_lo:[0,1] neg_hi:[0,1]
    v_pk_add_f32 v[118:119], v[16:17], v[24:25]
    v_pk_add_f32 v[122:123], v[18:19], v[26:27]
    v_pk_add_f32 v[24:25], v[16:17], v[24:25] neg_lo:[0,1] neg_hi:[0,1]
    v_pk_add_f32 v[26:27], v[18:19], v[26:27] neg_lo:[0,1] neg_hi:[0,1]
    v_pk_add_f32 v[126:127], v[110:111], v[118:119]
    v_pk_add_f32 v[130:131], v[114:115], v[122:123]
    v_pk_add_f32 v[118:119], v[110:111], v[118:119] neg_lo:[0,1] neg_hi:[0,1]
    v_pk_add_f32 v[122:123], v[114:115], v[122:123] neg_lo:[0,1] neg_hi:[0,1]
    v_pk_add_f32 v[142:143], v[20:21], v[26:27]
    v_pk_add_f32 v[158:159], v[22:23], v[24:25] neg_lo:[0,1] neg_hi:[0,1]
    v_pk_add_f32 v[26:27], v[20:21], v[26:27] neg_lo:[0,1] neg_hi:[0,1]
    v_pk_add_f32 v[24:25], v[22:23], v[24:25]
    v_pk_add_f32 v[12:13], v[134:135], v[154:155]
    v_pk_add_f32 v[14:15], v[138:139], v[150:151] neg_lo:[0,1] neg_hi:[0,1]
    v_pk_add_f32 v[154:155], v[134:135], v[154:155] neg_lo:[0,1] neg_hi:[0,1]
    v_pk_add_f32 v[150:151], v[138:139], v[150:151]
    v_pk_add_f32 v[16:17], v[102:103], v[162:163]
    v_pk_add_f32 v[18:19], v[146:147], v[106:107] neg_lo:[0,1] neg_hi:[0,1]
    v_pk_add_f32 v[162:163], v[102:103], v[162:163] neg_lo:[0,1] neg_hi:[0,1]
    v_pk_add_f32 v[106:107], v[146:147], v[106:107]
    v_pk_add_f32 v[110:111], v[12:13], v[16:17]
    v_pk_add_f32 v[114:115], v[14:15], v[18:19]
    v_pk_add_f32 v[16:17], v[12:13], v[16:17] neg_lo:[0,1] neg_hi:[0,1]
    v_pk_add_f32 v[18:19], v[14:15], v[18:19] neg_lo:[0,1] neg_hi:[0,1]
    v_pk_add_f32 v[20:21], v[154:155], v[106:107]
    v_pk_add_f32 v[22:23], v[150:151], v[162:163] neg_lo:[0,1] neg_hi:[0,1]
    v_pk_add_f32 v[106:107], v[154:155], v[106:107] neg_lo:[0,1] neg_hi:[0,1]
    v_pk_add_f32 v[162:163], v[150:151], v[162:163]
    v_cvt_pk_bf16_f32 v52, v126, v130
    buffer_store_dword v52, v246, s[16:19], s40 offen sc1
    v_cvt_pk_bf16_f32 v60, v127, v131
    buffer_store_dword v60, v247, s[16:19], s40 offen sc1
    v_cvt_pk_bf16_f32 v53, v110, v114
    buffer_store_dword v53, v246, s[16:19], s41 offen sc1
    v_cvt_pk_bf16_f32 v61, v111, v115
    buffer_store_dword v61, v247, s[16:19], s41 offen sc1
    v_cvt_pk_bf16_f32 v54, v142, v158
    buffer_store_dword v54, v246, s[16:19], s42 offen sc1
    v_cvt_pk_bf16_f32 v62, v143, v159
    buffer_store_dword v62, v247, s[16:19], s42 offen sc1
    v_cvt_pk_bf16_f32 v55, v20, v22
    buffer_store_dword v55, v246, s[16:19], s43 offen sc1
    v_cvt_pk_bf16_f32 v63, v21, v23
    buffer_store_dword v63, v247, s[16:19], s43 offen sc1
    v_cvt_pk_bf16_f32 v56, v118, -v122
    buffer_store_dword v56, v250, s[16:19], s44 offen sc1
    v_cvt_pk_bf16_f32 v64, v119, -v123
    buffer_store_dword v64, v251, s[16:19], s44 offen sc1
    v_cvt_pk_bf16_f32 v57, v16, -v18
    buffer_store_dword v57, v250, s[16:19], s45 offen sc1
    v_cvt_pk_bf16_f32 v65, v17, -v19
    buffer_store_dword v65, v251, s[16:19], s45 offen sc1
    v_cvt_pk_bf16_f32 v58, v26, -v24
    buffer_store_dword v58, v250, s[16:19], s46 offen sc1
    v_cvt_pk_bf16_f32 v66, v27, -v25
    buffer_store_dword v66, v251, s[16:19], s46 offen sc1
    v_cvt_pk_bf16_f32 v59, v106, -v162
    buffer_store_dword v59, v250, s[16:19], s47 offen sc1
    v_cvt_pk_bf16_f32 v67, v107, -v163
    buffer_store_dword v67, v251, s[16:19], s47 offen sc1
    s_mov_b32 s50, 0
    s_mov_b32 s51, -1
    s_branch fk_c_p1
fk_t3:
    s_lshr_b32 s32, s31, 3
    s_and_b32 s36, s31, 7
    s_lshl_b32 s33, s32, 7
    s_lshl_b32 s34, s36, 2
    s_add_u32 s33, s33, s34
    s_add_u32 s33, s33, s28
    s_mul_i32 s38, s33, 900
    s_lshl_b32 s37, s28, 13
    s_add_u32 s37, s37, 65536
    v_lshlrev_b32 v2, 7, v0
    s_and_b32 s34, s30, 7
    s_lshl_b32 s34, s34, 13
    buffer_load_dword v3, v2, s[20:23], s34 offen
    s_waitcnt vmcnt(0)
    s_waitcnt lgkmcnt(0)
    s_mov_b32 s12, s72
    s_mov_b32 s13, s73
    s_mov_b32 s14, 921600
    s_mov_b32 s15, 0x20000
    s_mov_b32 s24, s74
    s_mov_b32 s25, s75
    s_mov_b32 s26, 921600
    s_mov_b32 s27, 0x20000
    v_mov_b32 v254, 16384000
    buffer_load_dword v255, v254, s[16:19], 0 offen
    s_add_u32 m0, s37, 0
    s_add_u32 s33, s38, 0
    buffer_load_dwordx4 v1, s[12:15], s33 offen lds
    s_add_u32 m0, s37, 4096
    s_add_u32 s33, s38, 0
    buffer_load_dwordx4 v1, s[24:27], s33 offen lds
    s_add_u32 m0, s37, 1024
    s_add_u32 s33, s38, 28800
    buffer_load_dwordx4 v1, s[12:15], s33 offen lds
    s_add_u32 m0, s37, 5120
    s_add_u32 s33, s38, 28800
    buffer_load_dwordx4 v1, s[24:27], s33 offen lds
    s_add_u32 m0, s37, 2048
    s_add_u32 s33, s38, 57600
    buffer_load_dwordx4 v1, s[12:15], s33 offen lds
    s_add_u32 m0, s37, 6144
    s_add_u32 s33, s38, 57600
    buffer_load_dwordx4 v1, s[24:27], s33 offen lds
    s_add_u32 m0, s37, 3072
    s_add_u32 s33, s38, 86400
    buffer_load_dwordx4 v1, s[12:15], s33 offen lds
    s_add_u32 m0, s37, 7168
    s_add_u32 s33, s38, 86400
    buffer_load_dwordx4 v1, s[24:27], s33 offen lds
    v_and_b32 v2, 1, v0
    v_lshrrev_b32 v3, 1, v0
    v_mul_u32_u24 v4, 450, v2
    v_lshl_add_u32 v4, v3, 1, v4
    v_add_u32 v4, s37, v4
    v_lshrrev_b32 v5, 3, v0
    v_mul_u32_u24 v5, 32896, v5
    v_and_b32 v2, 7, v0
    v_lshl_add_u32 v5, v2, 4, v5
    s_lshl_b32 s33, s32, 12
    s_lshl_b32 s34, s36, 9
    s_add_u32 s33, s33, s34
    s_lshl_b32 s34, s28, 7
    s_add_u32 s33, s33, s34
    s_add_u32 s33, s33, 8912896
    s_waitcnt vmcnt(0)
    ds_read_u16 v160, v4 offset:0
    ds_read_u16 v192, v4 offset:4096
    ds_read_u16 v161, v4 offset:1024
    ds_read_u16 v193, v4 offset:5120
    ds_read_u16 v162, v4 offset:2048
    ds_read_u16 v194, v4 offset:6144
    ds_read_u16 v163, v4 offset:3072
    ds_read_u16 v195, v4 offset:7168
    ds_read_u16 v164, v4 offset:64
    ds_read_u16 v196, v4 offset:4160
    ds_read_u16 v165, v4 offset:1088
    ds_read_u16 v197, v4 offset:5184
    ds_read_u16 v166, v4 offset:2112
    ds_read_u16 v198, v4 offset:6208
    ds_read_u16 v167, v4 offset:3136
    ds_read_u16 v199, v4 offset:7232
    s_waitcnt lgkmcnt(8)
    v_lshl_or_b32 v160, v192, 16, v160
    v_lshl_or_b32 v161, v193, 16, v161
    v_lshl_or_b32 v162, v194, 16, v162
    v_lshl_or_b32 v163, v195, 16, v163
    buffer_store_dwordx4 v[160:163], v5, s[16:19], s33 offen sc1
    s_add_u32 s33, s33, 263168
    ds_read_u16 v168, v4 offset:128
    ds_read_u16 v192, v4 offset:4224
    ds_read_u16 v169, v4 offset:1152
    ds_read_u16 v193, v4 offset:5248
    ds_read_u16 v170, v4 offset:2176
    ds_read_u16 v194, v4 offset:6272
    ds_read_u16 v171, v4 offset:3200
    ds_read_u16 v195, v4 offset:7296
    s_waitcnt lgkmcnt(8)
    v_lshl_or_b32 v164, v196, 16, v164
    v_lshl_or_b32 v165, v197, 16, v165
    v_lshl_or_b32 v166, v198, 16, v166
    v_lshl_or_b32 v167, v199, 16, v167
    buffer_store_dwordx4 v[164:167], v5, s[16:19], s33 offen sc1
    s_add_u32 s33, s33, 263168
    ds_read_u16 v172, v4 offset:192
    ds_read_u16 v196, v4 offset:4288
    ds_read_u16 v173, v4 offset:1216
    ds_read_u16 v197, v4 offset:5312
    ds_read_u16 v174, v4 offset:2240
    ds_read_u16 v198, v4 offset:6336
    ds_read_u16 v175, v4 offset:3264
    ds_read_u16 v199, v4 offset:7360
    s_waitcnt lgkmcnt(8)
    v_lshl_or_b32 v168, v192, 16, v168
    v_lshl_or_b32 v169, v193, 16, v169
    v_lshl_or_b32 v170, v194, 16, v170
    v_lshl_or_b32 v171, v195, 16, v171
    buffer_store_dwordx4 v[168:171], v5, s[16:19], s33 offen sc1
    s_add_u32 s33, s33, 263168
    ds_read_u16 v176, v4 offset:256
    ds_read_u16 v192, v4 offset:4352
    ds_read_u16 v177, v4 offset:1280
    ds_read_u16 v193, v4 offset:5376
    ds_read_u16 v178, v4 offset:2304
    ds_read_u16 v194, v4 offset:6400
    ds_read_u16 v179, v4 offset:3328
    ds_read_u16 v195, v4 offset:7424
    s_waitcnt lgkmcnt(8)
    v_lshl_or_b32 v172, v196, 16, v172
    v_lshl_or_b32 v173, v197, 16, v173
    v_lshl_or_b32 v174, v198, 16, v174
    v_lshl_or_b32 v175, v199, 16, v175
    buffer_store_dwordx4 v[172:175], v5, s[16:19], s33 offen sc1
    s_add_u32 s33, s33, 263168
    ds_read_u16 v180, v4 offset:320
    ds_read_u16 v196, v4 offset:4416
    ds_read_u16 v181, v4 offset:1344
    ds_read_u16 v197, v4 offset:5440
    ds_read_u16 v182, v4 offset:2368
    ds_read_u16 v198, v4 offset:6464
    ds_read_u16 v183, v4 offset:3392
    ds_read_u16 v199, v4 offset:7488
    s_waitcnt lgkmcnt(8)
    v_lshl_or_b32 v176, v192, 16, v176
    v_lshl_or_b32 v177, v193, 16, v177
    v_lshl_or_b32 v178, v194, 16, v178
    v_lshl_or_b32 v179, v195, 16, v179
    buffer_store_dwordx4 v[176:179], v5, s[16:19], s33 offen sc1
    s_add_u32 s33, s33, 263168
    ds_read_u16 v184, v4 offset:384
    ds_read_u16 v192, v4 offset:4480
    ds_read_u16 v185, v4 offset:1408
    ds_read_u16 v193, v4 offset:5504
    ds_read_u16 v186, v4 offset:2432
    ds_read_u16 v194, v4 offset:6528
    ds_read_u16 v187, v4 offset:3456
    ds_read_u16 v195, v4 offset:7552
    s_waitcnt lgkmcnt(8)
    v_lshl_or_b32 v180, v196, 16, v180
    v_lshl_or_b32 v181, v197, 16, v181
    v_lshl_or_b32 v182, v198, 16, v182
    v_lshl_or_b32 v183, v199, 16, v183
    buffer_store_dwordx4 v[180:183], v5, s[16:19], s33 offen sc1
    s_add_u32 s33, s33, 263168
    ds_read_u16 v188, v4 offset:448
    ds_read_u16 v196, v4 offset:4544
    ds_read_u16 v189, v4 offset:1472
    ds_read_u16 v197, v4 offset:5568
    ds_read_u16 v190, v4 offset:2496
    ds_read_u16 v198, v4 offset:6592
    ds_read_u16 v191, v4 offset:3520
    ds_read_u16 v199, v4 offset:7616
    s_waitcnt lgkmcnt(8)
    v_lshl_or_b32 v184, v192, 16, v184
    v_lshl_or_b32 v185, v193, 16, v185
    v_lshl_or_b32 v186, v194, 16, v186
    v_lshl_or_b32 v187, v195, 16, v187
    buffer_store_dwordx4 v[184:187], v5, s[16:19], s33 offen sc1
    s_add_u32 s33, s33, 263168
    s_waitcnt lgkmcnt(0)
    v_lshl_or_b32 v188, v196, 16, v188
    v_lshl_or_b32 v189, v197, 16, v189
    v_lshl_or_b32 v190, v198, 16, v190
    v_lshl_or_b32 v191, v199, 16, v191
    buffer_store_dwordx4 v[188:191], v5, s[16:19], s33 offen sc1
    s_add_u32 s33, s33, 263168
    s_mov_b32 s39, 1
fk_h_p1:
    s_getpc_b64 s[20:21]
    s_add_u32 s20, s20, ctab@rel32@lo+4
    s_addc_u32 s21, s21, ctab@rel32@hi+12
    s_mov_b32 s22, 75776
    s_mov_b32 s23, 0x20000
    s_lshr_b32 s31, s30, 4
    s_lshl_b32 s33, s29, 1
    s_add_u32 s31, s31, s33
    s_mul_i32 s36, s31, 131072
    s_lshl_b32 s33, s28, 12
    s_add_u32 s36, s36, s33
    s_add_u32 s36, s36, 2097152
    s_lshl_b32 s37, s28, 13
    s_lshl_b32 s32, s29, 5
    s_add_u32 s32, s32, s30
    v_and_b32 v150, 15, v0
    v_lshrrev_b32 v151, 4, v0
    v_lshlrev_b32 v152, 12, v151
    v_lshrrev_b32 v144, 1, v150
    v_lshl_add_u32 v152, v144, 7, v152
    v_and_b32 v144, 1, v0
    v_lshl_add_u32 v152, v144, 4, v152
    v_mul_u32_u24 v153, 1088, v151
    v_lshl_add_u32 v153, v150, 2, v153
    s_lshl_b32 s33, s28, 6
    s_add_u32 s33, s33, 131072
    v_add_u32 v153, s33, v153
    v_mul_u32_u24 v154, 272, v150
    v_lshl_add_u32 v154, v151, 4, v154
    v_add_u32 v154, 131072, v154
    v_mul_u32_u24 v155, 144, v150
    v_lshl_add_u32 v155, v151, 4, v155
    s_mul_i32 s33, s28, 2304
    s_add_u32 s33, s33, 140544
    v_add_u32 v155, s33, v155
    v_lshrrev_b32 v144, 3, v0
    v_mul_u32_u24 v158, 144, v144
    v_and_b32 v144, 7, v0
    v_lshl_add_u32 v158, v144, 4, v158
    v_add_u32 v158, s33, v158
    s_mul_i32 s42, s32, 8320
    s_lshl_b32 s34, s28, 11
    s_add_u32 s42, s42, s34
    s_add_u32 s42, s42, 13631488
    s_cmp_lt_u32 s32, 225
    s_cselect_b32 s42, s42, 0x7f000000
    s_mul_i32 s33, s30, 37
    s_lshr_b32 s33, s33, 8
    s_mul_i32 s34, s33, 7
    s_sub_u32 s45, s30, s34
    v_bfe_u32 v144, v0, 2, 1
    v_lshl_add_u32 v144, v151, 1, v144
    v_mul_u32_u24 v156, 896, v144
    v_lshrrev_b32 v144, 3, v0
    v_xor_b32 v144, v144, v151
    v_and_b32 v144, 1, v144
    v_lshl_add_u32 v156, v144, 6, v156
    v_and_b32 v144, 3, v0
    v_lshl_add_u32 v156, v144, 4, v156
    s_mul_i32 s46, s28, 7168
    s_lshl_b32 s33, s45, 7
    s_add_u32 s46, s46, s33
    v_cmp_lt_u32 vcc, 6, v0
    s_and_b32 s33, s30, 15
    s_and_b32 s34, s33, 1
    s_mul_i32 s34, s34, 14
    v_add_u32 v157, s34, v0
    s_lshr_b32 s33, s33, 1
    v_lshl_add_u32 v157, v157, 3, s33
    v_lshlrev_b32 v157, 7, v157
    s_waitcnt lgkmcnt(0)
    s_mov_b32 s24, s78
    s_mov_b32 s25, s79
    s_mov_b32 s26, 256
    s_mov_b32 s27, 0x20000
    s_mov_b32 s8, s68
    s_mov_b32 s9, s69
    s_mov_b32 s11, 0x20000
    s_cmp_lt_u32 s30, 28
    s_cselect_b32 s10, 401408, 0
    s_mov_b32 s12, s76
    s_mov_b32 s13, s77
    s_mov_b32 s14, 3670016
    s_mov_b32 s15, 0x20000
    v_mov_b32 v5, 0
    v_lshlrev_b32 v6, 2, v0
    v_readfirstlane_b32 s49, v255
    s_nop 3
    s_add_u32 s49, s49, 1
    s_waitcnt vmcnt(0)
    s_barrier
    s_cmp_lg_u32 s28, 0
    s_cbranch_scc1 fk_nl1
    v_mov_b32 v7, s49
    s_cmp_lg_u32 s39, 0
    s_cbranch_scc1 fk_sigB
    buffer_store_dword v7, v2, s[16:19], s38 offen sc1
    s_branch fk_sigD
fk_sigB:
    s_lshr_b32 s34, s2, 4
    s_mul_i32 s33, s34, 2176
    s_and_b32 s34, s2, 15
    s_lshl_b32 s34, s34, 2
    s_add_u32 s33, s33, s34
    s_add_u32 s33, s33, 16351232
    v_mov_b32 v7, s49
    s_mov_b64 exec, 1
    buffer_store_dword v7, v5, s[16:19], s33 offen sc1
    s_mov_b64 exec, -1
fk_sigD:
fk_nl1:
    s_cmp_eq_u32 s39, 0
    s_cbranch_scc1 fk_tdB
    s_lshr_b32 s34, s2, 4
    s_and_b32 s35, s2, 15
    s_cmp_lg_u32 s34, s35
    s_cbranch_scc1 fk_tdB
    s_lshl_b32 s33, s2, 7
    s_add_u32 s33, s33, 16351232
    s_mov_b64 exec, 0xffff
    s_mov_b32 s56, 0
fk_poll1:
    buffer_load_dword v7, v6, s[16:19], s33 offen sc1
    s_waitcnt vmcnt(0)
    v_cmp_ne_u32 vcc, s49, v7
    s_add_u32 s56, s56, 1
    s_cmp_gt_u32 s56, 100000
    s_cbranch_scc1 fk_poll1_x
    s_cbranch_vccnz fk_poll1
fk_poll1_x:
    s_mov_b64 exec, -1
    s_lshl_b32 s34, s34, 2
    s_lshl_b32 s35, s28, 14
    v_lshlrev_b32 v3, 8, v0
    v_mov_b32 v7, s49
    s_add_u32 s33, s34, 16253060
    s_add_u32 s33, s33, s35
    buffer_store_dword v7, v3, s[16:19], s33 offen sc1
fk_tdB:
    s_cmp_lg_u32 s28, 0
    s_cbranch_scc1 fk_nl2
    s_lshl_b32 s33, s2, 8
    s_add_u32 s33, s33, 16252928
    s_mov_b32 s40, -1
    s_mov_b32 s41, 1
    s_mov_b64 exec, s[40:41]
    s_mov_b32 s56, 0
fk_poll2:
    buffer_load_dword v7, v6, s[16:19], s33 offen sc1
    s_waitcnt vmcnt(0)
    v_cmp_ne_u32 vcc, s49, v7
    s_add_u32 s56, s56, 1
    s_cmp_gt_u32 s56, 100000
    s_cbranch_scc1 fk_poll2_x
    s_cbranch_vccnz fk_poll2
fk_poll2_x:
    s_mov_b64 exec, -1
fk_nl2:
    s_barrier
    s_add_u32 m0, s37, 0
    s_add_u32 s33, s36, 0
    buffer_load_dwordx4 v1, s[16:19], s33 offen sc1 lds
    buffer_load_dwordx4 v1, s[16:19], s33 offen offset:1024 sc1 lds
    s_add_u32 m0, s37, 2048
    s_add_u32 s33, s36, 2097152
    buffer_load_dwordx4 v1, s[16:19], s33 offen sc1 lds
    buffer_load_dwordx4 v1, s[16:19], s33 offen offset:1024 sc1 lds
    s_add_u32 m0, s37, 4096
    s_add_u32 s33, s36, 2048
    buffer_load_dwordx4 v1, s[16:19], s33 offen sc1 lds
    buffer_load_dwordx4 v1, s[16:19], s33 offen offset:1024 sc1 lds
    s_add_u32 m0, s37, 6144
    s_add_u32 s33, s36, 2099200
    buffer_load_dwordx4 v1, s[16:19], s33 offen sc1 lds
    buffer_load_dwordx4 v1, s[16:19], s33 offen offset:1024 sc1 lds
    s_add_u32 m0, s37, 32768
    s_add_u32 s33, s36, 16384
    buffer_load_dwordx4 v1, s[16:19], s33 offen sc1 lds
    buffer_load_dwordx4 v1, s[16:19], s33 offen offset:1024 sc1 lds
    s_add_u32 m0, s37, 34816
    s_add_u32 s33, s36, 2113536
    buffer_load_dwordx4 v1, s[16:19], s33 offen sc1 lds
    buffer_load_dwordx4 v1, s[16:19], s33 offen offset:1024 sc1 lds
    s_add_u32 m0, s37, 36864
    s_add_u32 s33, s36, 18432
    buffer_load_dwordx4 v1, s[16:19], s33 offen sc1 lds
    buffer_load_dwordx4 v1, s[16:19], s33 offen offset:1024 sc1 lds
    s_add_u32 m0, s37, 38912
    s_add_u32 s33, s36, 2115584
    buffer_load_dwordx4 v1, s[16:19], s33 offen sc1 lds
    buffer_load_dwordx4 v1, s[16:19], s33 offen offset:1024 sc1 lds
    s_setprio 2
    s_waitcnt vmcnt(8)
    s_barrier
    s_cmp_lg_u32 s28, 0
    s_cbranch_scc1 fk_nl3
    s_lshl_b32 s33, s2, 8
    s_add_u32 s33, s33, 16253060
    s_mov_b64 exec, 0xf
    s_mov_b32 s56, 0
fk_poll3:
    buffer_load_dword v7, v6, s[16:19], s33 offen sc1
    s_waitcnt vmcnt(0)
    v_cmp_ne_u32 vcc, s49, v7
    s_add_u32 s56, s56, 1
    s_cmp_gt_u32 s56, 100000
    s_cbranch_scc1 fk_poll3_x
    s_cbranch_vccnz fk_poll3
fk_poll3_x:
    s_mov_b64 exec, -1
fk_nl3:
    s_add_u32 m0, s37, 65536
    s_add_u32 s33, s36, 32768
    buffer_load_dwordx4 v1, s[16:19], s33 offen sc1 lds
    buffer_load_dwordx4 v1, s[16:19], s33 offen offset:1024 sc1 lds
    s_add_u32 m0, s37, 67584
    s_add_u32 s33, s36, 2129920
    buffer_load_dwordx4 v1, s[16:19], s33 offen sc1 lds
    buffer_load_dwordx4 v1, s[16:19], s33 offen offset:1024 sc1 lds
    s_add_u32 m0, s37, 69632
    s_add_u32 s33, s36, 34816
    buffer_load_dwordx4 v1, s[16:19], s33 offen sc1 lds
    buffer_load_dwordx4 v1, s[16:19], s33 offen offset:1024 sc1 lds
    s_add_u32 m0, s37, 71680
    s_add_u32 s33, s36, 2131968
    buffer_load_dwordx4 v1, s[16:19], s33 offen sc1 lds
    buffer_load_dwordx4 v1, s[16:19], s33 offen offset:1024 sc1 lds
    s_lshl_b32 s40, s28, 13
    s_add_u32 s41, s40, 4096
    buffer_load_dwordx4 v[40:43], v1, s[20:23], s40 offen offset:0
    buffer_load_dwordx4 v[56:59], v1, s[20:23], s41 offen offset:0
    buffer_load_dwordx4 v[44:47], v1, s[20:23], s40 offen offset:1024
    buffer_load_dwordx4 v[60:63], v1, s[20:23], s41 offen offset:1024
    buffer_load_dwordx4 v[48:51], v1, s[20:23], s40 offen offset:2048
    buffer_load_dwordx4 v[64:67], v1, s[20:23], s41 offen offset:2048
    buffer_load_dwordx4 v[52:55], v1, s[20:23], s40 offen offset:3072
    buffer_load_dwordx4 v[68:71], v1, s[20:23], s41 offen offset:3072
    s_waitcnt vmcnt(16)
    s_barrier
    s_add_u32 m0, s37, 98304
    s_add_u32 s33, s36, 49152
    buffer_load_dwordx4 v1, s[16:19], s33 offen sc1 lds
    buffer_load_dwordx4 v1, s[16:19], s33 offen offset:1024 sc1 lds
    s_add_u32 m0, s37, 100352
    s_add_u32 s33, s36, 2146304
    buffer_load_dwordx4 v1, s[16:19], s33 offen sc1 lds
    buffer_load_dwordx4 v1, s[16:19], s33 offen offset:1024 sc1 lds
    s_add_u32 m0, s37, 102400
    s_add_u32 s33, s36, 51200
    buffer_load_dwordx4 v1, s[16:19], s33 offen sc1 lds
    buffer_load_dwordx4 v1, s[16:19], s33 offen offset:1024 sc1 lds
    s_add_u32 m0, s37, 104448
    s_add_u32 s33, s36, 2148352
    buffer_load_dwordx4 v1, s[16:19], s33 offen sc1 lds
    buffer_load_dwordx4 v1, s[16:19], s33 offen offset:1024 sc1 lds
    s_mul_i32 s35, s32, 8320
    s_add_u32 s40, s35, 6291456
    s_add_u32 s41, s40, 4096
    buffer_load_dwordx4 v[8:11], v1, s[16:19], s40 offen offset:0 sc1
    buffer_load_dwordx4 v[24:27], v1, s[16:19], s41 offen offset:0 sc1
    buffer_load_dwordx4 v[12:15], v1, s[16:19], s40 offen offset:1024 sc1
    buffer_load_dwordx4 v[28:31], v1, s[16:19], s41 offen offset:1024 sc1
    buffer_load_dwordx4 v[16:19], v1, s[16:19], s40 offen offset:2048 sc1
    buffer_load_dwordx4 v[32:35], v1, s[16:19], s41 offen offset:2048 sc1
    buffer_load_dwordx4 v[20:23], v1, s[16:19], s40 offen offset:3072 sc1
    buffer_load_dwordx4 v[36:39], v1, s[16:19], s41 offen offset:3072 sc1
    s_lshl_b32 s40, s28, 12
    s_add_u32 s40, s40, 38912
    buffer_load_dwordx4 v[96:99], v1, s[20:23], s40 offen offset:0
    buffer_load_dwordx4 v[100:103], v1, s[20:23], s40 offen offset:1024
    buffer_load_dwordx4 v[104:107], v1, s[20:23], s40 offen offset:2048
    buffer_load_dwordx4 v[108:111], v1, s[20:23], s40 offen offset:3072
    s_waitcnt vmcnt(28)
    s_barrier
    s_mov_b32 s40, 32768
    s_mov_b32 s41, 35840
    buffer_load_dwordx4 v[72:75], v1, s[20:23], s40 offen offset:0
    buffer_load_dwordx4 v[84:87], v1, s[20:23], s41 offen offset:0
    buffer_load_dwordx4 v[76:79], v1, s[20:23], s40 offen offset:1024
    buffer_load_dwordx4 v[88:91], v1, s[20:23], s41 offen offset:1024
    buffer_load_dwordx4 v[80:83], v1, s[20:23], s40 offen offset:2048
    buffer_load_dwordx4 v[92:95], v1, s[20:23], s41 offen offset:2048
    s_lshr_b32 s35, s32, 2
    s_mul_i32 s35, s35, 32896
    s_lshl_b32 s40, s28, 10
    s_add_u32 s40, s40, s35
    s_and_b32 s35, s32, 3
    s_lshl_b32 s35, s35, 5
    s_add_u32 s40, s40, s35
    s_add_u32 s40, s40, 8912896
    s_add_u32 s41, s40, 16384
    buffer_load_dwordx4 v[112:115], v152, s[16:19], s40 offen sc1
    buffer_load_dwordx4 v[116:119], v152, s[16:19], s41 offen sc1
    s_waitcnt vmcnt(8)
    s_cmp_ge_u32 s32, 225
    s_cbranch_scc1 fk_sk1
    v_mfma_f32_16x16x32_bf16 v[120:123], v[8:11], v[40:43], 0
    v_mfma_f32_16x16x32_bf16 v[124:127], v[8:11], v[56:59], 0
    v_mfma_f32_16x16x32_bf16 v[128:131], v[24:27], v[40:43], 0
    v_mfma_f32_16x16x32_bf16 v[132:135], v[24:27], v[56:59], 0
    v_mfma_f32_16x16x32_bf16 v[120:123], v[12:15], v[44:47], v[120:123]
    v_mfma_f32_16x16x32_bf16 v[124:127], v[12:15], v[60:63], v[124:127]
    v_mfma_f32_16x16x32_bf16 v[128:131], v[28:31], v[44:47], v[128:131]
    v_mfma_f32_16x16x32_bf16 v[132:135], v[28:31], v[60:63], v[132:135]
    v_mfma_f32_16x16x32_bf16 v[120:123], v[16:19], v[48:51], v[120:123]
    v_mfma_f32_16x16x32_bf16 v[124:127], v[16:19], v[64:67], v[124:127]
    v_mfma_f32_16x16x32_bf16 v[128:131], v[32:35], v[48:51], v[128:131]
    v_mfma_f32_16x16x32_bf16 v[132:135], v[32:35], v[64:67], v[132:135]
    v_mfma_f32_16x16x32_bf16 v[120:123], v[20:23], v[52:55], v[120:123]
    v_mfma_f32_16x16x32_bf16 v[124:127], v[20:23], v[68:71], v[124:127]
    v_mfma_f32_16x16x32_bf16 v[128:131], v[36:39], v[52:55], v[128:131]
    v_mfma_f32_16x16x32_bf16 v[132:135], v[36:39], v[68:71], v[132:135]
    s_nop 7
fk_sk1:
    s_add_u32 m0, s37, 0
    s_add_u32 s33, s36, 65536
    buffer_load_dwordx4 v1, s[16:19], s33 offen sc1 lds
    buffer_load_dwordx4 v1, s[16:19], s33 offen offset:1024 sc1 lds
    s_add_u32 m0, s37, 2048
    s_add_u32 s33, s36, 2162688
    buffer_load_dwordx4 v1, s[16:19], s33 offen sc1 lds
    buffer_load_dwordx4 v1, s[16:19], s33 offen offset:1024 sc1 lds
    s_add_u32 m0, s37, 4096
    s_add_u32 s33, s36, 67584
    buffer_load_dwordx4 v1, s[16:19], s33 offen sc1 lds
    buffer_load_dwordx4 v1, s[16:19], s33 offen offset:1024 sc1 lds
    s_add_u32 m0, s37, 6144
    s_add_u32 s33, s36, 2164736
    buffer_load_dwordx4 v1, s[16:19], s33 offen sc1 lds
    buffer_load_dwordx4 v1, s[16:19], s33 offen offset:1024 sc1 lds
    s_cmp_ge_u32 s32, 225
    s_cbranch_scc1 fk_sk2
    v_mul_f32 v144, v124, v97
    v_mul_f32 v145, v124, v96
    v_fma_f32 v124, v120, v97, v145
    v_fma_f32 v120, v120, v96, -v144
    v_mul_f32 v146, v125, v99
    v_mul_f32 v147, v125, v98
    v_fma_f32 v125, v121, v99, v147
    v_fma_f32 v121, v121, v98, -v146
    v_mul_f32 v144, v126, v101
    v_mul_f32 v145, v126, v100
    v_fma_f32 v126, v122, v101, v145
    v_fma_f32 v122, v122, v100, -v144
    v_mul_f32 v146, v127, v103
    v_mul_f32 v147, v127, v102
    v_fma_f32 v127, v123, v103, v147
    v_fma_f32 v123, v123, v102, -v146
    v_mul_f32 v144, v132, v105
    v_mul_f32 v145, v132, v104
    v_fma_f32 v132, v128, v105, v145
    v_fma_f32 v128, v128, v104, -v144
    v_mul_f32 v146, v133, v107
    v_mul_f32 v147, v133, v106
    v_fma_f32 v133, v129, v107, v147
    v_fma_f32 v129, v129, v106, -v146
    v_mul_f32 v144, v134, v109
    v_mul_f32 v145, v134, v108
    v_fma_f32 v134, v130, v109, v145
    v_fma_f32 v130, v130, v108, -v144
    v_mul_f32 v146, v135, v111
    v_mul_f32 v147, v135, v110
    v_fma_f32 v135, v131, v111, v147
    v_fma_f32 v131, v131, v110, -v146
    v_cvt_pk_bf16_f32 v136, v120, v121
    v_cvt_pk_bf16_f32 v137, v122, v123
    v_cvt_pk_bf16_f32 v138, v128, v129
    v_cvt_pk_bf16_f32 v139, v130, v131
    v_cvt_pk_bf16_f32 v140, v124, v125
    v_cvt_pk_bf16_f32 v141, v126, v127
    v_cvt_pk_bf16_f32 v142, v132, v133
    v_cvt_pk_bf16_f32 v143, v134, v135
    s_nop 1
fk_sk2:
    s_barrier
    s_waitcnt vmcnt(8)
    s_cmp_ge_u32 s32, 225
    s_cbranch_scc1 fk_sk3
    v_mfma_f32_16x16x32_bf16 v[120:123], v[72:75], v[136:139], 0
    v_mfma_f32_16x16x32_bf16 v[124:127], v[80:83], v[136:139], 0
    v_mfma_f32_16x16x32_bf16 v[128:131], v[84:87], v[136:139], 0
    v_mfma_f32_16x16x32_bf16 v[132:135], v[92:95], v[136:139], 0
    v_mfma_f32_16x16x32_bf16 v[120:123], v[76:79], v[140:143], v[120:123]
    v_mfma_f32_16x16x32_bf16 v[124:127], v[72:75], v[140:143], v[124:127]
    v_mfma_f32_16x16x32_bf16 v[128:131], v[88:91], v[140:143], v[128:131]
    v_mfma_f32_16x16x32_bf16 v[132:135], v[84:87], v[140:143], v[132:135]
    s_nop 7
    v_lshlrev_b32 v148, 16, v112
    v_and_b32 v149, 0xffff0000, v112
    v_mul_f32 v144, v124, v149
    v_mul_f32 v145, v124, v148
    v_fma_f32 v124, -v120, v149, -v145
    v_fma_f32 v120, v120, v148, -v144
    v_lshlrev_b32 v148, 16, v113
    v_and_b32 v149, 0xffff0000, v113
    v_mul_f32 v146, v125, v149
    v_mul_f32 v147, v125, v148
    v_fma_f32 v125, -v121, v149, -v147
    v_fma_f32 v121, v121, v148, -v146
    v_lshlrev_b32 v148, 16, v114
    v_and_b32 v149, 0xffff0000, v114
    v_mul_f32 v144, v126, v149
    v_mul_f32 v145, v126, v148
    v_fma_f32 v126, -v122, v149, -v145
    v_fma_f32 v122, v122, v148, -v144
    v_lshlrev_b32 v148, 16, v115
    v_and_b32 v149, 0xffff0000, v115
    v_mul_f32 v146, v127, v149
    v_mul_f32 v147, v127, v148
    v_fma_f32 v127, -v123, v149, -v147
    v_fma_f32 v123, v123, v148, -v146
    v_lshlrev_b32 v148, 16, v116
    v_and_b32 v149, 0xffff0000, v116
    v_mul_f32 v144, v132, v149
    v_mul_f32 v145, v132, v148
    v_fma_f32 v132, -v128, v149, -v145
    v_fma_f32 v128, v128, v148, -v144
    v_lshlrev_b32 v148, 16, v117
    v_and_b32 v149, 0xffff0000, v117
    v_mul_f32 v146, v133, v149
    v_mul_f32 v147, v133, v148
    v_fma_f32 v133, -v129, v149, -v147
    v_fma_f32 v129, v129, v148, -v146
    v_lshlrev_b32 v148, 16, v118
    v_and_b32 v149, 0xffff0000, v118
    v_mul_f32 v144, v134, v149
    v_mul_f32 v145, v134, v148
    v_fma_f32 v134, -v130, v149, -v145
    v_fma_f32 v130, v130, v148, -v144
    v_lshlrev_b32 v148, 16, v119
    v_and_b32 v149, 0xffff0000, v119
    v_mul_f32 v146, v135, v149
    v_mul_f32 v147, v135, v148
    v_fma_f32 v135, -v131, v149, -v147
    v_fma_f32 v131, v131, v148, -v146
    v_cvt_pk_bf16_f32 v136, v120, v121
    v_cvt_pk_bf16_f32 v137, v122, v123
    v_cvt_pk_bf16_f32 v138, v128, v129
    v_cvt_pk_bf16_f32 v139, v130, v131
    v_cvt_pk_bf16_f32 v140, v124, v125
    v_cvt_pk_bf16_f32 v141, v126, v127
    v_cvt_pk_bf16_f32 v142, v132, v133
    v_cvt_pk_bf16_f32 v143, v134, v135
    s_nop 1
    v_mfma_f32_16x16x32_bf16 v[120:123], v[72:75], v[136:139], 0
    v_mfma_f32_16x16x32_bf16 v[124:127], v[80:83], v[136:139], 0
    v_mfma_f32_16x16x32_bf16 v[128:131], v[84:87], v[136:139], 0
    v_mfma_f32_16x16x32_bf16 v[132:135], v[92:95], v[136:139], 0
    v_mfma_f32_16x16x32_bf16 v[120:123], v[76:79], v[140:143], v[120:123]
    v_mfma_f32_16x16x32_bf16 v[124:127], v[72:75], v[140:143], v[124:127]
    v_mfma_f32_16x16x32_bf16 v[128:131], v[88:91], v[140:143], v[128:131]
    v_mfma_f32_16x16x32_bf16 v[132:135], v[84:87], v[140:143], v[132:135]
    s_nop 7
fk_sk3:
    s_add_u32 m0, s37, 32768
    s_add_u32 s33, s36, 81920
    buffer_load_dwordx4 v1, s[16:19], s33 offen sc1 lds
    buffer_load_dwordx4 v1, s[16:19], s33 offen offset:1024 sc1 lds
    s_add_u32 m0, s37, 34816
    s_add_u32 s33, s36, 2179072
    buffer_load_dwordx4 v1, s[16:19], s33 offen sc1 lds
    buffer_load_dwordx4 v1, s[16:19], s33 offen offset:1024 sc1 lds
    s_add_u32 m0, s37, 36864
    s_add_u32 s33, s36, 83968
    buffer_load_dwordx4 v1, s[16:19], s33 offen sc1 lds
    buffer_load_dwordx4 v1, s[16:19], s33 offen offset:1024 sc1 lds
    s_add_u32 m0, s37, 38912
    s_add_u32 s33, s36, 2181120
    buffer_load_dwordx4 v1, s[16:19], s33 offen sc1 lds
    buffer_load_dwordx4 v1, s[16:19], s33 offen offset:1024 sc1 lds
    s_cmp_ge_u32 s32, 225
    s_cbranch_scc1 fk_sk4
    v_mul_f32 v144, v124, v97
    v_mul_f32 v145, v124, v96
    v_fma_f32 v124, v120, v97, v145
    v_fma_f32 v120, v120, v96, -v144
    v_mul_f32 v146, v125, v99
    v_mul_f32 v147, v125, v98
    v_fma_f32 v125, v121, v99, v147
    v_fma_f32 v121, v121, v98, -v146
    v_mul_f32 v144, v126, v101
    v_mul_f32 v145, v126, v100
    v_fma_f32 v126, v122, v101, v145
    v_fma_f32 v122, v122, v100, -v144
    v_mul_f32 v146, v127, v103
    v_mul_f32 v147, v127, v102
    v_fma_f32 v127, v123, v103, v147
    v_fma_f32 v123, v123, v102, -v146
    v_mul_f32 v144, v132, v105
    v_mul_f32 v145, v132, v104
    v_fma_f32 v132, v128, v105, v145
    v_fma_f32 v128, v128, v104, -v144
    v_mul_f32 v146, v133, v107
    v_mul_f32 v147, v133, v106
    v_fma_f32 v133, v129, v107, v147
    v_fma_f32 v129, v129, v106, -v146
    v_mul_f32 v144, v134, v109
    v_mul_f32 v145, v134, v108
    v_fma_f32 v134, v130, v109, v145
    v_fma_f32 v130, v130, v108, -v144
    v_mul_f32 v146, v135, v111
    v_mul_f32 v147, v135, v110
    v_fma_f32 v135, v131, v111, v147
    v_fma_f32 v131, v131, v110, -v146
    v_cvt_pk_bf16_f32 v136, v120, v124
    v_cvt_pk_bf16_f32 v137, v121, v125
    v_cvt_pk_bf16_f32 v138, v122, v126
    v_cvt_pk_bf16_f32 v139, v123, v127
    v_cvt_pk_bf16_f32 v140, v128, v132
    v_cvt_pk_bf16_f32 v141, v129, v133
    v_cvt_pk_bf16_f32 v142, v130, v134
    v_cvt_pk_bf16_f32 v143, v131, v135
    ds_write_b32 v153, v136 offset:0
    ds_write_b32 v153, v137 offset:272
    ds_write_b32 v153, v138 offset:544
    ds_write_b32 v153, v139 offset:816
    ds_write_b32 v153, v140 offset:4352
    ds_write_b32 v153, v141 offset:4624
    ds_write_b32 v153, v142 offset:4896
    ds_write_b32 v153, v143 offset:5168
    s_waitcnt lgkmcnt(0)
fk_sk4:
    s_waitcnt vmcnt(8)
    s_barrier
    s_cmp_ge_u32 s32, 225
    s_cbranch_scc1 fk_sk5
    ds_read_b128 v[8:11], v154 offset:0
    ds_read_b128 v[24:27], v154 offset:4352
    ds_read_b128 v[12:15], v154 offset:64
    ds_read_b128 v[28:31], v154 offset:4416
    ds_read_b128 v[16:19], v154 offset:128
    ds_read_b128 v[32:35], v154 offset:4480
    ds_read_b128 v[20:23], v154 offset:192
    ds_read_b128 v[36:39], v154 offset:4544
    s_waitcnt lgkmcnt(6)
    v_mfma_f32_16x16x32_bf16 v[120:123], v[8:11], v[40:43], 0
    v_mfma_f32_16x16x32_bf16 v[124:127], v[8:11], v[56:59], 0
    v_mfma_f32_16x16x32_bf16 v[128:131], v[24:27], v[40:43], 0
    v_mfma_f32_16x16x32_bf16 v[132:135], v[24:27], v[56:59], 0
    s_waitcnt lgkmcnt(4)
    v_mfma_f32_16x16x32_bf16 v[120:123], v[12:15], v[44:47], v[120:123]
    v_mfma_f32_16x16x32_bf16 v[124:127], v[12:15], v[60:63], v[124:127]
    v_mfma_f32_16x16x32_bf16 v[128:131], v[28:31], v[44:47], v[128:131]
    v_mfma_f32_16x16x32_bf16 v[132:135], v[28:31], v[60:63], v[132:135]
    s_waitcnt lgkmcnt(2)
    v_mfma_f32_16x16x32_bf16 v[120:123], v[16:19], v[48:51], v[120:123]
    v_mfma_f32_16x16x32_bf16 v[124:127], v[16:19], v[64:67], v[124:127]
    v_mfma_f32_16x16x32_bf16 v[128:131], v[32:35], v[48:51], v[128:131]
    v_mfma_f32_16x16x32_bf16 v[132:135], v[32:35], v[64:67], v[132:135]
    s_waitcnt lgkmcnt(0)
    v_mfma_f32_16x16x32_bf16 v[120:123], v[20:23], v[52:55], v[120:123]
    v_mfma_f32_16x16x32_bf16 v[124:127], v[20:23], v[68:71], v[124:127]
    v_mfma_f32_16x16x32_bf16 v[128:131], v[36:39], v[52:55], v[128:131]
    v_mfma_f32_16x16x32_bf16 v[132:135], v[36:39], v[68:71], v[132:135]
    s_nop 7
    v_cvt_pk_bf16_f32 v136, v120, v124
    v_cvt_pk_bf16_f32 v137, v121, v125
    v_cvt_pk_bf16_f32 v138, v122, v126
    v_cvt_pk_bf16_f32 v139, v123, v127
    v_cvt_pk_bf16_f32 v140, v128, v132
    v_cvt_pk_bf16_f32 v141, v129, v133
    v_cvt_pk_bf16_f32 v142, v130, v134
    v_cvt_pk_bf16_f32 v143, v131, v135
    ds_write_b128 v155, v[136:139]
    ds_write_b128 v155, v[140:143] offset:64
    s_waitcnt lgkmcnt(0)
    ds_read_b128 v[136:139], v158
    ds_read_b128 v[140:143], v158 offset:1152
    s_waitcnt lgkmcnt(0)
fk_sk5:
    buffer_store_dwordx4 v[136:139], v1, s[16:19], s42 offen sc1
    buffer_store_dwordx4 v[140:143], v1, s[16:19], s42 offen offset:1024 sc1
    s_add_u32 m0, s37, 65536
    s_add_u32 s33, s36, 98304
    buffer_load_dwordx4 v1, s[16:19], s33 offen sc1 lds
    buffer_load_dwordx4 v1, s[16:19], s33 offen offset:1024 sc1 lds
    s_add_u32 m0, s37, 67584
    s_add_u32 s33, s36, 2195456
    buffer_load_dwordx4 v1, s[16:19], s33 offen sc1 lds
    buffer_load_dwordx4 v1, s[16:19], s33 offen offset:1024 sc1 lds
    s_add_u32 m0, s37, 69632
    s_add_u32 s33, s36, 100352
    buffer_load_dwordx4 v1, s[16:19], s33 offen sc1 lds
    buffer_load_dwordx4 v1, s[16:19], s33 offen offset:1024 sc1 lds
    s_add_u32 m0, s37, 71680
    s_add_u32 s33, s36, 2197504
    buffer_load_dwordx4 v1, s[16:19], s33 offen sc1 lds
    buffer_load_dwordx4 v1, s[16:19], s33 offen offset:1024 sc1 lds
    s_setprio 0
    s_waitcnt vmcnt(8)
    s_barrier
    s_cmp_lg_u32 s28, 0
    s_cbranch_scc1 fk_nl4
    s_lshr_b32 s34, s2, 4
    s_mul_i32 s33, s34, 2176
    s_and_b32 s34, s2, 15
    s_lshl_b32 s34, s34, 2
    s_add_u32 s33, s33, s34
    s_add_u32 s33, s33, 16351296
    v_mov_b32 v7, s49
    s_mov_b64 exec, 1
    buffer_store_dword v7, v5, s[16:19], s33 offen sc1
    s_mov_b64 exec, -1
fk_nl4:
    s_add_u32 m0, s37, 98304
    s_add_u32 s33, s36, 114688
    buffer_load_dwordx4 v1, s[16:19], s33 offen sc1 lds
    buffer_load_dwordx4 v1, s[16:19], s33 offen offset:1024 sc1 lds
    s_add_u32 m0, s37, 100352
    s_add_u32 s33, s36, 2211840
    buffer_load_dwordx4 v1, s[16:19], s33 offen sc1 lds
    buffer_load_dwordx4 v1, s[16:19], s33 offen offset:1024 sc1 lds
    s_add_u32 m0, s37, 102400
    s_add_u32 s33, s36, 116736
    buffer_load_dwordx4 v1, s[16:19], s33 offen sc1 lds
    buffer_load_dwordx4 v1, s[16:19], s33 offen offset:1024 sc1 lds
    s_add_u32 m0, s37, 104448
    s_add_u32 s33, s36, 2213888
    buffer_load_dwordx4 v1, s[16:19], s33 offen sc1 lds
    buffer_load_dwordx4 v1, s[16:19], s33 offen offset:1024 sc1 lds
    s_waitcnt vmcnt(8)
    s_barrier
    s_lshr_b32 s34, s2, 4
    s_and_b32 s35, s2, 15
    s_cmp_lg_u32 s34, s35
    s_cbranch_scc1 fk_tdF
    s_lshl_b32 s33, s2, 7
    s_add_u32 s33, s33, 16351296
    s_mov_b64 exec, 0xffff
    s_mov_b32 s56, 0
fk_poll4:
    buffer_load_dword v7, v6, s[16:19], s33 offen sc1
    s_waitcnt vmcnt(0)
    v_cmp_ne_u32 vcc, s49, v7
    s_add_u32 s56, s56, 1
    s_cmp_gt_u32 s56, 100000
    s_cbranch_scc1 fk_poll4_x
    s_cbranch_vccnz fk_poll4
fk_poll4_x:
    s_mov_b64 exec, -1
    s_lshl_b32 s34, s34, 2
    s_lshl_b32 s35, s28, 13
    v_lshlrev_b32 v3, 7, v0
    v_mov_b32 v7, s49
    s_add_u32 s33, s34, 16318528
    s_add_u32 s33, s33, s35
    buffer_store_dword v7, v3, s[16:19], s33 offen sc1
fk_tdF:
    s_lshr_b32 s34, s37, 3
    s_add_u32 m0, s34, 0
    s_add_u32 s33, s46, 0
    buffer_load_dwordx4 v156, s[8:11], s33 offen lds
    s_lshr_b32 s34, s37, 3
    s_add_u32 m0, s34, 4096
    s_add_u32 s33, s46, 28672
    buffer_load_dwordx4 v156, s[8:11], s33 offen lds
    s_lshr_b32 s34, s37, 3
    s_add_u32 m0, s34, 8192
    s_add_u32 s33, s46, 57344
    buffer_load_dwordx4 v156, s[8:11], s33 offen lds
    s_lshr_b32 s34, s37, 3
    s_add_u32 m0, s34, 12288
    s_add_u32 s33, s46, 86016
    buffer_load_dwordx4 v156, s[8:11], s33 offen lds
    s_lshr_b32 s34, s37, 3
    s_add_u32 m0, s34, 16384
    s_add_u32 s33, s46, 114688
    buffer_load_dwordx4 v156, s[8:11], s33 offen lds
    s_lshr_b32 s34, s37, 3
    s_add_u32 m0, s34, 20480
    s_add_u32 s33, s46, 143360
    buffer_load_dwordx4 v156, s[8:11], s33 offen lds
    s_lshr_b32 s34, s37, 3
    s_add_u32 m0, s34, 24576
    s_add_u32 s33, s46, 172032
    buffer_load_dwordx4 v156, s[8:11], s33 offen lds
    s_lshr_b32 s34, s37, 3
    s_add_u32 m0, s34, 28672
    s_add_u32 s33, s46, 200704
    buffer_load_dwordx4 v156, s[8:11], s33 offen lds
    s_waitcnt vmcnt(8)
    s_barrier
    s_lshr_b32 s34, s37, 3
    s_add_u32 m0, s34, 32768
    s_add_u32 s33, s46, 229376
    buffer_load_dwordx4 v156, s[8:11], s33 offen lds
    s_lshr_b32 s34, s37, 3
    s_add_u32 m0, s34, 36864
    s_add_u32 s33, s46, 258048
    buffer_load_dwordx4 v156, s[8:11], s33 offen lds
    s_lshr_b32 s34, s37, 3
    s_add_u32 m0, s34, 40960
    s_add_u32 s33, s46, 286720
    buffer_load_dwordx4 v156, s[8:11], s33 offen lds
    s_lshr_b32 s34, s37, 3
    s_add_u32 m0, s34, 45056
    s_add_u32 s33, s46, 315392
    buffer_load_dwordx4 v156, s[8:11], s33 offen lds
    s_lshr_b32 s34, s37, 3
    s_add_u32 m0, s34, 49152
    s_add_u32 s33, s46, 344064
    buffer_load_dwordx4 v156, s[8:11], s33 offen lds
    s_lshr_b32 s34, s37, 3
    s_add_u32 m0, s34, 53248
    s_add_u32 s33, s46, 372736
    buffer_load_dwordx4 v156, s[8:11], s33 offen lds
    s_lshr_b32 s34, s37, 3
    s_add_u32 m0, s34, 57344
    s_add_u32 s33, s46, 401408
    buffer_load_dwordx4 v156, s[8:11], s33 offen lds
    v_lshrrev_b32 v104, 3, v0
    v_and_b32 v105, 7, v0
    v_sub_u32 v106, 7, v104
    v_mul_u32_u24 v106, 8320, v106
    v_lshl_add_u32 v113, v105, 2, v106
    v_mul_u32_u24 v106, 8320, v104
    v_lshl_add_u32 v112, v105, 2, v106
    v_lshlrev_b32 v107, 6, v104
    s_lshl_b32 s35, s28, 9
    s_add_u32 s35, s35, 63488
    buffer_load_dwordx4 v[48:51], v107, s[20:23], s35 offen offset:0
    buffer_load_dwordx4 v[52:55], v107, s[20:23], s35 offen offset:16
    buffer_load_dwordx4 v[56:59], v107, s[20:23], s35 offen offset:32
    buffer_load_dwordx4 v[60:63], v107, s[20:23], s35 offen offset:48
    s_and_b32 s40, s28, 1
    s_lshl_b32 s34, s40, 12
    s_add_u32 s34, s34, 65536
    buffer_load_dwordx4 v[64:67], v1, s[20:23], s34 offen offset:0
    buffer_load_dwordx4 v[68:71], v1, s[20:23], s34 offen offset:1024
    buffer_load_dwordx4 v[72:75], v1, s[20:23], s34 offen offset:2048
    buffer_load_dwordx4 v[76:79], v1, s[20:23], s34 offen offset:3072
    s_barrier
    v_mul_u32_u24 v114, 1168, v105
    v_lshl_add_u32 v114, v104, 2, v114
    s_lshl_b32 s34, s28, 5
    s_add_u32 s34, s34, 131072
    v_add_u32 v114, s34, v114
    v_and_b32 v108, 31, v0
    v_lshrrev_b32 v109, 5, v0
    v_mul_u32_u24 v115, 144, v108
    v_lshrrev_b32 v110, 3, v108
    v_add_u32 v110, v110, v109
    v_lshl_add_u32 v115, v110, 4, v115
    s_lshr_b32 s41, s28, 1
    s_mul_i32 s34, s41, 4672
    s_add_u32 s34, s34, 131072
    v_add_u32 v115, s34, v115
    s_lshl_b32 s34, s40, 5
    v_add_u32 v110, s34, v108
    v_lshlrev_b32 v116, 4, v110
    v_lshl_add_u32 v116, v109, 3, v116
    v_mov_b32 v111, 0x7f000000
    v_cmp_lt_u32 vcc, 55, v110
    s_lshl_b32 s42, s32, 5
    s_add_u32 s42, s42, 13631488
    v_cndmask_b32 v116, v116, v111, vcc
    s_mul_i32 s35, s28, 66560
    s_sub_u32 s43, s42, s35
    s_add_u32 s42, s42, s35
    s_mov_b32 s48, 0x3f3504f3
    s_lshl_b32 s36, s32, 3
    s_lshl_b32 s35, s41, 2
    s_add_u32 s36, s36, s35
    s_mul_i32 s36, s36, 1792
    s_add_u32 s36, s36, 896
    s_add_u32 s37, s36, 3584
    s_lshl_b32 s33, s2, 7
    s_add_u32 s33, s33, 16318528
    s_mov_b64 exec, 0xffff
    s_mov_b32 s56, 0
fk_poll5:
    buffer_load_dword v7, v6, s[16:19], s33 offen sc1
    s_waitcnt vmcnt(0)
    v_cmp_ne_u32 vcc, s49, v7
    s_add_u32 s56, s56, 1
    s_cmp_gt_u32 s56, 100000
    s_cbranch_scc1 fk_poll5_x
    s_cbranch_vccnz fk_poll5
fk_poll5_x:
    s_mov_b64 exec, -1
    s_add_u32 s33, s42, 0
    buffer_load_dword v24, v112, s[16:19], s33 offen sc1
    s_add_u32 s33, s42, 465920
    buffer_load_dword v25, v112, s[16:19], s33 offen sc1
    s_add_u32 s33, s42, 931840
    buffer_load_dword v26, v112, s[16:19], s33 offen sc1
    s_add_u32 s33, s42, 1397760
    buffer_load_dword v27, v112, s[16:19], s33 offen sc1
    s_add_u32 s33, s43, 1805440
    buffer_load_dword v28, v113, s[16:19], s33 offen sc1
    s_add_u32 s33, s43, 1339520
    buffer_load_dword v29, v113, s[16:19], s33 offen sc1
    s_add_u32 s33, s43, 873600
    buffer_load_dword v30, v113, s[16:19], s33 offen sc1
    s_add_u32 s33, s43, 407680
    buffer_load_dword v31, v113, s[16:19], s33 offen sc1
    s_barrier
    s_cmp_lg_u32 s28, 0
    s_cbranch_scc1 fk_nl5
    v_mov_b32 v7, s49
    s_lshl_b32 s33, s31, 2
    s_add_u32 s33, s33, 16318464
    s_mov_b64 exec, 0x3fff
    buffer_store_dword v7, v157, s[16:19], s33 offen sc1
    s_mov_b64 exec, -1
    s_cmp_lg_u32 s2, 255
    s_cbranch_scc1 fk_noadv
    s_mov_b32 s33, 16384000
    s_mov_b64 exec, 1
    buffer_store_dword v7, v5, s[16:19], s33 offen sc1
    s_mov_b64 exec, -1
fk_noadv:
    s_waitcnt vmcnt(2)
fk_nl5:
    s_cmp_eq_u32 s28, 0
    s_cbranch_scc1 fk_zok
    s_waitcnt vmcnt(0)
fk_zok:
    s_waitcnt vmcnt(1)
    v_lshlrev_b32 v32, 16, v24
    v_and_b32 v33, 0xffff0000, v24
    v_lshlrev_b32 v34, 16, v25
    v_and_b32 v35, 0xffff0000, v25
    v_lshlrev_b32 v36, 16, v26
    v_and_b32 v37, 0xffff0000, v26
    v_lshlrev_b32 v38, 16, v27
    v_and_b32 v39, 0xffff0000, v27
    v_lshlrev_b32 v40, 16, v28
    v_and_b32 v41, 0xffff0000, v28
    v_lshlrev_b32 v42, 16, v29
    v_and_b32 v43, 0xffff0000, v29
    v_lshlrev_b32 v44, 16, v30
    v_and_b32 v45, 0xffff0000, v30
    v_lshlrev_b32 v46, 16, v31
    v_and_b32 v47, 0xffff0000, v31
    v_add_f32 v96, v32, v40
    v_sub_f32 v97, v41, v33
    v_sub_f32 v40, v32, v40
    v_add_f32 v41, v33, v41
    v_add_f32 v98, v34, v42
    v_sub_f32 v99, v43, v35
    v_sub_f32 v42, v34, v42
    v_add_f32 v43, v35, v43
    v_add_f32 v100, v36, v44
    v_sub_f32 v101, v45, v37
    v_sub_f32 v44, v36, v44
    v_add_f32 v45, v37, v45
    v_add_f32 v102, v38, v46
    v_sub_f32 v103, v47, v39
    v_sub_f32 v46, v38, v46
    v_add_f32 v47, v39, v47
    v_add_f32 v32, v42, v43
    v_sub_f32 v43, v42, v43
    v_mul_f32 v32, s48, v32
    v_mul_f32 v43, s48, v43
    v_add_f32 v33, v46, v47
    v_sub_f32 v47, v46, v47
    v_mul_f32 v33, s48, v33
    v_mul_f32 v47, s48, v47
    v_add_f32 v34, v96, v100
    v_add_f32 v35, v97, v101
    v_sub_f32 v100, v96, v100
    v_sub_f32 v101, v97, v101
    v_add_f32 v36, v98, v102
    v_add_f32 v37, v99, v103
    v_sub_f32 v102, v98, v102
    v_sub_f32 v103, v99, v103
    v_add_f32 v38, v34, v36
    v_add_f32 v39, v35, v37
    v_sub_f32 v36, v34, v36
    v_sub_f32 v37, v35, v37
    v_sub_f32 v42, v100, v103
    v_add_f32 v46, v101, v102
    v_add_f32 v103, v100, v103
    v_sub_f32 v102, v101, v102
    v_add_f32 v96, v40, v45
    v_sub_f32 v97, v44, v41
    v_sub_f32 v45, v40, v45
    v_add_f32 v44, v41, v44
    v_sub_f32 v98, v32, v47
    v_add_f32 v99, v43, v33
    v_add_f32 v47, v32, v47
    v_sub_f32 v33, v43, v33
    v_add_f32 v34, v96, v98
    v_add_f32 v35, v97, v99
    v_sub_f32 v98, v96, v98
    v_sub_f32 v99, v97, v99
    v_sub_f32 v100, v45, v33
    v_sub_f32 v101, v47, v44
    v_add_f32 v33, v45, v33
    v_add_f32 v47, v44, v47
    v_cvt_pk_bf16_f32 v24, v38, v39
    ds_write_b32 v114, v24 offset:0
    v_mul_f32_e64 v106, v35, v49
    v_mul_f32_e64 v107, v35, v48
    v_fma_f32 v106, v34, v48, v106
    v_fma_f32 v107, -v34, v49, v107
    v_cvt_pk_bf16_f32 v25, v106, v107
    ds_write_b32 v114, v25 offset:144
    v_mul_f32_e64 v104, v46, v51
    v_mul_f32_e64 v105, v46, v50
    v_fma_f32 v104, v42, v50, v104
    v_fma_f32 v105, -v42, v51, v105
    v_cvt_pk_bf16_f32 v26, v104, v105
    ds_write_b32 v114, v26 offset:288
    v_mul_f32_e64 v106, v101, v53
    v_mul_f32_e64 v107, v101, v52
    v_fma_f32 v106, v100, v52, v106
    v_fma_f32 v107, -v100, v53, v107
    v_cvt_pk_bf16_f32 v27, v106, v107
    ds_write_b32 v114, v27 offset:432
    v_mul_f32_e64 v104, v37, v55
    v_mul_f32_e64 v105, v37, v54
    v_fma_f32 v104, v36, v54, v104
    v_fma_f32 v105, -v36, v55, v105
    v_cvt_pk_bf16_f32 v28, v104, v105
    ds_write_b32 v114, v28 offset:576
    v_mul_f32_e64 v106, v99, v57
    v_mul_f32_e64 v107, v99, v56
    v_fma_f32 v106, v98, v56, v106
    v_fma_f32 v107, -v98, v57, v107
    v_cvt_pk_bf16_f32 v29, v106, v107
    ds_write_b32 v114, v29 offset:720
    v_mul_f32_e64 v104, v102, v59
    v_mul_f32_e64 v105, v102, v58
    v_fma_f32 v104, v103, v58, v104
    v_fma_f32 v105, -v103, v59, v105
    v_cvt_pk_bf16_f32 v30, v104, v105
    ds_write_b32 v114, v30 offset:864
    v_mul_f32_e64 v106, -v47, v61
    v_mul_f32_e64 v107, -v47, v60
    v_fma_f32 v106, v33, v60, v106
    v_fma_f32 v107, -v33, v61, v107
    v_cvt_pk_bf16_f32 v31, v106, v107
    ds_write_b32 v114, v31 offset:1008
    s_waitcnt lgkmcnt(0)
    s_cmp_lg_u32 s28, 0
    s_cbranch_scc1 fk_nl6
    s_cmp_ge_u32 s30, 28
    s_cbranch_scc1 fk_np2
    s_lshl_b32 s33, s2, 7
    s_add_u32 s33, s33, 16318464
    s_mov_b64 exec, 0xffff
    s_mov_b32 s56, 0
fk_poll6:
    buffer_load_dword v7, v6, s[16:19], s33 offen sc1
    s_waitcnt vmcnt(0)
    v_cmp_ne_u32 vcc, s49, v7
    s_add_u32 s56, s56, 1
    s_cmp_gt_u32 s56, 100000
    s_cbranch_scc1 fk_poll6_x
    s_cbranch_vccnz fk_poll6
fk_poll6_x:
    s_mov_b64 exec, -1
fk_np2:
fk_nl6:
    s_barrier
    ds_read_b128 v[80:83], v115 offset:0
    ds_read_b128 v[84:87], v115 offset:32
    ds_read_b128 v[88:91], v115 offset:64
    ds_read_b128 v[92:95], v115 offset:96
    s_waitcnt lgkmcnt(3)
    v_mfma_f32_32x32x16_bf16 v[8:23], v[80:83], v[64:67], 0
    s_waitcnt lgkmcnt(2)
    v_mfma_f32_32x32x16_bf16 v[8:23], v[84:87], v[68:71], v[8:23]
    s_waitcnt lgkmcnt(1)
    v_mfma_f32_32x32x16_bf16 v[8:23], v[88:91], v[72:75], v[8:23]
    s_waitcnt lgkmcnt(0)
    v_mfma_f32_32x32x16_bf16 v[8:23], v[92:95], v[76:79], v[8:23]
    s_nop 7
    s_nop 3
    v_cvt_pk_bf16_f32 v32, v8, v9
    v_cvt_pk_bf16_f32 v33, v10, v11
    v_cvt_pk_bf16_f32 v34, v12, v13
    v_cvt_pk_bf16_f32 v35, v14, v15
    v_cvt_pk_bf16_f32 v36, v16, v17
    v_cvt_pk_bf16_f32 v37, v18, v19
    v_cvt_pk_bf16_f32 v38, v20, v21
    v_cvt_pk_bf16_f32 v39, v22, v23
    buffer_store_dwordx2 v[32:33], v116, s[12:15], s36 offen offset:0
    buffer_store_dwordx2 v[34:35], v116, s[12:15], s36 offen offset:1792
    buffer_store_dwordx2 v[36:37], v116, s[12:15], s37 offen offset:0
    buffer_store_dwordx2 v[38:39], v116, s[12:15], s37 offen offset:1792
    s_endpgm
fk_c_p1:
    s_mov_b32 s12, s76
    s_mov_b32 s13, s77
    s_lshr_b32 s31, s30, 4
    s_lshl_b32 s33, s29, 1
    s_add_u32 s31, s31, s33
    s_mul_i32 s33, s31, 131072
    s_add_u32 s36, s33, 2097152
    s_and_b32 s32, s30, 15
    s_lshl_b32 s32, s32, 2
    s_add_u32 s32, s32, s28
    s_lshl_b32 s34, s32, 11
    s_add_u32 s42, s33, s34
    s_add_u32 s42, s42, 0
    s_lshl_b32 s37, s32, 4
    s_add_u32 s37, s37, s31
    s_lshl_b32 s37, s37, 11
    s_add_u32 s37, s37, 11534336
    s_mov_b32 s38, 0
    s_mov_b32 s14, 3670016
    s_mov_b32 s15, 0x20000
    s_waitcnt vmcnt(0) lgkmcnt(0)
    s_barrier
    v_mov_b32 v108, 0xff800000
    v_mov_b32 v12, 0
    v_mov_b32 v13, 0
    v_mov_b32 v14, 0
    v_mov_b32 v15, 0
    v_mov_b32 v16, 0
    v_mov_b32 v17, 0
    v_mov_b32 v18, 0
    v_mov_b32 v19, 0
    v_mov_b32 v20, 0
    v_mov_b32 v21, 0
    v_mov_b32 v22, 0
    v_mov_b32 v23, 0
    v_mov_b32 v24, 0
    v_mov_b32 v25, 0
    v_mov_b32 v26, 0
    v_mov_b32 v27, 0
    v_mov_b32 v68, 0
    v_mov_b32 v69, 0
    v_mov_b32 v70, 0
    v_mov_b32 v71, 0
    v_mov_b32 v72, 0
    v_mov_b32 v73, 0
    v_mov_b32 v74, 0
    v_mov_b32 v75, 0
    v_mov_b32 v100, 0
    v_mov_b32 v101, 0
    v_mov_b32 v102, 0
    v_mov_b32 v103, 0
    v_mov_b32 v104, 0
    v_mov_b32 v105, 0
    v_mov_b32 v106, 0
    v_mov_b32 v107, 0
    v_mov_b32 v114, v1
    v_add_u32 v115, 0x8000, v1
    s_barrier
    buffer_load_dwordx4 v[76:79], v1, s[16:19], s36 offen offset:0 sc1
    buffer_load_dwordx4 v[80:83], v1, s[16:19], s36 offen offset:1024 sc1
    buffer_load_dwordx4 v[4:7], v1, s[16:19], s42 offen offset:0 sc1
    buffer_load_dwordx4 v[8:11], v1, s[16:19], s42 offen offset:1024 sc1
    s_waitcnt vmcnt(0)
    v_mfma_f32_32x32x16_bf16 v[44:59], v[76:79], v[4:7], 0
    v_mfma_f32_32x32x16_bf16 v[44:59], v[80:83], v[8:11], v[44:59]
    s_nop 7
    s_nop 3
    v_max3_f32 v108, v44, v45, v108
    v_max3_f32 v108, v46, v47, v108
    v_max3_f32 v108, v48, v49, v108
    v_max3_f32 v108, v50, v51, v108
    v_max3_f32 v108, v52, v53, v108
    v_max3_f32 v108, v54, v55, v108
    v_max3_f32 v108, v56, v57, v108
    v_max3_f32 v108, v58, v59, v108
    v_mov_b32 v110, v108
    v_mov_b32 v111, v108
    s_nop 1
    v_permlane32_swap_b32 v110, v111
    s_nop 0
    v_max_f32 v108, v110, v111
    v_cvt_pk_bf16_f32 v110, v108, v108
    v_and_b32 v110, 0xffff0000, v110
    v_sub_f32 v111, v108, v110
    s_mov_b64 exec, s[50:51]
    v_cvt_pk_bf16_f32 v10, -v110, -v111
    s_mov_b64 exec, -1
    v_mfma_f32_32x32x16_bf16 v[28:43], v[76:79], v[4:7], 0
    s_barrier
    v_mfma_f32_32x32x16_bf16 v[28:43], v[80:83], v[8:11], v[28:43]
    ds_read_b128 v[84:87], v114 offset:4096
    ds_read_b128 v[88:91], v114 offset:5120
    s_nop 7
    s_waitcnt lgkmcnt(0)
.p2align 6
fk_loop:
    v_mfma_f32_32x32x16_bf16 v[44:59], v[84:87], v[4:7], 0
    ds_read_b128 v[92:95], v114 offset:2048
    v_exp_f32 v28, v28
    v_exp_f32 v29, v29
    v_exp_f32 v30, v30
    v_exp_f32 v31, v31
    v_mfma_f32_32x32x16_bf16 v[44:59], v[88:91], v[8:11], v[44:59]
    ds_read_b128 v[96:99], v114 offset:3072
    v_exp_f32 v32, v32
    v_exp_f32 v33, v33
    v_cvt_pk_bf16_f32 v60, v28, v29
    v_exp_f32 v34, v34
    v_exp_f32 v35, v35
    v_cvt_pk_bf16_f32 v61, v30, v31
    v_mfma_f32_32x32x16_bf16 v[12:27], v[100:103], v[68:71], v[12:27]
    ds_read_b128 v[76:79], v114 offset:8192
    ds_read_b128 v[80:83], v114 offset:9216
    v_exp_f32 v36, v36
    v_exp_f32 v37, v37
    v_cvt_pk_bf16_f32 v62, v32, v33
    v_exp_f32 v38, v38
    v_exp_f32 v39, v39
    v_cvt_pk_bf16_f32 v63, v34, v35
    v_mfma_f32_32x32x16_bf16 v[12:27], v[104:107], v[72:75], v[12:27]
    v_exp_f32 v40, v40
    v_exp_f32 v41, v41
    v_cvt_pk_bf16_f32 v64, v36, v37
    v_exp_f32 v42, v42
    v_exp_f32 v43, v43
    s_waitcnt lgkmcnt(0)
    v_cvt_pk_bf16_f32 v65, v38, v39
    v_cvt_pk_bf16_f32 v66, v40, v41
    v_cvt_pk_bf16_f32 v67, v42, v43
    v_mfma_f32_32x32x16_bf16 v[28:43], v[76:79], v[4:7], 0
    ds_read_b128 v[100:103], v114 offset:6144
    v_exp_f32 v44, v44
    v_exp_f32 v45, v45
    v_exp_f32 v46, v46
    v_exp_f32 v47, v47
    v_mfma_f32_32x32x16_bf16 v[28:43], v[80:83], v[8:11], v[28:43]
    ds_read_b128 v[104:107], v114 offset:7168
    v_exp_f32 v48, v48
    v_exp_f32 v49, v49
    v_cvt_pk_bf16_f32 v68, v44, v45
    v_exp_f32 v50, v50
    v_exp_f32 v51, v51
    v_cvt_pk_bf16_f32 v69, v46, v47
    v_mfma_f32_32x32x16_bf16 v[12:27], v[92:95], v[60:63], v[12:27]
    ds_read_b128 v[84:87], v114 offset:12288
    ds_read_b128 v[88:91], v114 offset:13312
    v_exp_f32 v52, v52
    v_exp_f32 v53, v53
    v_cvt_pk_bf16_f32 v70, v48, v49
    v_exp_f32 v54, v54
    v_exp_f32 v55, v55
    v_cvt_pk_bf16_f32 v71, v50, v51
    v_mfma_f32_32x32x16_bf16 v[12:27], v[96:99], v[64:67], v[12:27]
    v_exp_f32 v56, v56
    v_exp_f32 v57, v57
    v_cvt_pk_bf16_f32 v72, v52, v53
    v_exp_f32 v58, v58
    v_exp_f32 v59, v59
    s_waitcnt lgkmcnt(0)
    v_cvt_pk_bf16_f32 v73, v54, v55
    v_cvt_pk_bf16_f32 v74, v56, v57
    v_cvt_pk_bf16_f32 v75, v58, v59
    v_mfma_f32_32x32x16_bf16 v[44:59], v[84:87], v[4:7], 0
    ds_read_b128 v[92:95], v114 offset:10240
    v_exp_f32 v28, v28
    v_exp_f32 v29, v29
    v_exp_f32 v30, v30
    v_exp_f32 v31, v31
    v_mfma_f32_32x32x16_bf16 v[44:59], v[88:91], v[8:11], v[44:59]
    ds_read_b128 v[96:99], v114 offset:11264
    v_exp_f32 v32, v32
    v_exp_f32 v33, v33
    v_cvt_pk_bf16_f32 v60, v28, v29
    v_exp_f32 v34, v34
    v_exp_f32 v35, v35
    v_cvt_pk_bf16_f32 v61, v30, v31
    v_mfma_f32_32x32x16_bf16 v[12:27], v[100:103], v[68:71], v[12:27]
    ds_read_b128 v[76:79], v114 offset:16384
    ds_read_b128 v[80:83], v114 offset:17408
    v_exp_f32 v36, v36
    v_exp_f32 v37, v37
    v_cvt_pk_bf16_f32 v62, v32, v33
    v_exp_f32 v38, v38
    v_exp_f32 v39, v39
    v_cvt_pk_bf16_f32 v63, v34, v35
    v_mfma_f32_32x32x16_bf16 v[12:27], v[104:107], v[72:75], v[12:27]
    v_exp_f32 v40, v40
    v_exp_f32 v41, v41
    v_cvt_pk_bf16_f32 v64, v36, v37
    v_exp_f32 v42, v42
    v_exp_f32 v43, v43
    s_waitcnt lgkmcnt(0)
    v_cvt_pk_bf16_f32 v65, v38, v39
    v_cvt_pk_bf16_f32 v66, v40, v41
    v_cvt_pk_bf16_f32 v67, v42, v43
    v_mfma_f32_32x32x16_bf16 v[28:43], v[76:79], v[4:7], 0
    ds_read_b128 v[100:103], v114 offset:14336
    v_exp_f32 v44, v44
    v_exp_f32 v45, v45
    v_exp_f32 v46, v46
    v_exp_f32 v47, v47
    v_mfma_f32_32x32x16_bf16 v[28:43], v[80:83], v[8:11], v[28:43]
    ds_read_b128 v[104:107], v114 offset:15360
    v_exp_f32 v48, v48
    v_exp_f32 v49, v49
    v_cvt_pk_bf16_f32 v68, v44, v45
    v_exp_f32 v50, v50
    v_exp_f32 v51, v51
    v_cvt_pk_bf16_f32 v69, v46, v47
    v_mfma_f32_32x32x16_bf16 v[12:27], v[92:95], v[60:63], v[12:27]
    ds_read_b128 v[84:87], v114 offset:20480
    ds_read_b128 v[88:91], v114 offset:21504
    v_exp_f32 v52, v52
    v_exp_f32 v53, v53
    v_cvt_pk_bf16_f32 v70, v48, v49
    v_exp_f32 v54, v54
    v_exp_f32 v55, v55
    v_cvt_pk_bf16_f32 v71, v50, v51
    v_mfma_f32_32x32x16_bf16 v[12:27], v[96:99], v[64:67], v[12:27]
    v_exp_f32 v56, v56
    v_exp_f32 v57, v57
    v_cvt_pk_bf16_f32 v72, v52, v53
    v_exp_f32 v58, v58
    v_exp_f32 v59, v59
    s_waitcnt lgkmcnt(0)
    v_cvt_pk_bf16_f32 v73, v54, v55
    v_cvt_pk_bf16_f32 v74, v56, v57
    v_cvt_pk_bf16_f32 v75, v58, v59
    v_mfma_f32_32x32x16_bf16 v[44:59], v[84:87], v[4:7], 0
    ds_read_b128 v[92:95], v114 offset:18432
    v_exp_f32 v28, v28
    v_exp_f32 v29, v29
    v_exp_f32 v30, v30
    v_exp_f32 v31, v31
    v_mfma_f32_32x32x16_bf16 v[44:59], v[88:91], v[8:11], v[44:59]
    ds_read_b128 v[96:99], v114 offset:19456
    v_exp_f32 v32, v32
    v_exp_f32 v33, v33
    v_cvt_pk_bf16_f32 v60, v28, v29
    v_exp_f32 v34, v34
    v_exp_f32 v35, v35
    v_cvt_pk_bf16_f32 v61, v30, v31
    v_mfma_f32_32x32x16_bf16 v[12:27], v[100:103], v[68:71], v[12:27]
    ds_read_b128 v[76:79], v114 offset:24576
    ds_read_b128 v[80:83], v114 offset:25600
    v_exp_f32 v36, v36
    v_exp_f32 v37, v37
    v_cvt_pk_bf16_f32 v62, v32, v33
    v_exp_f32 v38, v38
    v_exp_f32 v39, v39
    v_cvt_pk_bf16_f32 v63, v34, v35
    v_mfma_f32_32x32x16_bf16 v[12:27], v[104:107], v[72:75], v[12:27]
    v_exp_f32 v40, v40
    v_exp_f32 v41, v41
    v_cvt_pk_bf16_f32 v64, v36, v37
    v_exp_f32 v42, v42
    v_exp_f32 v43, v43
    s_waitcnt lgkmcnt(0)
    v_cvt_pk_bf16_f32 v65, v38, v39
    v_cvt_pk_bf16_f32 v66, v40, v41
    v_cvt_pk_bf16_f32 v67, v42, v43
    v_mfma_f32_32x32x16_bf16 v[28:43], v[76:79], v[4:7], 0
    ds_read_b128 v[100:103], v114 offset:22528
    v_exp_f32 v44, v44
    v_exp_f32 v45, v45
    v_exp_f32 v46, v46
    v_exp_f32 v47, v47
    v_mfma_f32_32x32x16_bf16 v[28:43], v[80:83], v[8:11], v[28:43]
    ds_read_b128 v[104:107], v114 offset:23552
    v_exp_f32 v48, v48
    v_exp_f32 v49, v49
    v_cvt_pk_bf16_f32 v68, v44, v45
    v_exp_f32 v50, v50
    v_exp_f32 v51, v51
    v_cvt_pk_bf16_f32 v69, v46, v47
    v_mfma_f32_32x32x16_bf16 v[12:27], v[92:95], v[60:63], v[12:27]
    ds_read_b128 v[84:87], v114 offset:28672
    ds_read_b128 v[88:91], v114 offset:29696
    v_exp_f32 v52, v52
    v_exp_f32 v53, v53
    v_cvt_pk_bf16_f32 v70, v48, v49
    v_exp_f32 v54, v54
    v_exp_f32 v55, v55
    v_cvt_pk_bf16_f32 v71, v50, v51
    v_mfma_f32_32x32x16_bf16 v[12:27], v[96:99], v[64:67], v[12:27]
    v_exp_f32 v56, v56
    v_exp_f32 v57, v57
    v_cvt_pk_bf16_f32 v72, v52, v53
    v_exp_f32 v58, v58
    v_exp_f32 v59, v59
    s_waitcnt lgkmcnt(0)
    v_cvt_pk_bf16_f32 v73, v54, v55
    v_cvt_pk_bf16_f32 v74, v56, v57
    v_cvt_pk_bf16_f32 v75, v58, v59
    v_mfma_f32_32x32x16_bf16 v[44:59], v[84:87], v[4:7], 0
    s_barrier
    ds_read_b128 v[92:95], v114 offset:26624
    v_exp_f32 v28, v28
    v_exp_f32 v29, v29
    v_exp_f32 v30, v30
    v_exp_f32 v31, v31
    v_mfma_f32_32x32x16_bf16 v[44:59], v[88:91], v[8:11], v[44:59]
    ds_read_b128 v[96:99], v114 offset:27648
    v_exp_f32 v32, v32
    v_exp_f32 v33, v33
    v_cvt_pk_bf16_f32 v60, v28, v29
    v_exp_f32 v34, v34
    v_exp_f32 v35, v35
    v_cvt_pk_bf16_f32 v61, v30, v31
    v_mfma_f32_32x32x16_bf16 v[12:27], v[100:103], v[68:71], v[12:27]
    ds_read_b128 v[76:79], v115 offset:0
    ds_read_b128 v[80:83], v115 offset:1024
    v_exp_f32 v36, v36
    v_exp_f32 v37, v37
    v_cvt_pk_bf16_f32 v62, v32, v33
    v_exp_f32 v38, v38
    v_exp_f32 v39, v39
    v_cvt_pk_bf16_f32 v63, v34, v35
    v_mfma_f32_32x32x16_bf16 v[12:27], v[104:107], v[72:75], v[12:27]
    v_exp_f32 v40, v40
    v_exp_f32 v41, v41
    v_cvt_pk_bf16_f32 v64, v36, v37
    v_exp_f32 v42, v42
    v_exp_f32 v43, v43
    s_waitcnt lgkmcnt(0)
    v_cvt_pk_bf16_f32 v65, v38, v39
    v_cvt_pk_bf16_f32 v66, v40, v41
    v_cvt_pk_bf16_f32 v67, v42, v43
    v_mfma_f32_32x32x16_bf16 v[28:43], v[76:79], v[4:7], 0
    ds_read_b128 v[100:103], v114 offset:30720
    v_exp_f32 v44, v44
    v_exp_f32 v45, v45
    v_exp_f32 v46, v46
    v_exp_f32 v47, v47
    v_mfma_f32_32x32x16_bf16 v[28:43], v[80:83], v[8:11], v[28:43]
    ds_read_b128 v[104:107], v114 offset:31744
    v_exp_f32 v48, v48
    v_exp_f32 v49, v49
    v_cvt_pk_bf16_f32 v68, v44, v45
    v_exp_f32 v50, v50
    v_exp_f32 v51, v51
    v_cvt_pk_bf16_f32 v69, v46, v47
    v_mfma_f32_32x32x16_bf16 v[12:27], v[92:95], v[60:63], v[12:27]
    ds_read_b128 v[84:87], v115 offset:4096
    ds_read_b128 v[88:91], v115 offset:5120
    v_exp_f32 v52, v52
    v_exp_f32 v53, v53
    v_cvt_pk_bf16_f32 v70, v48, v49
    v_exp_f32 v54, v54
    v_exp_f32 v55, v55
    v_cvt_pk_bf16_f32 v71, v50, v51
    v_mfma_f32_32x32x16_bf16 v[12:27], v[96:99], v[64:67], v[12:27]
    v_exp_f32 v56, v56
    s_add_u32 s38, s38, 1
    v_exp_f32 v57, v57
    v_cvt_pk_bf16_f32 v72, v52, v53
    v_exp_f32 v58, v58
    s_cmp_lt_u32 s38, 8
    v_exp_f32 v59, v59
    s_waitcnt lgkmcnt(0)
    v_cvt_pk_bf16_f32 v73, v54, v55
    v_cvt_pk_bf16_f32 v74, v56, v57
    v_cvt_pk_bf16_f32 v75, v58, v59
    v_mov_b32 v114, v115
    v_add_u32 v115, 0x8000, v115
    v_and_b32 v115, 0x1ffff, v115
    s_cbranch_scc1 fk_loop
    v_mfma_f32_32x32x16_bf16 v[12:27], v[100:103], v[68:71], v[12:27]
    v_mfma_f32_32x32x16_bf16 v[12:27], v[104:107], v[72:75], v[12:27]
    s_mov_b32 s34, 0x5d800000
    s_nop 7
    s_nop 3
    v_cmp_nge_f32 vcc, s34, v24
    v_mov_b32 v110, v24
    v_mov_b32 v111, v24
    s_cmp_lg_u32 vcc_hi, 0
    s_cbranch_scc1 fk_redo
fk_epi:
    v_permlane32_swap_b32 v110, v111
    s_nop 1
    v_rcp_f32 v112, v111
    s_nop 0
    v_pk_mul_f32 v[12:13], v[12:13], v[112:113] op_sel_hi:[1,0]
    v_pk_mul_f32 v[14:15], v[14:15], v[112:113] op_sel_hi:[1,0]
    v_pk_mul_f32 v[16:17], v[16:17], v[112:113] op_sel_hi:[1,0]
    v_pk_mul_f32 v[18:19], v[18:19], v[112:113] op_sel_hi:[1,0]
    v_pk_mul_f32 v[20:21], v[20:21], v[112:113] op_sel_hi:[1,0]
    v_pk_mul_f32 v[22:23], v[22:23], v[112:113] op_sel_hi:[1,0]
    v_pk_mul_f32 v[24:25], v[24:25], v[112:113] op_sel_hi:[1,0]
    v_pk_mul_f32 v[26:27], v[26:27], v[112:113] op_sel_hi:[1,0]
    v_cvt_pk_bf16_f32 v28, v12, v13
    v_cvt_pk_bf16_f32 v29, v14, v15
    v_cvt_pk_bf16_f32 v30, v16, v17
    v_cvt_pk_bf16_f32 v31, v18, v19
    v_cvt_pk_bf16_f32 v32, v20, v21
    v_cvt_pk_bf16_f32 v33, v22, v23
    v_cvt_pk_bf16_f32 v34, v24, v25
    v_cvt_pk_bf16_f32 v35, v26, v27
    s_mov_b64 exec, s[50:51]
    v_mov_b32 v34, 0
    v_mov_b32 v35, 0
    s_mov_b64 exec, -1
    buffer_store_dwordx4 v[28:31], v1, s[16:19], s37 offen sc1
    buffer_store_dwordx4 v[32:35], v1, s[16:19], s37 offen offset:1024 sc1
    s_mul_i32 s33, s30, 37
    s_lshr_b32 s33, s33, 8
    s_mul_i32 s34, s33, 7
    s_sub_u32 s45, s30, s34
    s_lshl_b32 s44, s29, 2
    s_add_u32 s44, s44, s33
    s_and_b32 s40, s28, 1
    s_lshr_b32 s41, s28, 1
    s_waitcnt vmcnt(0)
    s_barrier
    s_cmp_ge_u32 s30, 28
    s_cbranch_scc1 fk_c_end
    v_lshrrev_b32 v41, 5, v0
    v_bfe_u32 v42, v0, 3, 1
    v_lshlrev_b32 v248, 9, v41
    v_lshl_add_u32 v248, v42, 8, v248
    v_xor_b32 v42, s40, v42
    v_lshl_add_u32 v248, v42, 7, v248
    v_bfe_u32 v42, v0, 2, 1
    v_lshl_add_u32 v248, v42, 6, v248
    v_bfe_u32 v42, v0, 4, 1
    v_lshl_add_u32 v248, v42, 5, v248
    v_and_b32 v42, 3, v0
    v_lshl_add_u32 v248, v42, 3, v248
    s_mul_i32 s33, s40, 28672
    v_add_u32 v248, s33, v248
    v_xor_b32 v249, 0x80, v248
    ds_read_b64_tr_b16 v[120:121], v248 offset:0
    ds_read_b64_tr_b16 v[122:123], v248 offset:1024
    ds_read_b64_tr_b16 v[184:185], v249 offset:0
    ds_read_b64_tr_b16 v[186:187], v249 offset:1024
    ds_read_b64_tr_b16 v[124:125], v248 offset:2048
    ds_read_b64_tr_b16 v[126:127], v248 offset:3072
    ds_read_b64_tr_b16 v[188:189], v249 offset:2048
    ds_read_b64_tr_b16 v[190:191], v249 offset:3072
    ds_read_b64_tr_b16 v[128:129], v248 offset:3584
    ds_read_b64_tr_b16 v[130:131], v248 offset:4608
    ds_read_b64_tr_b16 v[192:193], v249 offset:3584
    ds_read_b64_tr_b16 v[194:195], v249 offset:4608
    s_waitcnt lgkmcnt(4)
    ds_read_b64_tr_b16 v[132:133], v248 offset:5632
    ds_read_b64_tr_b16 v[134:135], v248 offset:6656
    ds_read_b64_tr_b16 v[196:197], v249 offset:5632
    ds_read_b64_tr_b16 v[198:199], v249 offset:6656
    ds_read_b64_tr_b16 v[136:137], v248 offset:7168
    ds_read_b64_tr_b16 v[138:139], v248 offset:8192
    ds_read_b64_tr_b16 v[200:201], v249 offset:7168
    ds_read_b64_tr_b16 v[202:203], v249 offset:8192
    ds_read_b64_tr_b16 v[140:141], v248 offset:9216
    ds_read_b64_tr_b16 v[142:143], v248 offset:10240
    ds_read_b64_tr_b16 v[204:205], v249 offset:9216
    ds_read_b64_tr_b16 v[206:207], v249 offset:10240
    s_waitcnt lgkmcnt(4)
    ds_read_b64_tr_b16 v[144:145], v248 offset:10752
    ds_read_b64_tr_b16 v[146:147], v248 offset:11776
    ds_read_b64_tr_b16 v[208:209], v249 offset:10752
    ds_read_b64_tr_b16 v[210:211], v249 offset:11776
    ds_read_b64_tr_b16 v[148:149], v248 offset:12800
    ds_read_b64_tr_b16 v[150:151], v248 offset:13824
    ds_read_b64_tr_b16 v[212:213], v249 offset:12800
    ds_read_b64_tr_b16 v[214:215], v249 offset:13824
    ds_read_b64_tr_b16 v[152:153], v248 offset:14336
    ds_read_b64_tr_b16 v[154:155], v248 offset:15360
    ds_read_b64_tr_b16 v[216:217], v249 offset:14336
    ds_read_b64_tr_b16 v[218:219], v249 offset:15360
    s_waitcnt lgkmcnt(4)
    ds_read_b64_tr_b16 v[156:157], v248 offset:16384
    ds_read_b64_tr_b16 v[158:159], v248 offset:17408
    ds_read_b64_tr_b16 v[220:221], v249 offset:16384
    ds_read_b64_tr_b16 v[222:223], v249 offset:17408
    ds_read_b64_tr_b16 v[160:161], v248 offset:17920
    ds_read_b64_tr_b16 v[162:163], v248 offset:18944
    ds_read_b64_tr_b16 v[224:225], v249 offset:17920
    ds_read_b64_tr_b16 v[226:227], v249 offset:18944
    ds_read_b64_tr_b16 v[164:165], v248 offset:19968
    ds_read_b64_tr_b16 v[166:167], v248 offset:20992
    ds_read_b64_tr_b16 v[228:229], v249 offset:19968
    ds_read_b64_tr_b16 v[230:231], v249 offset:20992
    s_waitcnt lgkmcnt(4)
    ds_read_b64_tr_b16 v[168:169], v248 offset:21504
    ds_read_b64_tr_b16 v[170:171], v248 offset:22528
    ds_read_b64_tr_b16 v[232:233], v249 offset:21504
    ds_read_b64_tr_b16 v[234:235], v249 offset:22528
    ds_read_b64_tr_b16 v[172:173], v248 offset:23552
    ds_read_b64_tr_b16 v[174:175], v248 offset:24576
    ds_read_b64_tr_b16 v[236:237], v249 offset:23552
    ds_read_b64_tr_b16 v[238:239], v249 offset:24576
    ds_read_b64_tr_b16 v[176:177], v248 offset:25088
    ds_read_b64_tr_b16 v[178:179], v248 offset:26112
    ds_read_b64_tr_b16 v[240:241], v249 offset:25088
    ds_read_b64_tr_b16 v[242:243], v249 offset:26112
    s_waitcnt lgkmcnt(4)
    ds_read_b64_tr_b16 v[180:181], v248 offset:27136
    ds_read_b64_tr_b16 v[182:183], v248 offset:28160
    ds_read_b64_tr_b16 v[244:245], v249 offset:27136
    ds_read_b64_tr_b16 v[246:247], v249 offset:28160
    v_and_b32 v40, 31, v0
    s_mul_i32 s34, s28, 2560
    s_add_u32 s34, s34, 98304
    v_mul_u32_u24 v250, 80, v40
    v_lshl_add_u32 v250, v41, 3, v250
    v_add_u32 v250, s34, v250
    v_lshrrev_b32 v43, 2, v0
    v_mul_u32_u24 v251, 80, v43
    v_lshl_add_u32 v251, v42, 4, v251
    v_add_u32 v251, s34, v251
    v_mul_u32_u24 v252, 1792, v43
    v_lshl_add_u32 v252, v42, 4, v252
    s_lshl_b32 s34, s28, 12
    s_add_u32 s34, s34, 65536
    v_add_u32 v253, s34, v1
    v_xor_b32 v254, 0x1000, v253
    s_lshl_b32 s33, s44, 1
    s_add_u32 s33, s33, s41
    s_lshl_b32 s37, s33, 15
    s_lshl_b32 s34, s40, 14
    s_add_u32 s37, s37, s34
    s_add_u32 s37, s37, 11534336
    s_mul_i32 s42, s33, 57344
    s_lshl_b32 s34, s45, 7
    s_add_u32 s42, s42, s34
    s_lshl_b32 s34, s40, 6
    s_add_u32 s42, s42, s34
    s_add_u32 s36, s42, 28672
    s_waitcnt lgkmcnt(0)
    s_barrier
    buffer_load_dwordx4 v[56:59], v1, s[16:19], s37 offen offset:0 sc1
    buffer_load_dwordx4 v[60:63], v1, s[16:19], s37 offen offset:1024 sc1
    buffer_load_dwordx4 v[64:67], v1, s[16:19], s37 offen offset:2048 sc1
    buffer_load_dwordx4 v[68:71], v1, s[16:19], s37 offen offset:3072 sc1
    s_add_u32 s37, s37, 4096
    buffer_load_dwordx4 v[72:75], v1, s[16:19], s37 offen offset:0 sc1
    buffer_load_dwordx4 v[76:79], v1, s[16:19], s37 offen offset:1024 sc1
    buffer_load_dwordx4 v[80:83], v1, s[16:19], s37 offen offset:2048 sc1
    buffer_load_dwordx4 v[84:87], v1, s[16:19], s37 offen offset:3072 sc1
    s_add_u32 s37, s37, 4096
    buffer_load_dwordx4 v[88:91], v1, s[16:19], s37 offen offset:0 sc1
    buffer_load_dwordx4 v[92:95], v1, s[16:19], s37 offen offset:1024 sc1
    buffer_load_dwordx4 v[96:99], v1, s[16:19], s37 offen offset:2048 sc1
    buffer_load_dwordx4 v[100:103], v1, s[16:19], s37 offen offset:3072 sc1
    s_add_u32 s37, s37, 4096
    buffer_load_dwordx4 v[104:107], v1, s[16:19], s37 offen offset:0 sc1
    buffer_load_dwordx4 v[108:111], v1, s[16:19], s37 offen offset:1024 sc1
    buffer_load_dwordx4 v[112:115], v1, s[16:19], s37 offen offset:2048 sc1
    buffer_load_dwordx4 v[116:119], v1, s[16:19], s37 offen offset:3072 sc1
    s_add_u32 s37, s37, 4096
    s_waitcnt vmcnt(15)
    v_mfma_f32_32x32x16_bf16 v[20:35], v[184:187], v[56:59], 0
    v_mfma_f32_32x32x16_bf16 v[4:19], v[120:123], v[56:59], 0
    s_waitcnt vmcnt(14)
    v_mfma_f32_32x32x16_bf16 v[20:35], v[188:191], v[60:63], v[20:35]
    v_mfma_f32_32x32x16_bf16 v[4:19], v[124:127], v[60:63], v[4:19]
    s_waitcnt vmcnt(13)
    v_mfma_f32_32x32x16_bf16 v[20:35], v[192:195], v[64:67], v[20:35]
    v_mfma_f32_32x32x16_bf16 v[4:19], v[128:131], v[64:67], v[4:19]
    s_waitcnt vmcnt(12)
    v_mfma_f32_32x32x16_bf16 v[20:35], v[196:199], v[68:71], v[20:35]
    v_mfma_f32_32x32x16_bf16 v[4:19], v[132:135], v[68:71], v[4:19]
    s_waitcnt vmcnt(11)
    v_mfma_f32_32x32x16_bf16 v[20:35], v[200:203], v[72:75], v[20:35]
    v_mfma_f32_32x32x16_bf16 v[4:19], v[136:139], v[72:75], v[4:19]
    s_waitcnt vmcnt(10)
    v_mfma_f32_32x32x16_bf16 v[20:35], v[204:207], v[76:79], v[20:35]
    v_mfma_f32_32x32x16_bf16 v[4:19], v[140:143], v[76:79], v[4:19]
    s_waitcnt vmcnt(9)
    v_mfma_f32_32x32x16_bf16 v[20:35], v[208:211], v[80:83], v[20:35]
    v_mfma_f32_32x32x16_bf16 v[4:19], v[144:147], v[80:83], v[4:19]
    s_waitcnt vmcnt(8)
    v_mfma_f32_32x32x16_bf16 v[20:35], v[212:215], v[84:87], v[20:35]
    v_mfma_f32_32x32x16_bf16 v[4:19], v[148:151], v[84:87], v[4:19]
    s_waitcnt vmcnt(7)
    v_mfma_f32_32x32x16_bf16 v[20:35], v[216:219], v[88:91], v[20:35]
    v_mfma_f32_32x32x16_bf16 v[4:19], v[152:155], v[88:91], v[4:19]
    s_waitcnt vmcnt(6)
    v_mfma_f32_32x32x16_bf16 v[20:35], v[220:223], v[92:95], v[20:35]
    v_mfma_f32_32x32x16_bf16 v[4:19], v[156:159], v[92:95], v[4:19]
    s_waitcnt vmcnt(5)
    v_mfma_f32_32x32x16_bf16 v[20:35], v[224:227], v[96:99], v[20:35]
    v_mfma_f32_32x32x16_bf16 v[4:19], v[160:163], v[96:99], v[4:19]
    s_waitcnt vmcnt(4)
    v_mfma_f32_32x32x16_bf16 v[20:35], v[228:231], v[100:103], v[20:35]
    v_mfma_f32_32x32x16_bf16 v[4:19], v[164:167], v[100:103], v[4:19]
    s_waitcnt vmcnt(3)
    v_mfma_f32_32x32x16_bf16 v[20:35], v[232:235], v[104:107], v[20:35]
    v_mfma_f32_32x32x16_bf16 v[4:19], v[168:171], v[104:107], v[4:19]
    s_waitcnt vmcnt(2)
    v_mfma_f32_32x32x16_bf16 v[20:35], v[236:239], v[108:111], v[20:35]
    v_mfma_f32_32x32x16_bf16 v[4:19], v[172:175], v[108:111], v[4:19]
    s_waitcnt vmcnt(1)
    v_mfma_f32_32x32x16_bf16 v[20:35], v[240:243], v[112:115], v[20:35]
    v_mfma_f32_32x32x16_bf16 v[4:19], v[176:179], v[112:115], v[4:19]
    s_waitcnt vmcnt(0)
    v_mfma_f32_32x32x16_bf16 v[20:35], v[244:247], v[116:119], v[20:35]
    v_mfma_f32_32x32x16_bf16 v[4:19], v[180:183], v[116:119], v[4:19]
    s_nop 7
    s_nop 3
    ds_write_b128 v253, v[20:23] offset:0
    ds_write_b128 v253, v[24:27] offset:1024
    ds_write_b128 v253, v[28:31] offset:2048
    ds_write_b128 v253, v[32:35] offset:3072
    s_waitcnt lgkmcnt(0)
    s_barrier
    ds_read_b128 v[20:23], v254 offset:0
    ds_read_b128 v[24:27], v254 offset:1024
    ds_read_b128 v[28:31], v254 offset:2048
    ds_read_b128 v[32:35], v254 offset:3072
    s_waitcnt lgkmcnt(3)
    v_pk_add_f32 v[4:5], v[4:5], v[20:21]
    v_pk_add_f32 v[6:7], v[6:7], v[22:23]
    v_cvt_pk_bf16_f32 v56, v4, v5
    v_cvt_pk_bf16_f32 v57, v6, v7
    s_waitcnt lgkmcnt(2)
    v_pk_add_f32 v[8:9], v[8:9], v[24:25]
    v_pk_add_f32 v[10:11], v[10:11], v[26:27]
    v_cvt_pk_bf16_f32 v58, v8, v9
    v_cvt_pk_bf16_f32 v59, v10, v11
    s_waitcnt lgkmcnt(1)
    v_pk_add_f32 v[12:13], v[12:13], v[28:29]
    v_pk_add_f32 v[14:15], v[14:15], v[30:31]
    v_cvt_pk_bf16_f32 v60, v12, v13
    v_cvt_pk_bf16_f32 v61, v14, v15
    s_waitcnt lgkmcnt(0)
    v_pk_add_f32 v[16:17], v[16:17], v[32:33]
    v_pk_add_f32 v[18:19], v[18:19], v[34:35]
    v_cvt_pk_bf16_f32 v62, v16, v17
    v_cvt_pk_bf16_f32 v63, v18, v19
    ds_write_b64 v250, v[56:57] offset:0
    ds_write_b64 v250, v[58:59] offset:16
    ds_write_b64 v250, v[60:61] offset:32
    ds_write_b64 v250, v[62:63] offset:48
    s_waitcnt lgkmcnt(0)
    ds_read_b128 v[72:75], v251
    ds_read_b128 v[76:79], v251 offset:1280
    s_waitcnt lgkmcnt(1)
    buffer_store_dwordx4 v[72:75], v252, s[12:15], s42 offen
    s_waitcnt lgkmcnt(0)
    buffer_store_dwordx4 v[76:79], v252, s[12:15], s36 offen
fk_c_end:
    s_endpgm
fk_redo:
    s_mov_b64 exec, s[50:51]
    v_mov_b32 v10, 0
    s_mov_b64 exec, -1
    s_mov_b32 s40, s36
    s_mov_b32 s38, 0
fk_redo1:
    buffer_load_dwordx4 v[76:79], v1, s[16:19], s40 offen offset:0 sc1
    buffer_load_dwordx4 v[80:83], v1, s[16:19], s40 offen offset:1024 sc1
    s_waitcnt vmcnt(0)
    v_mfma_f32_32x32x16_bf16 v[44:59], v[76:79], v[4:7], 0
    v_mfma_f32_32x32x16_bf16 v[44:59], v[80:83], v[8:11], v[44:59]
    s_nop 7
    s_nop 3
    v_max3_f32 v108, v44, v45, v108
    v_max3_f32 v108, v46, v47, v108
    v_max3_f32 v108, v48, v49, v108
    v_max3_f32 v108, v50, v51, v108
    v_max3_f32 v108, v52, v53, v108
    v_max3_f32 v108, v54, v55, v108
    v_max3_f32 v108, v56, v57, v108
    v_max3_f32 v108, v58, v59, v108
    s_add_u32 s40, s40, 2048
    s_add_u32 s38, s38, 1
    s_cmp_lt_u32 s38, 64
    s_cbranch_scc1 fk_redo1
    v_mov_b32 v110, v108
    v_mov_b32 v111, v108
    s_nop 1
    v_permlane32_swap_b32 v110, v111
    s_nop 0
    v_max_f32 v108, v110, v111
    v_cvt_pk_bf16_f32 v110, v108, v108
    v_and_b32 v110, 0xffff0000, v110
    v_sub_f32 v111, v108, v110
    s_mov_b64 exec, s[50:51]
    v_cvt_pk_bf16_f32 v10, -v110, -v111
    s_mov_b64 exec, -1
    v_mov_b32 v12, 0
    v_mov_b32 v13, 0
    v_mov_b32 v14, 0
    v_mov_b32 v15, 0
    v_mov_b32 v16, 0
    v_mov_b32 v17, 0
    v_mov_b32 v18, 0
    v_mov_b32 v19, 0
    v_mov_b32 v20, 0
    v_mov_b32 v21, 0
    v_mov_b32 v22, 0
    v_mov_b32 v23, 0
    v_mov_b32 v24, 0
    v_mov_b32 v25, 0
    v_mov_b32 v26, 0
    v_mov_b32 v27, 0
    s_mov_b32 s40, s36
    s_mov_b32 s38, 0
fk_redo2:
    s_add_u32 s41, s40, 2097152
    buffer_load_dwordx4 v[76:79], v1, s[16:19], s40 offen offset:0 sc1
    buffer_load_dwordx4 v[80:83], v1, s[16:19], s40 offen offset:1024 sc1
    buffer_load_dwordx4 v[92:95], v1, s[16:19], s41 offen offset:0 sc1
    buffer_load_dwordx4 v[96:99], v1, s[16:19], s41 offen offset:1024 sc1
    s_waitcnt vmcnt(0)
    v_mfma_f32_32x32x16_bf16 v[28:43], v[76:79], v[4:7], 0
    v_mfma_f32_32x32x16_bf16 v[28:43], v[80:83], v[8:11], v[28:43]
    s_nop 7
    s_nop 3
    v_exp_f32 v28, v28
    v_exp_f32 v29, v29
    v_exp_f32 v30, v30
    v_exp_f32 v31, v31
    v_exp_f32 v32, v32
    v_exp_f32 v33, v33
    v_exp_f32 v34, v34
    v_exp_f32 v35, v35
    v_exp_f32 v36, v36
    v_exp_f32 v37, v37
    v_exp_f32 v38, v38
    v_exp_f32 v39, v39
    v_exp_f32 v40, v40
    v_exp_f32 v41, v41
    v_exp_f32 v42, v42
    v_exp_f32 v43, v43
    s_nop 0
    v_cvt_pk_bf16_f32 v60, v28, v29
    v_cvt_pk_bf16_f32 v61, v30, v31
    v_cvt_pk_bf16_f32 v62, v32, v33
    v_cvt_pk_bf16_f32 v63, v34, v35
    v_cvt_pk_bf16_f32 v64, v36, v37
    v_cvt_pk_bf16_f32 v65, v38, v39
    v_cvt_pk_bf16_f32 v66, v40, v41
    v_cvt_pk_bf16_f32 v67, v42, v43
    s_nop 1
    v_mfma_f32_32x32x16_bf16 v[12:27], v[92:95], v[60:63], v[12:27]
    v_mfma_f32_32x32x16_bf16 v[12:27], v[96:99], v[64:67], v[12:27]
    s_add_u32 s40, s40, 2048
    s_add_u32 s38, s38, 1
    s_cmp_lt_u32 s38, 64
    s_nop 7
    s_cbranch_scc1 fk_redo2
    s_nop 7
    v_mov_b32 v110, v24
    v_mov_b32 v111, v24
    s_nop 1
    s_branch fk_epi
fk_end:
    s_endpgm
.section .rodata,"a"
.p2align 6
.amdhsa_kernel concat_heads__mha_block__spectral_gfnet__prompt_kernel
  .amdhsa_next_free_vgpr 256
  .amdhsa_next_free_sgpr 102
  .amdhsa_accum_offset 256
  .amdhsa_group_segment_fixed_size 0
  .amdhsa_kernarg_size 72
  .amdhsa_user_sgpr_count 2
  .amdhsa_user_sgpr_kernarg_segment_ptr 1
  .amdhsa_system_sgpr_workgroup_id_x 1
.end_amdhsa_kernel
.text
.section .rodata,"a"
.p2align 8
.type ctab,@object
ctab:
.quad 0x3f8000003f80,0x3f8000003f80,0x3dc93f7f00003f80,0x3e953f753e483f7b,0x3e483f7b00003f80,0x3f0e3f553ec43f6d,0x3e953f7500003f80,0x3f463f223f0e3f55
.quad 0x3ec43f6d00003f80,0x3f6d3ec43f353f35,0x3ef13f6200003f80,0x3f7f3dc93f553f0e,0x3f0e3f5500003f80,0x3f7bbe483f6d3ec4,0x3f223f4600003f80,0x3f62bef13f7b3e48
.quad 0x3f353f3500003f80,0x3f35bf353f80248d,0x3f463f2200003f80,0x3ef1bf623f7bbe48,0x3f553f0e00003f80,0x3e48bf7b3f6dbec4,0x3f623ef100003f80,0xbdc9bf7f3f55bf0e
.quad 0x3f6d3ec400003f80,0xbec4bf6d3f35bf35,0x3f753e9500003f80,0xbf22bf463f0ebf55,0x3f7b3e4800003f80,0xbf55bf0e3ec4bf6d,0x3f7f3dc900003f80,0xbf75be953e48bf7b
.quad 0x3f8000003f80,0x3f8000003f80,0x3ef13f623ec43f6d,0x3f223f463f0e3f55,0x3f553f0e3f353f35,0x3f7b3e483f6d3ec4,0x3f7f3dc93f6d3ec4,0x3f62bef13f7bbe48
.quad 0x3f6dbec43f80248d,0x3ec4bf6d3f35bf35,0x3f22bf463f6dbec4,0xbe95bf753e48bf7b,0x3e48bf7b3f35bf35,0xbf55bf0ebec4bf6d,0xbe95bf753ec4bf6d,0xbf7f3dc9bf55bf0e
.quad 0xbf35bf35250dbf80,0xbf353f35bf80a554,0xbf75be95bec4bf6d,0xbdc93f7fbf553f0e,0xbf7b3e48bf35bf35,0x3f0e3f55bec43f6d,0xbf463f22bf6dbec4,0x3f753e953e483f7b
.quad 0xbec43f6dbf80a554,0x3f6dbec43f353f35,0x3dc93f7fbf6d3ec4,0x3ef1bf623f7b3e48,0x3f0e3f55bf353f35,0xbe48bf7b3f6dbec4,0x3f623ef1bec43f6d,0xbf46bf223f0ebf55
.quad 0x3f8000003f80,0x3f8000003f80,0x3f463f223f353f35,0x3f623ef13f553f0e,0x3f7bbe483f80248d,0x3f55bf0e3f6dbec4,0x3ef1bf623f35bf35,0xbdc9bf7f3e48bf7b
.quad 0xbec4bf6d250dbf80,0xbf6dbec4bf35bf35,0xbf75be95bf35bf35,0xbf463f22bf7b3e48,0xbf553f0ebf80a554,0x3e483f7bbec43f6d,0xbdc93f7fbf353f35,0x3f753e953f0e3f55
.quad 0x3f353f3500003f80,0x3f35bf353f80248d,0x3f7fbdc93f353f35,0xbe95bf753f0ebf55,0x3f0ebf553f80248d,0xbf7bbe48bec4bf6d,0xbe95bf753f35bf35,0xbf223f46bf7bbe48
.quad 0xbf6dbec4250dbf80,0x3ec43f6dbf353f35,0xbf623ef1bf35bf35,0x3f7f3dc93e483f7b,0xbe483f7bbf80a554,0x3f0ebf553f6d3ec4,0x3f223f46bf353f35,0xbef1bf623f55bf0e
.quad 0x3f8000003f80,0x3f8000003f80,0x3f753e953f6d3ec4,0x3f7f3dc93f7b3e48,0x3f0ebf553f35bf35,0x3e48bf7b3ec4bf6d,0xbf22bf46bec4bf6d,0xbf75be95bf55bf0e
.quad 0xbf6d3ec4bf80a554,0xbec43f6dbf353f35,0x3dc93f7fbec43f6d,0x3f623ef13f0e3f55,0x3f7b3e483f353f35,0x3f0ebf553f6dbec4,0x3ef1bf623f6dbec4,0xbf46bf22be48bf7b
.quad 0xbf35bf35250dbf80,0xbf353f35bf80a554,0xbf623ef1bf6dbec4,0x3f223f46be483f7b,0x3e483f7bbf353f35,0x3f55bf0e3f6d3ec4,0x3f7f3dc93ec43f6d,0xbef1bf623f0ebf55
.quad 0x3ec4bf6d3f80248d,0xbf6d3ec4bf35bf35,0xbf46bf223ec4bf6d,0x3e953f75bf553f0e,0xbf553f0ebf35bf35,0x3f7bbe483ec43f6d,0x3e953f75bf6d3ec4,0xbdc9bf7f3f7bbe48
.quad 0x3f8000003f80,0x3f8000003f80,0x3f7fbdc93f80248d,0x3f75be953f7bbe48,0xbe48bf7b250dbf80,0xbf0ebf55bec4bf6d,0xbf753e95bf80a554,0xbf223f46bf553f0e
.quad 0x3ec43f6d00003f80,0x3f6d3ec43f353f35,0x3f62bef13f80248d,0x3dc9bf7f3f0ebf55,0xbf0ebf55250dbf80,0xbf7b3e48bf6dbec4,0xbf463f22bf80a554,0x3ef13f62be483f7b
.quad 0x3f353f3500003f80,0x3f35bf353f80248d,0x3f22bf463f80248d,0xbf62bef1be48bf7b,0xbf55bf0e250dbf80,0xbe483f7bbf6d3ec4,0xbef13f62bf80a554,0x3f7fbdc93f0e3f55
.quad 0x3f6d3ec400003f80,0xbec4bf6d3f35bf35,0x3e95bf753f80248d,0xbf463f22bf55bf0e,0xbf7bbe48250dbf80,0x3f553f0ebec43f6d,0xbdc93f7fbf80a554,0x3e95bf753f7b3e48
.quad 0x3f8000003f80,0x3f8000003f80,0x3f62bef13f6dbec4,0x3f46bf223f55bf0e,0xbf55bf0ebf35bf35,0xbf7bbe48bf6dbec4,0xbdc93f7fbec43f6d,0x3ef13f623e483f7b
.quad 0x3f6dbec43f80248d,0x3ec4bf6d3f35bf35,0xbf46bf22bec4bf6d,0xbf753e95bf7bbe48,0xbe483f7bbf353f35,0x3f553f0e3ec43f6d,0x3f75be953f6d3ec4,0xbdc9bf7f3f0ebf55
.quad 0xbf35bf35250dbf80,0xbf353f35bf80a554,0xbe953f75bf6d3ec4,0x3f7f3dc93f0e3f55,0x3f7bbe483f353f35,0xbf0ebf553ec4bf6d,0xbf22bf463ec4bf6d,0xbe953f75bf7b3e48
.quad 0xbec43f6dbf80a554,0x3f6dbec43f353f35,0x3f7fbdc93ec43f6d,0xbf62bef13e48bf7b,0xbf0ebf553f35bf35,0x3e483f7bbf6d3ec4,0xbef13f62bf6dbec4,0x3f22bf463f553f0e
.quad 0x3f8000003f80,0x3f8000003f80,0x3f22bf463f35bf35,0x3ef1bf623f0ebf55,0xbf7b3e48bf80a554,0xbf553f0ebf6d3ec4,0x3f623ef13f353f35,0x3f7fbdc93f7b3e48
.quad 0xbec4bf6d250dbf80,0xbf6dbec4bf35bf35,0xbe953f75bf353f35,0x3f223f463e483f7b,0x3f55bf0e3f80248d,0xbe48bf7b3ec4bf6d,0xbf7fbdc9bf35bf35,0xbe953f75bf553f0e
.quad 0x3f353f3500003f80,0x3f35bf353f80248d,0xbdc9bf7f3f35bf35,0xbf753e95bf55bf0e,0xbf0e3f55bf80a554,0x3f7b3e483ec43f6d,0x3f75be953f353f35,0xbf46bf223e48bf7b
.quad 0xbf6dbec4250dbf80,0x3ec43f6dbf353f35,0x3ef13f62bf353f35,0x3dc9bf7f3f7bbe48,0x3e48bf7b3f80248d,0xbf0e3f55bf6dbec4,0xbf463f22bf35bf35,0x3f62bef13f0e3f55
.quad 0x3f8000003f80,0x3f8000003f80,0x3e95bf753ec4bf6d,0x3dc9bf7f3e48bf7b,0xbf0e3f55bf353f35,0xbe483f7bbec43f6d,0x3f46bf223f6dbec4,0x3e95bf753f0ebf55
.quad 0xbf6d3ec4bf80a554,0xbec43f6dbf353f35,0x3f7fbdc93f6d3ec4,0x3ef1bf623f55bf0e,0xbf7bbe48bf35bf35,0xbf0e3f55bf6d3ec4,0x3f623ef13ec43f6d,0x3f22bf463f7bbe48
.quad 0xbf35bf35250dbf80,0xbf353f35bf80a554,0x3ef13f62bec43f6d,0x3f46bf223f7b3e48,0xbe48bf7b3f35bf35,0xbf553f0ebf6dbec4,0xbdc93f7fbf6d3ec4,0x3f62bef13f553f0e
.quad 0x3ec4bf6d3f80248d,0xbf6d3ec4bf35bf35,0xbf223f46bf6dbec4,0x3f75be953f0e3f55,0x3f55bf0e3f353f35,0xbf7b3e48bec4bf6d,0xbf753e95bec4bf6d,0x3f7fbdc93e483f7b
.quad 0x3f8000003f80,0x3f8000003f80,0xbdc9bf7f250dbf80,0xbe95bf75be48bf7b,0x3e483f7b00003f80,0x3f0e3f553ec43f6d,0xbe95bf75250dbf80,0xbf46bf22bf0ebf55
.quad 0x3ec43f6d00003f80,0x3f6d3ec43f353f35,0xbef1bf62250dbf80,0xbf7fbdc9bf55bf0e,0x3f0e3f5500003f80,0x3f7bbe483f6d3ec4,0xbf22bf46250dbf80,0xbf623ef1bf7bbe48
.quad 0x3f353f3500003f80,0x3f35bf353f80248d,0xbf46bf22250dbf80,0xbef13f62bf7b3e48,0x3f553f0e00003f80,0x3e48bf7b3f6dbec4,0xbf62bef1250dbf80,0x3dc93f7fbf553f0e
.quad 0x3f6d3ec400003f80,0xbec4bf6d3f35bf35,0xbf75be95250dbf80,0x3f223f46bf0e3f55,0x3f7b3e4800003f80,0xbf55bf0e3ec4bf6d,0xbf7fbdc9250dbf80,0x3f753e95be483f7b
.quad 0x3f8000003f80,0x3f8000003f80,0xbef1bf62bec4bf6d,0xbf22bf46bf0ebf55,0x3f553f0e3f353f35,0x3f7b3e483f6d3ec4,0xbf7fbdc9bf6dbec4,0xbf623ef1bf7b3e48
.quad 0x3f6dbec43f80248d,0x3ec4bf6d3f35bf35,0xbf223f46bf6d3ec4,0x3e953f75be483f7b,0x3e48bf7b3f35bf35,0xbf55bf0ebec4bf6d,0x3e953f75bec43f6d,0x3f7fbdc93f553f0e
.quad 0xbf35bf35250dbf80,0xbf353f35bf80a554,0x3f753e953ec43f6d,0x3dc9bf7f3f55bf0e,0xbf7b3e48bf35bf35,0x3f0e3f55bec43f6d,0x3f46bf223f6d3ec4,0xbf75be95be48bf7b
.quad 0xbec43f6dbf80a554,0x3f6dbec43f353f35,0xbdc9bf7f3f6dbec4,0xbef13f62bf7bbe48,0x3f0e3f55bf353f35,0xbe48bf7b3f6dbec4,0xbf62bef13ec4bf6d,0x3f463f22bf0e3f55
.quad 0x3f8000003f80,0x3f8000003f80,0xbf46bf22bf35bf35,0xbf62bef1bf55bf0e,0x3f7bbe483f80248d,0x3f55bf0e3f6dbec4,0xbef13f62bf353f35,0x3dc93f7fbe483f7b
.quad 0xbec4bf6d250dbf80,0xbf6dbec4bf35bf35,0x3f753e953f353f35,0x3f46bf223f7bbe48,0xbf553f0ebf80a554,0x3e483f7bbec43f6d,0x3dc9bf7f3f35bf35,0xbf75be95bf0ebf55
.quad 0x3f353f3500003f80,0x3f35bf353f80248d,0xbf7f3dc9bf35bf35,0x3e953f75bf0e3f55,0x3f0ebf553f80248d,0xbf7bbe48bec4bf6d,0x3e953f75bf353f35,0x3f22bf463f7b3e48
.quad 0xbf6dbec4250dbf80,0x3ec43f6dbf353f35,0x3f62bef13f353f35,0xbf7fbdc9be48bf7b,0xbe483f7bbf80a554,0x3f0ebf553f6d3ec4,0xbf22bf463f35bf35,0x3ef13f62bf553f0e
.quad 0x3f8000003f80,0x3f8000003f80,0xbf75be95bf6dbec4,0xbf7fbdc9bf7bbe48,0x3f0ebf553f35bf35,0x3e48bf7b3ec4bf6d,0x3f223f463ec43f6d,0x3f753e953f553f0e
.quad 0xbf6d3ec4bf80a554,0xbec43f6dbf353f35,0xbdc9bf7f3ec4bf6d,0xbf62bef1bf0ebf55,0x3f7b3e483f353f35,0x3f0ebf553f6dbec4,0xbef13f62bf6d3ec4,0x3f463f223e483f7b
.quad 0xbf35bf35250dbf80,0xbf353f35bf80a554,0x3f62bef13f6d3ec4,0xbf22bf463e48bf7b,0x3e483f7bbf353f35,0x3f55bf0e3f6d3ec4,0xbf7fbdc9bec4bf6d,0x3ef13f62bf0e3f55
.quad 0x3ec4bf6d3f80248d,0xbf6d3ec4bf35bf35,0x3f463f22bec43f6d,0xbe95bf753f55bf0e,0xbf553f0ebf35bf35,0x3f7bbe483ec43f6d,0xbe95bf753f6dbec4,0x3dc93f7fbf7b3e48
.quad 0x3f8000003f80,0x3f8000003f80,0xbf7f3dc9bf80a554,0xbf753e95bf7b3e48,0xbe48bf7b250dbf80,0xbf0ebf55bec4bf6d,0x3f75be953f80248d,0x3f22bf463f55bf0e
.quad 0x3ec43f6d00003f80,0x3f6d3ec43f353f35,0xbf623ef1bf80a554,0xbdc93f7fbf0e3f55,0xbf0ebf55250dbf80,0xbf7b3e48bf6dbec4,0x3f46bf223f80248d,0xbef1bf623e48bf7b
.quad 0x3f353f3500003f80,0x3f35bf353f80248d,0xbf223f46bf80a554,0x3f623ef13e483f7b,0xbf55bf0e250dbf80,0xbe483f7bbf6d3ec4,0x3ef1bf623f80248d,0xbf7f3dc9bf0ebf55
.quad 0x3f6d3ec400003f80,0xbec4bf6d3f35bf35,0xbe953f75bf80a554,0x3f46bf223f553f0e,0xbf7bbe48250dbf80,0x3f553f0ebec43f6d,0x3dc9bf7f3f80248d,0xbe953f75bf7bbe48
.quad 0x3f8000003f80,0x3f8000003f80,0xbf623ef1bf6d3ec4,0xbf463f22bf553f0e,0xbf55bf0ebf35bf35,0xbf7bbe48bf6dbec4,0x3dc9bf7f3ec4bf6d,0xbef1bf62be48bf7b
.quad 0x3f6dbec43f80248d,0x3ec4bf6d3f35bf35,0x3f463f223ec43f6d,0x3f75be953f7b3e48,0xbe483f7bbf353f35,0x3f553f0e3ec43f6d,0xbf753e95bf6dbec4,0x3dc93f7fbf0e3f55
.quad 0xbf35bf35250dbf80,0xbf353f35bf80a554,0x3e95bf753f6dbec4,0xbf7fbdc9bf0ebf55,0x3f7bbe483f353f35,0xbf0ebf553ec4bf6d,0x3f223f46bec43f6d,0x3e95bf753f7bbe48
.quad 0xbec43f6dbf80a554,0x3f6dbec43f353f35,0xbf7f3dc9bec4bf6d,0x3f623ef1be483f7b,0xbf0ebf553f35bf35,0x3e483f7bbf6d3ec4,0x3ef1bf623f6d3ec4,0xbf223f46bf55bf0e
.quad 0x3f8000003f80,0x3f8000003f80,0xbf223f46bf353f35,0xbef13f62bf0e3f55,0xbf7b3e48bf80a554,0xbf553f0ebf6d3ec4,0xbf62bef1bf35bf35,0xbf7f3dc9bf7bbe48
.quad 0xbec4bf6d250dbf80,0xbf6dbec4bf35bf35,0x3e95bf753f35bf35,0xbf22bf46be48bf7b,0x3f55bf0e3f80248d,0xbe48bf7b3ec4bf6d,0x3f7f3dc93f353f35,0x3e95bf753f55bf0e
.quad 0x3f353f3500003f80,0x3f35bf353f80248d,0x3dc93f7fbf353f35,0x3f75be953f553f0e,0xbf0e3f55bf80a554,0x3f7b3e483ec43f6d,0xbf753e95bf35bf35,0x3f463f22be483f7b
.quad 0xbf6dbec4250dbf80,0x3ec43f6dbf353f35,0xbef1bf623f35bf35,0xbdc93f7fbf7b3e48,0x3e48bf7b3f80248d,0xbf0e3f55bf6dbec4,0x3f46bf223f353f35,0xbf623ef1bf0ebf55
.quad 0x3f8000003f80,0x3f8000003f80,0xbe953f75bec43f6d,0xbdc93f7fbe483f7b,0xbf0e3f55bf353f35,0xbe483f7bbec43f6d,0xbf463f22bf6d3ec4,0xbe953f75bf0e3f55
.quad 0xbf6d3ec4bf80a554,0xbec43f6dbf353f35,0xbf7f3dc9bf6dbec4,0xbef13f62bf553f0e,0xbf7bbe48bf35bf35,0xbf0e3f55bf6d3ec4,0xbf62bef1bec4bf6d,0xbf223f46bf7b3e48
.quad 0xbf35bf35250dbf80,0xbf353f35bf80a554,0xbef1bf623ec4bf6d,0xbf463f22bf7bbe48,0xbe48bf7b3f35bf35,0xbf553f0ebf6dbec4,0x3dc9bf7f3f6dbec4,0xbf623ef1bf55bf0e
.quad 0x3ec4bf6d3f80248d,0xbf6d3ec4bf35bf35,0x3f22bf463f6d3ec4,0xbf753e95bf0ebf55,0x3f55bf0e3f353f35,0xbf7b3e48bec4bf6d,0x3f75be953ec43f6d,0xbf7f3dc9be48bf7b
.quad 0x3f8080003f808000,0x3f8080003f808000,0x3f7fbdc93f808000,0x3f75be953f7bbe48,0x3f7bbe483f808000,0x3f55bf0e3f6dbec4,0x3f75be953f808000,0x3f22bf463f55bf0e
.quad 0x3f6dbec43f808000,0x3ec4bf6d3f35bf35,0x3f62bef13f808000,0x3dc9bf7f3f0ebf55,0x3f55bf0e3f808000,0xbe48bf7b3ec4bf6d,0x3f46bf223f808000,0xbef1bf623e48bf7b
.quad 0x3f35bf353f808000,0xbf35bf35248dbf80,0x3f22bf463f808000,0xbf62bef1be48bf7b,0x3f0ebf553f808000,0xbf7bbe48bec4bf6d,0x3ef1bf623f808000,0xbf7f3dc9bf0ebf55
.quad 0x3ec4bf6d3f808000,0xbf6d3ec4bf35bf35,0x3e95bf753f808000,0xbf463f22bf55bf0e,0x3e48bf7b3f808000,0xbf0e3f55bf6dbec4,0x3dc9bf7f3f808000,0xbe953f75bf7bbe48
.quad 0x3f8080003f808000,0x3f8080003f808000,0x3f62bef13f6dbec4,0x3f46bf223f55bf0e,0x3f0ebf553f35bf35,0x3e48bf7b3ec4bf6d,0x3dc9bf7f3ec4bf6d,0xbef1bf62be48bf7b
.quad 0xbec4bf6d248dbf80,0xbf6dbec4bf35bf35,0xbf46bf22bec4bf6d,0xbf753e95bf7bbe48,0xbf7bbe48bf35bf35,0xbf0e3f55bf6d3ec4,0xbf753e95bf6dbec4,0x3dc93f7fbf0e3f55
.quad 0xbf353f35bf80a50d,0x3f353f35a5543f80,0xbe953f75bf6d3ec4,0x3f7f3dc93f0e3f55,0x3e483f7bbf353f35,0x3f55bf0e3f6d3ec4,0x3f223f46bec43f6d,0x3e95bf753f7bbe48
.quad 0x3f6d3ec4a5543f80,0xbec4bf6d3f35bf35,0x3f7fbdc93ec43f6d,0xbf62bef13e48bf7b,0x3f55bf0e3f353f35,0xbf7b3e48bec4bf6d,0x3ef1bf623f6d3ec4,0xbf223f46bf55bf0e
.quad 0x3f8080003f808000,0x3f8080003f808000,0x3f22bf463f35bf35,0x3ef1bf623f0ebf55,0xbe48bf7b248dbf80,0xbf0ebf55bec4bf6d,0xbf62bef1bf35bf35,0xbf7f3dc9bf7bbe48
.quad 0xbf6d3ec4bf80a50d,0xbec43f6dbf353f35,0xbe953f75bf353f35,0x3f223f463e483f7b,0x3f0e3f55a5543f80,0x3f7bbe483f6d3ec4,0x3f7f3dc93f353f35,0x3e95bf753f55bf0e
.quad 0x3f35bf353f808000,0xbf35bf35248dbf80,0xbdc9bf7f3f35bf35,0xbf753e95bf55bf0e,0xbf55bf0e248dbf80,0xbe483f7bbf6d3ec4,0xbf753e95bf35bf35,0x3f463f22be483f7b
.quad 0xbec43f6dbf80a50d,0x3f6dbec43f353f35,0x3ef13f62bf353f35,0x3dc9bf7f3f7bbe48,0x3f7b3e48a5543f80,0xbf55bf0e3ec4bf6d,0x3f46bf223f353f35,0xbf623ef1bf0ebf55
.quad 0x3f8080003f808000,0x3f8080003f808000,0x3e95bf753ec4bf6d,0x3dc9bf7f3e48bf7b,0xbf55bf0ebf35bf35,0xbf7bbe48bf6dbec4,0xbf463f22bf6d3ec4,0xbe953f75bf0e3f55
.quad 0x3ec43f6da5543f80,0x3f6d3ec43f353f35,0x3f7fbdc93f6d3ec4,0x3ef1bf623f55bf0e,0x3e48bf7b3f35bf35,0xbf55bf0ebec4bf6d,0xbf62bef1bec4bf6d,0xbf223f46bf7b3e48
.quad 0xbf353f35bf80a50d,0x3f353f35a5543f80,0x3ef13f62bec43f6d,0x3f46bf223f7b3e48,0x3f7bbe483f353f35,0xbf0ebf553ec4bf6d,0x3dc9bf7f3f6dbec4,0xbf623ef1bf55bf0e
.quad 0xbf6dbec4248dbf80,0x3ec43f6dbf353f35,0xbf223f46bf6dbec4,0x3f75be953f0e3f55,0x3f0e3f55bf353f35,0xbe48bf7b3f6dbec4,0x3f75be953ec43f6d,0xbf7f3dc9be48bf7b
.quad 0x3f8080003f808000,0x3f8080003f808000,0xbdc9bf7f248dbf80,0xbe95bf75be48bf7b,0xbf7b3e48bf80a50d,0xbf553f0ebf6d3ec4,0x3e953f75a5543f80,0x3f463f223f0e3f55
.quad 0x3f6dbec43f808000,0x3ec4bf6d3f35bf35,0xbef1bf62248dbf80,0xbf7fbdc9bf55bf0e,0xbf553f0ebf80a50d,0x3e483f7bbec43f6d,0x3f223f46a5543f80,0x3f62bef13f7b3e48
.quad 0x3f35bf353f808000,0xbf35bf35248dbf80,0xbf46bf22248dbf80,0xbef13f62bf7b3e48,0xbf0e3f55bf80a50d,0x3f7b3e483ec43f6d,0x3f623ef1a5543f80,0xbdc9bf7f3f55bf0e
.quad 0x3ec4bf6d3f808000,0xbf6d3ec4bf35bf35,0xbf75be95248dbf80,0x3f223f46bf0e3f55,0xbe483f7bbf80a50d,0x3f0ebf553f6d3ec4,0x3f7f3dc9a5543f80,0xbf75be953e48bf7b
.quad 0x3f8080003f808000,0x3f8080003f808000,0xbef1bf62bec4bf6d,0xbf22bf46bf0ebf55,0xbf0e3f55bf353f35,0xbe483f7bbec43f6d,0x3f7f3dc93f6d3ec4,0x3f62bef13f7bbe48
.quad 0xbec4bf6d248dbf80,0xbf6dbec4bf35bf35,0xbf223f46bf6d3ec4,0x3e953f75be483f7b,0x3f7b3e483f353f35,0x3f0ebf553f6dbec4,0xbe95bf753ec4bf6d,0xbf7f3dc9bf55bf0e
.quad 0xbf353f35bf80a50d,0x3f353f35a5543f80,0x3f753e953ec43f6d,0x3dc9bf7f3f55bf0e,0xbe48bf7b3f35bf35,0xbf553f0ebf6dbec4,0xbf463f22bf6dbec4,0x3f753e953e483f7b
.quad 0x3f6d3ec4a5543f80,0xbec4bf6d3f35bf35,0xbdc9bf7f3f6dbec4,0xbef13f62bf7bbe48,0xbf553f0ebf35bf35,0x3f7bbe483ec43f6d,0x3f623ef1bec43f6d,0xbf46bf223f0ebf55
.quad 0x3f8080003f808000,0x3f8080003f808000,0xbf46bf22bf35bf35,0xbf62bef1bf55bf0e,0x3e483f7ba5543f80,0x3f0e3f553ec43f6d,0x3ef1bf623f35bf35,0xbdc9bf7f3e48bf7b
.quad 0xbf6d3ec4bf80a50d,0xbec43f6dbf353f35,0x3f753e953f353f35,0x3f46bf223f7bbe48,0xbf0ebf55248dbf80,0xbf7b3e48bf6dbec4,0xbdc93f7fbf353f35,0x3f753e953f0e3f55
.quad 0x3f35bf353f808000,0xbf35bf35248dbf80,0xbf7f3dc9bf35bf35,0x3e953f75bf0e3f55,0x3f553f0ea5543f80,0x3e48bf7b3f6dbec4,0xbe95bf753f35bf35,0xbf223f46bf7bbe48
.quad 0xbec43f6dbf80a50d,0x3f6dbec43f353f35,0x3f62bef13f353f35,0xbf7fbdc9be48bf7b,0xbf7bbe48248dbf80,0x3f553f0ebec43f6d,0x3f223f46bf353f35,0xbef1bf623f55bf0e
.quad 0x3f8080003f808000,0x3f8080003f808000,0xbf75be95bf6dbec4,0xbf7fbdc9bf7bbe48,0x3f553f0e3f353f35,0x3f7b3e483f6d3ec4,0xbf22bf46bec4bf6d,0xbf75be95bf55bf0e
.quad 0x3ec43f6da5543f80,0x3f6d3ec43f353f35,0xbdc9bf7f3ec4bf6d,0xbf62bef1bf0ebf55,0xbe483f7bbf353f35,0x3f553f0e3ec43f6d,0x3ef1bf623f6dbec4,0xbf46bf22be48bf7b
.quad 0xbf353f35bf80a50d,0x3f353f35a5543f80,0x3f62bef13f6d3ec4,0xbf22bf463e48bf7b,0xbf7b3e48bf35bf35,0x3f0e3f55bec43f6d,0x3f7f3dc93ec43f6d,0xbef1bf623f0ebf55
.quad 0xbf6dbec4248dbf80,0x3ec43f6dbf353f35,0x3f463f22bec43f6d,0xbe95bf753f55bf0e,0xbf0ebf553f35bf35,0x3e483f7bbf6d3ec4,0x3e953f75bf6d3ec4,0xbdc9bf7f3f7bbe48
.quad 0x3f8080003f808000,0x3f8080003f808000,0xbf7f3dc9bf80a50d,0xbf753e95bf7b3e48,0x3f7bbe483f808000,0x3f55bf0e3f6dbec4,0xbf753e95bf80a50d,0xbf223f46bf553f0e
.quad 0x3f6dbec43f808000,0x3ec4bf6d3f35bf35,0xbf623ef1bf80a50d,0xbdc93f7fbf0e3f55,0x3f55bf0e3f808000,0xbe48bf7b3ec4bf6d,0xbf463f22bf80a50d,0x3ef13f62be483f7b
.quad 0x3f35bf353f808000,0xbf35bf35248dbf80,0xbf223f46bf80a50d,0x3f623ef13e483f7b,0x3f0ebf553f808000,0xbf7bbe48bec4bf6d,0xbef13f62bf80a50d,0x3f7fbdc93f0e3f55
.quad 0x3ec4bf6d3f808000,0xbf6d3ec4bf35bf35,0xbe953f75bf80a50d,0x3f46bf223f553f0e,0x3e48bf7b3f808000,0xbf0e3f55bf6dbec4,0xbdc93f7fbf80a50d,0x3e95bf753f7b3e48
.quad 0x3f8080003f808000,0x3f8080003f808000,0xbf623ef1bf6d3ec4,0xbf463f22bf553f0e,0x3f0ebf553f35bf35,0x3e48bf7b3ec4bf6d,0xbdc93f7fbec43f6d,0x3ef13f623e483f7b
.quad 0xbec4bf6d248dbf80,0xbf6dbec4bf35bf35,0x3f463f223ec43f6d,0x3f75be953f7b3e48,0xbf7bbe48bf35bf35,0xbf0e3f55bf6d3ec4,0x3f75be953f6d3ec4,0xbdc9bf7f3f0ebf55
.quad 0xbf353f35bf80a50d,0x3f353f35a5543f80,0x3e95bf753f6dbec4,0xbf7fbdc9bf0ebf55,0x3e483f7bbf353f35,0x3f55bf0e3f6d3ec4,0xbf22bf463ec4bf6d,0xbe953f75bf7b3e48
.quad 0x3f6d3ec4a5543f80,0xbec4bf6d3f35bf35,0xbf7f3dc9bec4bf6d,0x3f623ef1be483f7b,0x3f55bf0e3f353f35,0xbf7b3e48bec4bf6d,0xbef13f62bf6dbec4,0x3f22bf463f553f0e
.quad 0x3f8080003f808000,0x3f8080003f808000,0xbf223f46bf353f35,0xbef13f62bf0e3f55,0xbe48bf7b248dbf80,0xbf0ebf55bec4bf6d,0x3f623ef13f353f35,0x3f7fbdc93f7b3e48
.quad 0xbf6d3ec4bf80a50d,0xbec43f6dbf353f35,0x3e95bf753f35bf35,0xbf22bf46be48bf7b,0x3f0e3f55a5543f80,0x3f7bbe483f6d3ec4,0xbf7fbdc9bf35bf35,0xbe953f75bf553f0e
.quad 0x3f35bf353f808000,0xbf35bf35248dbf80,0x3dc93f7fbf353f35,0x3f75be953f553f0e,0xbf55bf0e248dbf80,0xbe483f7bbf6d3ec4,0x3f75be953f353f35,0xbf46bf223e48bf7b
.quad 0xbec43f6dbf80a50d,0x3f6dbec43f353f35,0xbef1bf623f35bf35,0xbdc93f7fbf7b3e48,0x3f7b3e48a5543f80,0xbf55bf0e3ec4bf6d,0xbf463f22bf35bf35,0x3f62bef13f0e3f55
.quad 0x3f8080003f808000,0x3f8080003f808000,0xbe953f75bec43f6d,0xbdc93f7fbe483f7b,0xbf55bf0ebf35bf35,0xbf7bbe48bf6dbec4,0x3f46bf223f6dbec4,0x3e95bf753f0ebf55
.quad 0x3ec43f6da5543f80,0x3f6d3ec43f353f35,0xbf7f3dc9bf6dbec4,0xbef13f62bf553f0e,0x3e48bf7b3f35bf35,0xbf55bf0ebec4bf6d,0x3f623ef13ec43f6d,0x3f22bf463f7bbe48
.quad 0xbf353f35bf80a50d,0x3f353f35a5543f80,0xbef1bf623ec4bf6d,0xbf463f22bf7bbe48,0x3f7bbe483f353f35,0xbf0ebf553ec4bf6d,0xbdc93f7fbf6d3ec4,0x3f62bef13f553f0e
.quad 0xbf6dbec4248dbf80,0x3ec43f6dbf353f35,0x3f22bf463f6d3ec4,0xbf753e95bf0ebf55,0x3f0e3f55bf353f35,0xbe48bf7b3f6dbec4,0xbf753e95bec4bf6d,0x3f7fbdc93e483f7b
.quad 0x3f8080003f808000,0x3f8080003f808000,0x3dc93f7fa5543f80,0x3e953f753e483f7b,0xbf7b3e48bf80a50d,0xbf553f0ebf6d3ec4,0xbe95bf75248dbf80,0xbf46bf22bf0ebf55
.quad 0x3f6dbec43f808000,0x3ec4bf6d3f35bf35,0x3ef13f62a5543f80,0x3f7f3dc93f553f0e,0xbf553f0ebf80a50d,0x3e483f7bbec43f6d,0xbf22bf46248dbf80,0xbf623ef1bf7bbe48
.quad 0x3f35bf353f808000,0xbf35bf35248dbf80,0x3f463f22a5543f80,0x3ef1bf623f7bbe48,0xbf0e3f55bf80a50d,0x3f7b3e483ec43f6d,0xbf62bef1248dbf80,0x3dc93f7fbf553f0e
.quad 0x3ec4bf6d3f808000,0xbf6d3ec4bf35bf35,0x3f753e95a5543f80,0xbf22bf463f0ebf55,0xbe483f7bbf80a50d,0x3f0ebf553f6d3ec4,0xbf7fbdc9248dbf80,0x3f753e95be483f7b
.quad 0x3f8080003f808000,0x3f8080003f808000,0x3ef13f623ec43f6d,0x3f223f463f0e3f55,0xbf0e3f55bf353f35,0xbe483f7bbec43f6d,0xbf7fbdc9bf6dbec4,0xbf623ef1bf7b3e48
.quad 0xbec4bf6d248dbf80,0xbf6dbec4bf35bf35,0x3f22bf463f6dbec4,0xbe95bf753e48bf7b,0x3f7b3e483f353f35,0x3f0ebf553f6dbec4,0x3e953f75bec43f6d,0x3f7fbdc93f553f0e
.quad 0xbf353f35bf80a50d,0x3f353f35a5543f80,0xbf75be95bec4bf6d,0xbdc93f7fbf553f0e,0xbe48bf7b3f35bf35,0xbf553f0ebf6dbec4,0x3f46bf223f6d3ec4,0xbf75be95be48bf7b
.quad 0x3f6d3ec4a5543f80,0xbec4bf6d3f35bf35,0x3dc93f7fbf6d3ec4,0x3ef1bf623f7b3e48,0xbf553f0ebf35bf35,0x3f7bbe483ec43f6d,0xbf62bef13ec4bf6d,0x3f463f22bf0e3f55
.quad 0x3f8080003f808000,0x3f8080003f808000,0x3f463f223f353f35,0x3f623ef13f553f0e,0x3e483f7ba5543f80,0x3f0e3f553ec43f6d,0xbef13f62bf353f35,0x3dc93f7fbe483f7b
.quad 0xbf6d3ec4bf80a50d,0xbec43f6dbf353f35,0xbf75be95bf35bf35,0xbf463f22bf7b3e48,0xbf0ebf55248dbf80,0xbf7b3e48bf6dbec4,0x3dc9bf7f3f35bf35,0xbf75be95bf0ebf55
.quad 0x3f35bf353f808000,0xbf35bf35248dbf80,0x3f7fbdc93f353f35,0xbe95bf753f0ebf55,0x3f553f0ea5543f80,0x3e48bf7b3f6dbec4,0x3e953f75bf353f35,0x3f22bf463f7b3e48
.quad 0xbec43f6dbf80a50d,0x3f6dbec43f353f35,0xbf623ef1bf35bf35,0x3f7f3dc93e483f7b,0xbf7bbe48248dbf80,0x3f553f0ebec43f6d,0xbf22bf463f35bf35,0x3ef13f62bf553f0e
.quad 0x3f8080003f808000,0x3f8080003f808000,0x3f753e953f6d3ec4,0x3f7f3dc93f7b3e48,0x3f553f0e3f353f35,0x3f7b3e483f6d3ec4,0x3f223f463ec43f6d,0x3f753e953f553f0e
.quad 0x3ec43f6da5543f80,0x3f6d3ec43f353f35,0x3dc93f7fbec43f6d,0x3f623ef13f0e3f55,0xbe483f7bbf353f35,0x3f553f0e3ec43f6d,0xbef13f62bf6d3ec4,0x3f463f223e483f7b
.quad 0xbf353f35bf80a50d,0x3f353f35a5543f80,0xbf623ef1bf6dbec4,0x3f223f46be483f7b,0xbf7b3e48bf35bf35,0x3f0e3f55bec43f6d,0xbf7fbdc9bec4bf6d,0x3ef13f62bf0e3f55
.quad 0xbf6dbec4248dbf80,0x3ec43f6dbf353f35,0xbf46bf223ec4bf6d,0x3e953f75bf553f0e,0xbf0ebf553f35bf35,0x3e483f7bbf6d3ec4,0xbe95bf753f6dbec4,0x3dc93f7fbf7b3e48
.quad 0x3f80248d00003f80,0xbf80a554250dbf80,0x3f7fbdc900003f80,0xbf753e95be48bf7b,0x3f7bbe4800003f80,0xbf553f0ebec4bf6d,0x3f75be9500003f80,0xbf223f46bf0ebf55
.quad 0x3f6dbec400003f80,0xbec43f6dbf35bf35,0x3f62bef100003f80,0xbdc93f7fbf55bf0e,0x3f55bf0e00003f80,0x3e483f7bbf6dbec4,0x3f46bf2200003f80,0x3ef13f62bf7bbe48
.quad 0x3f35bf3500003f80,0x3f353f35bf80a554,0x3f22bf4600003f80,0x3f623ef1bf7b3e48,0x3f0ebf5500003f80,0x3f7b3e48bf6d3ec4,0x3ef1bf6200003f80,0x3f7fbdc9bf553f0e
.quad 0x3ec4bf6d00003f80,0x3f6dbec4bf353f35,0x3e95bf7500003f80,0x3f46bf22bf0e3f55,0x3e48bf7b00003f80,0x3f0ebf55bec43f6d,0x3dc9bf7f00003f80,0x3e95bf75be483f7b
.quad 0x3f80248d00003f80,0xbf80a554250dbf80,0x3f62bef13ec43f6d,0xbf463f22bf0ebf55,0x3f0ebf553f353f35,0xbe483f7bbf6dbec4,0x3dc9bf7f3f6d3ec4,0x3ef13f62bf7b3e48
.quad 0xbec4bf6d3f80248d,0x3f6d3ec4bf353f35,0xbf46bf223f6dbec4,0x3f75be95be483f7b,0xbf7bbe483f35bf35,0x3f0ebf553ec43f6d,0xbf753e953ec4bf6d,0xbdc9bf7f3f553f0e
.quad 0xbf353f35250dbf80,0xbf35bf353f80248d,0xbe953f75bec4bf6d,0xbf7fbdc93f55bf0e,0x3e483f7bbf35bf35,0xbf553f0e3ec4bf6d,0x3f223f46bf6dbec4,0xbe953f75be48bf7b
.quad 0x3f6d3ec4bf80a554,0x3ec43f6dbf35bf35,0x3f7fbdc9bf6d3ec4,0x3f623ef1bf7bbe48,0x3f55bf0ebf353f35,0x3f7bbe48bf6d3ec4,0x3ef1bf62bec43f6d,0x3f22bf46bf0e3f55
.quad 0x3f80248d00003f80,0xbf80a554250dbf80,0x3f22bf463f353f35,0xbef13f62bf55bf0e,0xbe48bf7b3f80248d,0x3f0e3f55bf6d3ec4,0xbf62bef13f35bf35,0x3f7fbdc9be483f7b
.quad 0xbf6d3ec4250dbf80,0x3ec4bf6d3f353f35,0xbe953f75bf35bf35,0xbf22bf463f7bbe48,0x3f0e3f55bf80a554,0xbf7b3e483ec4bf6d,0x3f7f3dc9bf353f35,0xbe953f75bf0ebf55
.quad 0x3f35bf3500003f80,0x3f353f35bf80a554,0xbdc9bf7f3f353f35,0x3f75be95bf0e3f55,0xbf55bf0e3f80248d,0x3e48bf7b3ec43f6d,0xbf753e953f35bf35,0xbf46bf223f7b3e48
.quad 0xbec43f6d250dbf80,0xbf6d3ec43f35bf35,0x3ef13f62bf35bf35,0xbdc93f7fbe48bf7b,0x3f7b3e48bf80a554,0x3f553f0ebf6dbec4,0x3f46bf22bf353f35,0x3f62bef1bf553f0e
.quad 0x3f80248d00003f80,0xbf80a554250dbf80,0x3e95bf753f6d3ec4,0xbdc93f7fbf7bbe48,0xbf55bf0e3f35bf35,0x3f7b3e48bec43f6d,0xbf463f22bec4bf6d,0x3e95bf753f553f0e
.quad 0x3ec43f6dbf80a554,0xbf6dbec43f35bf35,0x3f7fbdc9bec43f6d,0xbef13f62bf0ebf55,0x3e48bf7b3f353f35,0x3f553f0ebf6d3ec4,0xbf62bef13f6dbec4,0x3f22bf463e483f7b
.quad 0xbf353f35250dbf80,0xbf35bf353f80248d,0x3ef13f62bf6dbec4,0xbf463f223e48bf7b,0x3f7bbe48bf353f35,0x3f0e3f55bf6dbec4,0x3dc9bf7f3ec43f6d,0x3f62bef1bf0e3f55
.quad 0xbf6dbec43f80248d,0xbec4bf6d3f353f35,0xbf223f463ec4bf6d,0xbf753e953f55bf0e,0x3f0e3f55bf35bf35,0x3e483f7bbec4bf6d,0x3f75be95bf6d3ec4,0x3f7fbdc9bf7b3e48
.quad 0x3f80248d00003f80,0xbf80a554250dbf80,0xbdc9bf7f3f80248d,0x3e953f75bf7b3e48,0xbf7b3e48250dbf80,0x3f55bf0e3ec43f6d,0x3e953f75bf80a554,0xbf46bf223f55bf0e
.quad 0x3f6dbec400003f80,0xbec43f6dbf35bf35,0xbef1bf623f80248d,0x3f7f3dc9bf0e3f55,0xbf553f0e250dbf80,0xbe48bf7b3f6d3ec4,0x3f223f46bf80a554,0xbf623ef13e48bf7b
.quad 0x3f35bf3500003f80,0x3f353f35bf80a554,0xbf46bf223f80248d,0x3ef1bf623e483f7b,0xbf0e3f55250dbf80,0xbf7bbe483f6dbec4,0x3f623ef1bf80a554,0x3dc93f7fbf0ebf55
.quad 0x3ec4bf6d00003f80,0x3f6dbec4bf353f35,0xbf75be953f80248d,0xbf22bf463f553f0e,0xbe483f7b250dbf80,0xbf0e3f553ec4bf6d,0x3f7f3dc9bf80a554,0x3f753e95bf7bbe48
.quad 0x3f80248d00003f80,0xbf80a554250dbf80,0xbef1bf623f6dbec4,0x3f223f46bf553f0e,0xbf0e3f55bf35bf35,0x3e48bf7b3f6d3ec4,0x3f7f3dc9bec43f6d,0xbf623ef1be48bf7b
.quad 0xbec4bf6d3f80248d,0x3f6d3ec4bf353f35,0xbf223f46bec4bf6d,0xbe95bf753f7b3e48,0x3f7b3e48bf353f35,0xbf0e3f55bec4bf6d,0xbe95bf753f6d3ec4,0x3f7fbdc9bf0e3f55
.quad 0xbf353f35250dbf80,0xbf35bf353f80248d,0x3f753e95bf6d3ec4,0xbdc93f7fbf0ebf55,0xbe48bf7b3f353f35,0x3f55bf0ebec43f6d,0xbf463f223ec4bf6d,0xbf75be953f7bbe48
.quad 0x3f6d3ec4bf80a554,0x3ec43f6dbf35bf35,0xbdc9bf7f3ec43f6d,0x3ef1bf62be483f7b,0xbf553f0e3f35bf35,0xbf7b3e483f6dbec4,0x3f623ef1bf6dbec4,0x3f463f22bf55bf0e
.quad 0x3f80248d00003f80,0xbf80a554250dbf80,0xbf46bf223f35bf35,0x3f623ef1bf0e3f55,0x3e483f7bbf80a554,0xbf0ebf553f6dbec4,0x3ef1bf623f353f35,0x3dc93f7fbf7bbe48
.quad 0xbf6d3ec4250dbf80,0x3ec4bf6d3f353f35,0x3f753e95bf353f35,0xbf463f22be48bf7b,0xbf0ebf553f80248d,0x3f7bbe48bec43f6d,0xbdc93f7fbf35bf35,0xbf75be953f55bf0e
.quad 0x3f35bf3500003f80,0x3f353f35bf80a554,0xbf7f3dc93f35bf35,0xbe95bf753f553f0e,0x3f553f0ebf80a554,0xbe483f7bbec4bf6d,0xbe95bf753f353f35,0x3f22bf46be483f7b
.quad 0xbec43f6d250dbf80,0xbf6d3ec43f35bf35,0x3f62bef1bf353f35,0x3f7f3dc9bf7b3e48,0xbf7bbe483f80248d,0xbf55bf0e3f6d3ec4,0x3f223f46bf35bf35,0x3ef13f62bf0ebf55
.quad 0x3f80248d00003f80,0xbf80a554250dbf80,0xbf75be953ec4bf6d,0x3f7f3dc9be483f7b,0x3f553f0ebf353f35,0xbf7bbe483ec4bf6d,0xbf22bf463f6dbec4,0x3f753e95bf0e3f55
.quad 0x3ec43f6dbf80a554,0xbf6dbec43f35bf35,0xbdc9bf7f3f6d3ec4,0x3f623ef1bf553f0e,0xbe483f7bbf35bf35,0xbf55bf0e3f6dbec4,0x3ef1bf623ec43f6d,0x3f463f22bf7b3e48
.quad 0xbf353f35250dbf80,0xbf35bf353f80248d,0x3f62bef1bec43f6d,0x3f223f46bf7bbe48,0xbf7b3e483f35bf35,0xbf0ebf553f6d3ec4,0x3f7f3dc9bf6d3ec4,0x3ef13f62bf55bf0e
.quad 0xbf6dbec43f80248d,0xbec4bf6d3f353f35,0x3f463f22bf6dbec4,0x3e953f75bf0ebf55,0xbf0ebf553f353f35,0xbe48bf7b3ec43f6d,0x3e953f75bec4bf6d,0x3dc93f7fbe48bf7b
.quad 0x3f80248d00003f80,0xbf80a554250dbf80,0xbf7f3dc9250dbf80,0x3f75be953e483f7b,0x3f7bbe4800003f80,0xbf553f0ebec4bf6d,0xbf753e95250dbf80,0x3f22bf463f0e3f55
.quad 0x3f6dbec400003f80,0xbec43f6dbf35bf35,0xbf623ef1250dbf80,0x3dc9bf7f3f553f0e,0x3f55bf0e00003f80,0x3e483f7bbf6dbec4,0xbf463f22250dbf80,0xbef1bf623f7b3e48
.quad 0x3f35bf3500003f80,0x3f353f35bf80a554,0xbf223f46250dbf80,0xbf62bef13f7bbe48,0x3f0ebf5500003f80,0x3f7b3e48bf6d3ec4,0xbef13f62250dbf80,0xbf7f3dc93f55bf0e
.quad 0x3ec4bf6d00003f80,0x3f6dbec4bf353f35,0xbe953f75250dbf80,0xbf463f223f0ebf55,0x3e48bf7b00003f80,0x3f0ebf55bec43f6d,0xbdc93f7f250dbf80,0xbe953f753e48bf7b
.quad 0x3f80248d00003f80,0xbf80a554250dbf80,0xbf623ef1bec4bf6d,0x3f46bf223f0e3f55,0x3f0ebf553f353f35,0xbe483f7bbf6dbec4,0xbdc93f7fbf6dbec4,0xbef1bf623f7bbe48
.quad 0xbec4bf6d3f80248d,0x3f6d3ec4bf353f35,0x3f463f22bf6d3ec4,0xbf753e953e48bf7b,0xbf7bbe483f35bf35,0x3f0ebf553ec43f6d,0x3f75be95bec43f6d,0x3dc93f7fbf55bf0e
.quad 0xbf353f35250dbf80,0xbf35bf353f80248d,0x3e95bf753ec43f6d,0x3f7f3dc9bf553f0e,0x3e483f7bbf35bf35,0xbf553f0e3ec4bf6d,0xbf22bf463f6d3ec4,0x3e95bf753e483f7b
.quad 0x3f6d3ec4bf80a554,0x3ec43f6dbf35bf35,0xbf7f3dc93f6dbec4,0xbf62bef13f7b3e48,0x3f55bf0ebf353f35,0x3f7bbe48bf6d3ec4,0xbef13f623ec4bf6d,0xbf223f463f0ebf55
.quad 0x3f80248d00003f80,0xbf80a554250dbf80,0xbf223f46bf35bf35,0x3ef1bf623f553f0e,0xbe48bf7b3f80248d,0x3f0e3f55bf6d3ec4,0x3f623ef1bf353f35,0xbf7f3dc93e48bf7b
.quad 0xbf6d3ec4250dbf80,0x3ec4bf6d3f353f35,0x3e95bf753f353f35,0x3f223f46bf7b3e48,0x3f0e3f55bf80a554,0xbf7b3e483ec4bf6d,0xbf7fbdc93f35bf35,0x3e95bf753f0e3f55
.quad 0x3f35bf3500003f80,0x3f353f35bf80a554,0x3dc93f7fbf35bf35,0xbf753e953f0ebf55,0xbf55bf0e3f80248d,0x3e48bf7b3ec43f6d,0x3f75be95bf353f35,0x3f463f22bf7bbe48
.quad 0xbec43f6d250dbf80,0xbf6d3ec43f35bf35,0xbef1bf623f353f35,0x3dc9bf7f3e483f7b,0x3f7b3e48bf80a554,0x3f553f0ebf6dbec4,0xbf463f223f35bf35,0xbf623ef13f55bf0e
.quad 0x3f80248d00003f80,0xbf80a554250dbf80,0xbe953f75bf6dbec4,0x3dc9bf7f3f7b3e48,0xbf55bf0e3f35bf35,0x3f7b3e48bec43f6d,0x3f46bf223ec43f6d,0xbe953f75bf55bf0e
.quad 0x3ec43f6dbf80a554,0xbf6dbec43f35bf35,0xbf7f3dc93ec4bf6d,0x3ef1bf623f0e3f55,0x3e48bf7b3f353f35,0x3f553f0ebf6d3ec4,0x3f623ef1bf6d3ec4,0xbf223f46be48bf7b
.quad 0xbf353f35250dbf80,0xbf35bf353f80248d,0xbef1bf623f6d3ec4,0x3f46bf22be483f7b,0x3f7bbe48bf353f35,0x3f0e3f55bf6dbec4,0xbdc93f7fbec4bf6d,0xbf623ef13f0ebf55
.quad 0xbf6dbec43f80248d,0xbec4bf6d3f353f35,0x3f22bf46bec43f6d,0x3f75be95bf553f0e,0x3f0e3f55bf35bf35,0x3e483f7bbec4bf6d,0xbf753e953f6dbec4,0xbf7f3dc93f7bbe48
.quad 0x3f80248d00003f80,0xbf80a554250dbf80,0x3dc93f7fbf80a554,0xbe95bf753f7bbe48,0xbf7b3e48250dbf80,0x3f55bf0e3ec43f6d,0xbe95bf753f80248d,0x3f463f22bf553f0e
.quad 0x3f6dbec400003f80,0xbec43f6dbf35bf35,0x3ef13f62bf80a554,0xbf7fbdc93f0ebf55,0xbf553f0e250dbf80,0xbe48bf7b3f6d3ec4,0xbf22bf463f80248d,0x3f62bef1be483f7b
.quad 0x3f35bf3500003f80,0x3f353f35bf80a554,0x3f463f22bf80a554,0xbef13f62be48bf7b,0xbf0e3f55250dbf80,0xbf7bbe483f6dbec4,0xbf62bef13f80248d,0xbdc9bf7f3f0e3f55
.quad 0x3ec4bf6d00003f80,0x3f6dbec4bf353f35,0x3f753e95bf80a554,0x3f223f46bf55bf0e,0xbe483f7b250dbf80,0xbf0e3f553ec4bf6d,0xbf7fbdc93f80248d,0xbf75be953f7b3e48
.quad 0x3f80248d00003f80,0xbf80a554250dbf80,0x3ef13f62bf6d3ec4,0xbf22bf463f55bf0e,0xbf0e3f55bf35bf35,0x3e48bf7b3f6d3ec4,0xbf7fbdc93ec4bf6d,0x3f62bef13e483f7b
.quad 0xbec4bf6d3f80248d,0x3f6d3ec4bf353f35,0x3f22bf463ec43f6d,0x3e953f75bf7bbe48,0x3f7b3e48bf353f35,0xbf0e3f55bec4bf6d,0x3e953f75bf6dbec4,0xbf7f3dc93f0ebf55
.quad 0xbf353f35250dbf80,0xbf35bf353f80248d,0xbf75be953f6dbec4,0x3dc9bf7f3f0e3f55,0xbe48bf7b3f353f35,0x3f55bf0ebec43f6d,0x3f46bf22bec43f6d,0x3f753e95bf7b3e48
.quad 0x3f6d3ec4bf80a554,0x3ec43f6dbf35bf35,0x3dc93f7fbec4bf6d,0xbef13f623e48bf7b,0xbf553f0e3f35bf35,0xbf7b3e483f6dbec4,0xbf62bef13f6d3ec4,0xbf46bf223f553f0e
.quad 0x3f80248d00003f80,0xbf80a554250dbf80,0x3f463f22bf353f35,0xbf62bef13f0ebf55,0x3e483f7bbf80a554,0xbf0ebf553f6dbec4,0xbef13f62bf35bf35,0xbdc9bf7f3f7b3e48
.quad 0xbf6d3ec4250dbf80,0x3ec4bf6d3f353f35,0xbf75be953f35bf35,0x3f46bf223e483f7b,0xbf0ebf553f80248d,0x3f7bbe48bec43f6d,0x3dc9bf7f3f353f35,0x3f753e95bf553f0e
.quad 0x3f35bf3500003f80,0x3f353f35bf80a554,0x3f7fbdc9bf353f35,0x3e953f75bf55bf0e,0x3f553f0ebf80a554,0xbe483f7bbec4bf6d,0x3e953f75bf35bf35,0xbf223f463e48bf7b
.quad 0xbec43f6d250dbf80,0xbf6d3ec43f35bf35,0xbf623ef13f35bf35,0xbf7fbdc93f7bbe48,0xbf7bbe483f80248d,0xbf55bf0e3f6d3ec4,0xbf22bf463f353f35,0xbef1bf623f0e3f55
.quad 0x3f80248d00003f80,0xbf80a554250dbf80,0x3f753e95bec43f6d,0xbf7fbdc93e48bf7b,0x3f553f0ebf353f35,0xbf7bbe483ec4bf6d,0x3f223f46bf6d3ec4,0xbf75be953f0ebf55
.quad 0x3ec43f6dbf80a554,0xbf6dbec43f35bf35,0x3dc93f7fbf6dbec4,0xbf62bef13f55bf0e,0xbe483f7bbf35bf35,0xbf55bf0e3f6dbec4,0xbef13f62bec4bf6d,0xbf46bf223f7bbe48
.quad 0xbf353f35250dbf80,0xbf35bf353f80248d,0xbf623ef13ec4bf6d,0xbf22bf463f7b3e48,0xbf7b3e483f35bf35,0xbf0ebf553f6d3ec4,0xbf7fbdc93f6dbec4,0xbef1bf623f553f0e
.quad 0xbf6dbec43f80248d,0xbec4bf6d3f353f35,0xbf46bf223f6d3ec4,0xbe95bf753f0e3f55,0xbf0ebf553f353f35,0xbe48bf7b3ec43f6d,0xbe95bf753ec43f6d,0xbdc9bf7f3e483f7b
.quad 0x248dbf803f808000,0xa5543f80bf80a50d,0xbdc9bf7f3f808000,0x3e953f75bf7b3e48,0xbe48bf7b3f808000,0x3f0e3f55bf6d3ec4,0xbe95bf753f808000,0x3f463f22bf553f0e
.quad 0xbec4bf6d3f808000,0x3f6d3ec4bf353f35,0xbef1bf623f808000,0x3f7f3dc9bf0e3f55,0xbf0ebf553f808000,0x3f7bbe48bec43f6d,0xbf22bf463f808000,0x3f62bef1be483f7b
.quad 0xbf35bf353f808000,0x3f35bf35a5543f80,0xbf46bf223f808000,0x3ef1bf623e483f7b,0xbf55bf0e3f808000,0x3e48bf7b3ec43f6d,0xbf62bef13f808000,0xbdc9bf7f3f0e3f55
.quad 0xbf6dbec43f808000,0xbec4bf6d3f353f35,0xbf75be953f808000,0xbf22bf463f553f0e,0xbf7bbe483f808000,0xbf55bf0e3f6d3ec4,0xbf7fbdc93f808000,0xbf75be953f7b3e48
.quad 0x248dbf803f808000,0xa5543f80bf80a50d,0xbef1bf623f6dbec4,0x3f223f46bf553f0e,0xbf55bf0e3f35bf35,0x3f7b3e48bec43f6d,0xbf7fbdc93ec4bf6d,0x3f62bef13e483f7b
.quad 0xbf6d3ec4248dbf80,0x3ec4bf6d3f353f35,0xbf223f46bec4bf6d,0xbe95bf753f7b3e48,0xbe483f7bbf35bf35,0xbf55bf0e3f6dbec4,0x3e953f75bf6dbec4,0xbf7f3dc93f0ebf55
.quad 0x3f353f35bf80a50d,0xbf353f35248dbf80,0x3f753e95bf6d3ec4,0xbdc93f7fbf0ebf55,0x3f7bbe48bf353f35,0x3f0e3f55bf6dbec4,0x3f46bf22bec43f6d,0x3f753e95bf7b3e48
.quad 0x3ec4bf6da5543f80,0x3f6dbec4bf353f35,0xbdc9bf7f3ec43f6d,0x3ef1bf62be483f7b,0xbf0ebf553f353f35,0xbe48bf7b3ec43f6d,0xbf62bef13f6d3ec4,0xbf46bf223f553f0e
.quad 0x248dbf803f808000,0xa5543f80bf80a50d,0xbf46bf223f35bf35,0x3f623ef1bf0e3f55,0xbf7b3e48248dbf80,0x3f55bf0e3ec43f6d,0xbef13f62bf35bf35,0xbdc9bf7f3f7b3e48
.quad 0x3ec43f6dbf80a50d,0xbf6dbec43f35bf35,0x3f753e95bf353f35,0xbf463f22be48bf7b,0x3f55bf0ea5543f80,0x3e483f7bbf6dbec4,0x3dc9bf7f3f353f35,0x3f753e95bf553f0e
.quad 0xbf35bf353f808000,0x3f35bf35a5543f80,0xbf7f3dc93f35bf35,0xbe95bf753f553f0e,0xbf0e3f55248dbf80,0xbf7bbe483f6dbec4,0x3e953f75bf35bf35,0xbf223f463e48bf7b
.quad 0x3f6d3ec4bf80a50d,0x3ec43f6dbf35bf35,0x3f62bef1bf353f35,0x3f7f3dc9bf7b3e48,0x3e48bf7ba5543f80,0x3f0ebf55bec43f6d,0xbf22bf463f353f35,0xbef1bf623f0e3f55
.quad 0x248dbf803f808000,0xa5543f80bf80a50d,0xbf75be953ec4bf6d,0x3f7f3dc9be483f7b,0xbf0e3f55bf35bf35,0x3e48bf7b3f6d3ec4,0x3f223f46bf6d3ec4,0xbf75be953f0ebf55
.quad 0x3f6dbec4a5543f80,0xbec43f6dbf35bf35,0xbdc9bf7f3f6d3ec4,0x3f623ef1bf553f0e,0xbf7bbe483f35bf35,0x3f0ebf553ec43f6d,0xbef13f62bec4bf6d,0xbf46bf223f7bbe48
.quad 0x3f353f35bf80a50d,0xbf353f35248dbf80,0x3f62bef1bec43f6d,0x3f223f46bf7bbe48,0xbe48bf7b3f353f35,0x3f55bf0ebec43f6d,0xbf7fbdc93f6dbec4,0xbef1bf623f553f0e
.quad 0xbec43f6d248dbf80,0xbf6d3ec43f35bf35,0x3f463f22bf6dbec4,0x3e953f75bf0ebf55,0x3f55bf0ebf353f35,0x3f7bbe48bf6d3ec4,0xbe95bf753ec43f6d,0xbdc9bf7f3e483f7b
.quad 0x248dbf803f808000,0xa5543f80bf80a50d,0xbf7f3dc9248dbf80,0x3f75be953e483f7b,0x3e483f7bbf80a50d,0xbf0ebf553f6dbec4,0x3f75be95a5543f80,0xbf223f46bf0ebf55
.quad 0xbec4bf6d3f808000,0x3f6d3ec4bf353f35,0xbf623ef1248dbf80,0x3dc9bf7f3f553f0e,0x3f0e3f55bf80a50d,0xbf7b3e483ec4bf6d,0x3f46bf22a5543f80,0x3ef13f62bf7bbe48
.quad 0xbf35bf353f808000,0x3f35bf35a5543f80,0xbf223f46248dbf80,0xbf62bef13f7bbe48,0x3f553f0ebf80a50d,0xbe483f7bbec4bf6d,0x3ef1bf62a5543f80,0x3f7fbdc9bf553f0e
.quad 0xbf6dbec43f808000,0xbec4bf6d3f353f35,0xbe953f75248dbf80,0xbf463f223f0ebf55,0x3f7b3e48bf80a50d,0x3f553f0ebf6dbec4,0x3dc9bf7fa5543f80,0x3e95bf75be483f7b
.quad 0x248dbf803f808000,0xa5543f80bf80a50d,0xbf623ef1bec4bf6d,0x3f46bf223f0e3f55,0x3f553f0ebf353f35,0xbf7bbe483ec4bf6d,0x3dc9bf7f3f6d3ec4,0x3ef13f62bf7b3e48
.quad 0xbf6d3ec4248dbf80,0x3ec4bf6d3f353f35,0x3f463f22bf6d3ec4,0xbf753e953e48bf7b,0x3e48bf7b3f353f35,0x3f553f0ebf6d3ec4,0xbf753e953ec4bf6d,0xbdc9bf7f3f553f0e
.quad 0x3f353f35bf80a50d,0xbf353f35248dbf80,0x3e95bf753ec43f6d,0x3f7f3dc9bf553f0e,0xbf7b3e483f35bf35,0xbf0ebf553f6d3ec4,0x3f223f46bf6dbec4,0xbe953f75be48bf7b
.quad 0x3ec4bf6da5543f80,0x3f6dbec4bf353f35,0xbf7f3dc93f6dbec4,0xbf62bef13f7b3e48,0x3f0e3f55bf35bf35,0x3e483f7bbec4bf6d,0x3ef1bf62bec43f6d,0x3f22bf46bf0e3f55
.quad 0x248dbf803f808000,0xa5543f80bf80a50d,0xbf223f46bf35bf35,0x3ef1bf623f553f0e,0x3f7bbe48a5543f80,0xbf553f0ebec4bf6d,0xbf62bef13f35bf35,0x3f7fbdc9be483f7b
.quad 0x3ec43f6dbf80a50d,0xbf6dbec43f35bf35,0x3e95bf753f353f35,0x3f223f46bf7b3e48,0xbf553f0e248dbf80,0xbe48bf7b3f6d3ec4,0x3f7f3dc9bf353f35,0xbe953f75bf0ebf55
.quad 0xbf35bf353f808000,0x3f35bf35a5543f80,0x3dc93f7fbf35bf35,0xbf753e953f0ebf55,0x3f0ebf55a5543f80,0x3f7b3e48bf6d3ec4,0xbf753e953f35bf35,0xbf46bf223f7b3e48
.quad 0x3f6d3ec4bf80a50d,0x3ec43f6dbf35bf35,0xbef1bf623f353f35,0x3dc9bf7f3e483f7b,0xbe483f7b248dbf80,0xbf0e3f553ec4bf6d,0x3f46bf22bf353f35,0x3f62bef1bf553f0e
.quad 0x248dbf803f808000,0xa5543f80bf80a50d,0xbe953f75bf6dbec4,0x3dc9bf7f3f7b3e48,0x3f0ebf553f353f35,0xbe483f7bbf6dbec4,0xbf463f22bec4bf6d,0x3e95bf753f553f0e
.quad 0x3f6dbec4a5543f80,0xbec43f6dbf35bf35,0xbf7f3dc93ec4bf6d,0x3ef1bf623f0e3f55,0x3f7b3e48bf353f35,0xbf0e3f55bec4bf6d,0xbf62bef13f6dbec4,0x3f22bf463e483f7b
.quad 0x3f353f35bf80a50d,0xbf353f35248dbf80,0xbef1bf623f6d3ec4,0x3f46bf22be483f7b,0x3e483f7bbf35bf35,0xbf553f0e3ec4bf6d,0x3dc9bf7f3ec43f6d,0x3f62bef1bf0e3f55
.quad 0xbec43f6d248dbf80,0xbf6d3ec43f35bf35,0x3f22bf46bec43f6d,0x3f75be95bf553f0e,0xbf553f0e3f35bf35,0xbf7b3e483f6dbec4,0x3f75be95bf6d3ec4,0x3f7fbdc9bf7b3e48
.quad 0x248dbf803f808000,0xa5543f80bf80a50d,0x3dc93f7fbf80a50d,0xbe95bf753f7bbe48,0xbe48bf7b3f808000,0x3f0e3f55bf6d3ec4,0x3e953f75bf80a50d,0xbf46bf223f55bf0e
.quad 0xbec4bf6d3f808000,0x3f6d3ec4bf353f35,0x3ef13f62bf80a50d,0xbf7fbdc93f0ebf55,0xbf0ebf553f808000,0x3f7bbe48bec43f6d,0x3f223f46bf80a50d,0xbf623ef13e48bf7b
.quad 0xbf35bf353f808000,0x3f35bf35a5543f80,0x3f463f22bf80a50d,0xbef13f62be48bf7b,0xbf55bf0e3f808000,0x3e48bf7b3ec43f6d,0x3f623ef1bf80a50d,0x3dc93f7fbf0ebf55
.quad 0xbf6dbec43f808000,0xbec4bf6d3f353f35,0x3f753e95bf80a50d,0x3f223f46bf55bf0e,0xbf7bbe483f808000,0xbf55bf0e3f6d3ec4,0x3f7f3dc9bf80a50d,0x3f753e95bf7bbe48
.quad 0x248dbf803f808000,0xa5543f80bf80a50d,0x3ef13f62bf6d3ec4,0xbf22bf463f55bf0e,0xbf55bf0e3f35bf35,0x3f7b3e48bec43f6d,0x3f7f3dc9bec43f6d,0xbf623ef1be48bf7b
.quad 0xbf6d3ec4248dbf80,0x3ec4bf6d3f353f35,0x3f22bf463ec43f6d,0x3e953f75bf7bbe48,0xbe483f7bbf35bf35,0xbf55bf0e3f6dbec4,0xbe95bf753f6d3ec4,0x3f7fbdc9bf0e3f55
.quad 0x3f353f35bf80a50d,0xbf353f35248dbf80,0xbf75be953f6dbec4,0x3dc9bf7f3f0e3f55,0x3f7bbe48bf353f35,0x3f0e3f55bf6dbec4,0xbf463f223ec4bf6d,0xbf75be953f7bbe48
.quad 0x3ec4bf6da5543f80,0x3f6dbec4bf353f35,0x3dc93f7fbec4bf6d,0xbef13f623e48bf7b,0xbf0ebf553f353f35,0xbe48bf7b3ec43f6d,0x3f623ef1bf6dbec4,0x3f463f22bf55bf0e
.quad 0x248dbf803f808000,0xa5543f80bf80a50d,0x3f463f22bf353f35,0xbf62bef13f0ebf55,0xbf7b3e48248dbf80,0x3f55bf0e3ec43f6d,0x3ef1bf623f353f35,0x3dc93f7fbf7bbe48
.quad 0x3ec43f6dbf80a50d,0xbf6dbec43f35bf35,0xbf75be953f35bf35,0x3f46bf223e483f7b,0x3f55bf0ea5543f80,0x3e483f7bbf6dbec4,0xbdc93f7fbf35bf35,0xbf75be953f55bf0e
.quad 0xbf35bf353f808000,0x3f35bf35a5543f80,0x3f7fbdc9bf353f35,0x3e953f75bf55bf0e,0xbf0e3f55248dbf80,0xbf7bbe483f6dbec4,0xbe95bf753f353f35,0x3f22bf46be483f7b
.quad 0x3f6d3ec4bf80a50d,0x3ec43f6dbf35bf35,0xbf623ef13f35bf35,0xbf7fbdc93f7bbe48,0x3e48bf7ba5543f80,0x3f0ebf55bec43f6d,0x3f223f46bf35bf35,0x3ef13f62bf0ebf55
.quad 0x248dbf803f808000,0xa5543f80bf80a50d,0x3f753e95bec43f6d,0xbf7fbdc93e48bf7b,0xbf0e3f55bf35bf35,0x3e48bf7b3f6d3ec4,0xbf22bf463f6dbec4,0x3f753e95bf0e3f55
.quad 0x3f6dbec4a5543f80,0xbec43f6dbf35bf35,0x3dc93f7fbf6dbec4,0xbf62bef13f55bf0e,0xbf7bbe483f35bf35,0x3f0ebf553ec43f6d,0x3ef1bf623ec43f6d,0x3f463f22bf7b3e48
.quad 0x3f353f35bf80a50d,0xbf353f35248dbf80,0xbf623ef13ec4bf6d,0xbf22bf463f7b3e48,0xbe48bf7b3f353f35,0x3f55bf0ebec43f6d,0x3f7f3dc9bf6d3ec4,0x3ef13f62bf55bf0e
.quad 0xbec43f6d248dbf80,0xbf6d3ec43f35bf35,0xbf46bf223f6d3ec4,0xbe95bf753f0e3f55,0x3f55bf0ebf353f35,0x3f7bbe48bf6d3ec4,0x3e953f75bec4bf6d,0x3dc93f7fbe48bf7b
.quad 0x248dbf803f808000,0xa5543f80bf80a50d,0x3f7fbdc9a5543f80,0xbf753e95be48bf7b,0x3e483f7bbf80a50d,0xbf0ebf553f6dbec4,0xbf753e95248dbf80,0x3f22bf463f0e3f55
.quad 0xbec4bf6d3f808000,0x3f6d3ec4bf353f35,0x3f62bef1a5543f80,0xbdc93f7fbf55bf0e,0x3f0e3f55bf80a50d,0xbf7b3e483ec4bf6d,0xbf463f22248dbf80,0xbef1bf623f7b3e48
.quad 0xbf35bf353f808000,0x3f35bf35a5543f80,0x3f22bf46a5543f80,0x3f623ef1bf7b3e48,0x3f553f0ebf80a50d,0xbe483f7bbec4bf6d,0xbef13f62248dbf80,0xbf7f3dc93f55bf0e
.quad 0xbf6dbec43f808000,0xbec4bf6d3f353f35,0x3e95bf75a5543f80,0x3f46bf22bf0e3f55,0x3f7b3e48bf80a50d,0x3f553f0ebf6dbec4,0xbdc93f7f248dbf80,0xbe953f753e48bf7b
.quad 0x248dbf803f808000,0xa5543f80bf80a50d,0x3f62bef13ec43f6d,0xbf463f22bf0ebf55,0x3f553f0ebf353f35,0xbf7bbe483ec4bf6d,0xbdc93f7fbf6dbec4,0xbef1bf623f7bbe48
.quad 0xbf6d3ec4248dbf80,0x3ec4bf6d3f353f35,0xbf46bf223f6dbec4,0x3f75be95be483f7b,0x3e48bf7b3f353f35,0x3f553f0ebf6d3ec4,0x3f75be95bec43f6d,0x3dc93f7fbf55bf0e
.quad 0x3f353f35bf80a50d,0xbf353f35248dbf80,0xbe953f75bec4bf6d,0xbf7fbdc93f55bf0e,0xbf7b3e483f35bf35,0xbf0ebf553f6d3ec4,0xbf22bf463f6d3ec4,0x3e95bf753e483f7b
.quad 0x3ec4bf6da5543f80,0x3f6dbec4bf353f35,0x3f7fbdc9bf6d3ec4,0x3f623ef1bf7bbe48,0x3f0e3f55bf35bf35,0x3e483f7bbec4bf6d,0xbef13f623ec4bf6d,0xbf223f463f0ebf55
.quad 0x248dbf803f808000,0xa5543f80bf80a50d,0x3f22bf463f353f35,0xbef13f62bf55bf0e,0x3f7bbe48a5543f80,0xbf553f0ebec4bf6d,0x3f623ef1bf353f35,0xbf7f3dc93e48bf7b
.quad 0x3ec43f6dbf80a50d,0xbf6dbec43f35bf35,0xbe953f75bf35bf35,0xbf22bf463f7bbe48,0xbf553f0e248dbf80,0xbe48bf7b3f6d3ec4,0xbf7fbdc93f35bf35,0x3e95bf753f0e3f55
.quad 0xbf35bf353f808000,0x3f35bf35a5543f80,0xbdc9bf7f3f353f35,0x3f75be95bf0e3f55,0x3f0ebf55a5543f80,0x3f7b3e48bf6d3ec4,0x3f75be95bf353f35,0x3f463f22bf7bbe48
.quad 0x3f6d3ec4bf80a50d,0x3ec43f6dbf35bf35,0x3ef13f62bf35bf35,0xbdc93f7fbe48bf7b,0xbe483f7b248dbf80,0xbf0e3f553ec4bf6d,0xbf463f223f35bf35,0xbf623ef13f55bf0e
.quad 0x248dbf803f808000,0xa5543f80bf80a50d,0x3e95bf753f6d3ec4,0xbdc93f7fbf7bbe48,0x3f0ebf553f353f35,0xbe483f7bbf6dbec4,0x3f46bf223ec43f6d,0xbe953f75bf55bf0e
.quad 0x3f6dbec4a5543f80,0xbec43f6dbf35bf35,0x3f7fbdc9bec43f6d,0xbef13f62bf0ebf55,0x3f7b3e48bf353f35,0xbf0e3f55bec4bf6d,0x3f623ef1bf6d3ec4,0xbf223f46be48bf7b
.quad 0x3f353f35bf80a50d,0xbf353f35248dbf80,0x3ef13f62bf6dbec4,0xbf463f223e48bf7b,0x3e483f7bbf35bf35,0xbf553f0e3ec4bf6d,0xbdc93f7fbec4bf6d,0xbf623ef13f0ebf55
.quad 0xbec43f6d248dbf80,0xbf6d3ec43f35bf35,0xbf223f463ec4bf6d,0xbf753e953f55bf0e,0xbf553f0e3f35bf35,0xbf7b3e483f6dbec4,0xbf753e953f6dbec4,0xbf7f3dc93f7bbe48
.quad 0x250dbf8000003f80,0x250dbf8000003f80,0xbdc9bf7f00003f80,0xbe95bf753e483f7b,0xbe48bf7b00003f80,0xbf0ebf553ec43f6d,0xbe95bf7500003f80,0xbf46bf223f0e3f55
.quad 0xbec4bf6d00003f80,0xbf6dbec43f353f35,0xbef1bf6200003f80,0xbf7fbdc93f553f0e,0xbf0ebf5500003f80,0xbf7b3e483f6d3ec4,0xbf22bf4600003f80,0xbf623ef13f7b3e48
.quad 0xbf35bf3500003f80,0xbf353f353f80248d,0xbf46bf2200003f80,0xbef13f623f7bbe48,0xbf55bf0e00003f80,0xbe483f7b3f6dbec4,0xbf62bef100003f80,0x3dc93f7f3f55bf0e
.quad 0xbf6dbec400003f80,0x3ec43f6d3f35bf35,0xbf75be9500003f80,0x3f223f463f0ebf55,0xbf7bbe4800003f80,0x3f553f0e3ec4bf6d,0xbf7fbdc900003f80,0x3f753e953e48bf7b
.quad 0x250dbf8000003f80,0x250dbf8000003f80,0xbef1bf623ec43f6d,0xbf22bf463f0e3f55,0xbf55bf0e3f353f35,0xbf7bbe483f6d3ec4,0xbf7fbdc93f6d3ec4,0xbf623ef13f7bbe48
.quad 0xbf6d3ec43f80248d,0xbec43f6d3f35bf35,0xbf223f463f6dbec4,0x3e953f753e48bf7b,0xbe483f7b3f35bf35,0x3f553f0ebec4bf6d,0x3e953f753ec4bf6d,0x3f7fbdc9bf55bf0e
.quad 0x3f353f35250dbf80,0x3f35bf35bf80a554,0x3f753e95bec4bf6d,0x3dc9bf7fbf553f0e,0x3f7bbe48bf35bf35,0xbf0ebf55bec43f6d,0x3f46bf22bf6dbec4,0xbf75be953e483f7b
.quad 0x3ec4bf6dbf80a554,0xbf6d3ec43f353f35,0xbdc9bf7fbf6d3ec4,0xbef13f623f7b3e48,0xbf0ebf55bf353f35,0x3e483f7b3f6dbec4,0xbf62bef1bec43f6d,0x3f463f223f0ebf55
.quad 0x250dbf8000003f80,0x250dbf8000003f80,0xbf46bf223f353f35,0xbf62bef13f553f0e,0xbf7b3e483f80248d,0xbf553f0e3f6dbec4,0xbef13f623f35bf35,0x3dc93f7f3e48bf7b
.quad 0x3ec43f6d250dbf80,0x3f6d3ec4bf35bf35,0x3f753e95bf35bf35,0x3f46bf22bf7b3e48,0x3f55bf0ebf80a554,0xbe48bf7bbec43f6d,0x3dc9bf7fbf353f35,0xbf75be953f0e3f55
.quad 0xbf35bf3500003f80,0xbf353f353f80248d,0xbf7f3dc93f353f35,0x3e953f753f0ebf55,0xbf0e3f553f80248d,0x3f7b3e48bec4bf6d,0x3e953f753f35bf35,0x3f22bf46bf7bbe48
.quad 0x3f6d3ec4250dbf80,0xbec4bf6dbf353f35,0x3f62bef1bf35bf35,0xbf7fbdc93e483f7b,0x3e48bf7bbf80a554,0xbf0e3f553f6d3ec4,0xbf22bf46bf353f35,0x3ef13f623f55bf0e
.quad 0x250dbf8000003f80,0x250dbf8000003f80,0xbf75be953f6d3ec4,0xbf7fbdc93f7b3e48,0xbf0e3f553f35bf35,0xbe483f7b3ec4bf6d,0x3f223f46bec4bf6d,0x3f753e95bf55bf0e
.quad 0x3f6dbec4bf80a554,0x3ec4bf6dbf353f35,0xbdc9bf7fbec43f6d,0xbf62bef13f0e3f55,0xbf7bbe483f353f35,0xbf0e3f553f6dbec4,0xbef13f623f6dbec4,0x3f463f22be48bf7b
.quad 0x3f353f35250dbf80,0x3f35bf35bf80a554,0x3f62bef1bf6dbec4,0xbf22bf46be483f7b,0xbe48bf7bbf353f35,0xbf553f0e3f6d3ec4,0xbf7fbdc93ec43f6d,0x3ef13f623f0ebf55
.quad 0xbec43f6d3f80248d,0x3f6dbec4bf35bf35,0x3f463f223ec4bf6d,0xbe95bf75bf553f0e,0x3f55bf0ebf35bf35,0xbf7b3e483ec43f6d,0xbe95bf75bf6d3ec4,0x3dc93f7f3f7bbe48
.quad 0x250dbf8000003f80,0x250dbf8000003f80,0xbf7f3dc93f80248d,0xbf753e953f7bbe48,0x3e483f7b250dbf80,0x3f0e3f55bec4bf6d,0x3f75be95bf80a554,0x3f22bf46bf553f0e
.quad 0xbec4bf6d00003f80,0xbf6dbec43f353f35,0xbf623ef13f80248d,0xbdc93f7f3f0ebf55,0x3f0e3f55250dbf80,0x3f7bbe48bf6dbec4,0x3f46bf22bf80a554,0xbef1bf62be483f7b
.quad 0xbf35bf3500003f80,0xbf353f353f80248d,0xbf223f463f80248d,0x3f623ef1be48bf7b,0x3f553f0e250dbf80,0x3e48bf7bbf6d3ec4,0x3ef1bf62bf80a554,0xbf7f3dc93f0e3f55
.quad 0xbf6dbec400003f80,0x3ec43f6d3f35bf35,0xbe953f753f80248d,0x3f46bf22bf55bf0e,0x3f7b3e48250dbf80,0xbf55bf0ebec43f6d,0x3dc9bf7fbf80a554,0xbe953f753f7b3e48
.quad 0x250dbf8000003f80,0x250dbf8000003f80,0xbf623ef13f6dbec4,0xbf463f223f55bf0e,0x3f553f0ebf35bf35,0x3f7b3e48bf6dbec4,0x3dc9bf7fbec43f6d,0xbef1bf623e483f7b
.quad 0xbf6d3ec43f80248d,0xbec43f6d3f35bf35,0x3f463f22bec4bf6d,0x3f75be95bf7bbe48,0x3e48bf7bbf353f35,0xbf55bf0e3ec43f6d,0xbf753e953f6d3ec4,0x3dc93f7f3f0ebf55
.quad 0x3f353f35250dbf80,0x3f35bf35bf80a554,0x3e95bf75bf6d3ec4,0xbf7fbdc93f0e3f55,0xbf7b3e483f353f35,0x3f0e3f553ec4bf6d,0x3f223f463ec4bf6d,0x3e95bf75bf7b3e48
.quad 0x3ec4bf6dbf80a554,0xbf6d3ec43f353f35,0xbf7f3dc93ec43f6d,0x3f623ef13e48bf7b,0x3f0e3f553f35bf35,0xbe48bf7bbf6d3ec4,0x3ef1bf62bf6dbec4,0xbf223f463f553f0e
.quad 0x250dbf8000003f80,0x250dbf8000003f80,0xbf223f463f35bf35,0xbef13f623f0ebf55,0x3f7bbe48bf80a554,0x3f55bf0ebf6d3ec4,0xbf62bef13f353f35,0xbf7f3dc93f7b3e48
.quad 0x3ec43f6d250dbf80,0x3f6d3ec4bf35bf35,0x3e95bf75bf353f35,0xbf22bf463e483f7b,0xbf553f0e3f80248d,0x3e483f7b3ec4bf6d,0x3f7f3dc9bf35bf35,0x3e95bf75bf553f0e
.quad 0xbf35bf3500003f80,0xbf353f353f80248d,0x3dc93f7f3f35bf35,0x3f75be95bf55bf0e,0x3f0ebf55bf80a554,0xbf7bbe483ec43f6d,0xbf753e953f353f35,0x3f463f223e48bf7b
.quad 0x3f6d3ec4250dbf80,0xbec4bf6dbf353f35,0xbef1bf62bf353f35,0xbdc93f7f3f7bbe48,0xbe483f7b3f80248d,0x3f0ebf55bf6dbec4,0x3f46bf22bf35bf35,0xbf623ef13f0e3f55
.quad 0x250dbf8000003f80,0x250dbf8000003f80,0xbe953f753ec4bf6d,0xbdc93f7f3e48bf7b,0x3f0ebf55bf353f35,0x3e48bf7bbec43f6d,0xbf463f223f6dbec4,0xbe953f753f0ebf55
.quad 0x3f6dbec4bf80a554,0x3ec4bf6dbf353f35,0xbf7f3dc93f6d3ec4,0xbef13f623f55bf0e,0x3f7b3e48bf35bf35,0x3f0ebf55bf6d3ec4,0xbf62bef13ec43f6d,0xbf223f463f7bbe48
.quad 0x3f353f35250dbf80,0x3f35bf35bf80a554,0xbef1bf62bec43f6d,0xbf463f223f7b3e48,0x3e483f7b3f35bf35,0x3f55bf0ebf6dbec4,0x3dc9bf7fbf6d3ec4,0xbf623ef13f553f0e
.quad 0xbec43f6d3f80248d,0x3f6dbec4bf35bf35,0x3f22bf46bf6dbec4,0xbf753e953f0e3f55,0xbf553f0e3f353f35,0x3f7bbe48bec4bf6d,0x3f75be95bec4bf6d,0xbf7f3dc93e483f7b
.quad 0x250dbf8000003f80,0x250dbf8000003f80,0x3dc93f7f250dbf80,0x3e953f75be48bf7b,0xbe48bf7b00003f80,0xbf0ebf553ec43f6d,0x3e953f75250dbf80,0x3f463f22bf0ebf55
.quad 0xbec4bf6d00003f80,0xbf6dbec43f353f35,0x3ef13f62250dbf80,0x3f7f3dc9bf55bf0e,0xbf0ebf5500003f80,0xbf7b3e483f6d3ec4,0x3f223f46250dbf80,0x3f62bef1bf7bbe48
.quad 0xbf35bf3500003f80,0xbf353f353f80248d,0x3f463f22250dbf80,0x3ef1bf62bf7b3e48,0xbf55bf0e00003f80,0xbe483f7b3f6dbec4,0x3f623ef1250dbf80,0xbdc9bf7fbf553f0e
.quad 0xbf6dbec400003f80,0x3ec43f6d3f35bf35,0x3f753e95250dbf80,0xbf22bf46bf0e3f55,0xbf7bbe4800003f80,0x3f553f0e3ec4bf6d,0x3f7f3dc9250dbf80,0xbf75be95be483f7b
.quad 0x250dbf8000003f80,0x250dbf8000003f80,0x3ef13f62bec4bf6d,0x3f223f46bf0ebf55,0xbf55bf0e3f353f35,0xbf7bbe483f6d3ec4,0x3f7f3dc9bf6dbec4,0x3f62bef1bf7b3e48
.quad 0xbf6d3ec43f80248d,0xbec43f6d3f35bf35,0x3f22bf46bf6d3ec4,0xbe95bf75be483f7b,0xbe483f7b3f35bf35,0x3f553f0ebec4bf6d,0xbe95bf75bec43f6d,0xbf7f3dc93f553f0e
.quad 0x3f353f35250dbf80,0x3f35bf35bf80a554,0xbf75be953ec43f6d,0xbdc93f7f3f55bf0e,0x3f7bbe48bf35bf35,0xbf0ebf55bec43f6d,0xbf463f223f6d3ec4,0x3f753e95be48bf7b
.quad 0x3ec4bf6dbf80a554,0xbf6d3ec43f353f35,0x3dc93f7f3f6dbec4,0x3ef1bf62bf7bbe48,0xbf0ebf55bf353f35,0x3e483f7b3f6dbec4,0x3f623ef13ec4bf6d,0xbf46bf22bf0e3f55
.quad 0x250dbf8000003f80,0x250dbf8000003f80,0x3f463f22bf35bf35,0x3f623ef1bf55bf0e,0xbf7b3e483f80248d,0xbf553f0e3f6dbec4,0x3ef1bf62bf353f35,0xbdc9bf7fbe483f7b
.quad 0x3ec43f6d250dbf80,0x3f6d3ec4bf35bf35,0xbf75be953f353f35,0xbf463f223f7bbe48,0x3f55bf0ebf80a554,0xbe48bf7bbec43f6d,0xbdc93f7f3f35bf35,0x3f753e95bf0ebf55
.quad 0xbf35bf3500003f80,0xbf353f353f80248d,0x3f7fbdc9bf35bf35,0xbe95bf75bf0e3f55,0xbf0e3f553f80248d,0x3f7b3e48bec4bf6d,0xbe95bf75bf353f35,0xbf223f463f7b3e48
.quad 0x3f6d3ec4250dbf80,0xbec4bf6dbf353f35,0xbf623ef13f353f35,0x3f7f3dc9be48bf7b,0x3e48bf7bbf80a554,0xbf0e3f553f6d3ec4,0x3f223f463f35bf35,0xbef1bf62bf553f0e
.quad 0x250dbf8000003f80,0x250dbf8000003f80,0x3f753e95bf6dbec4,0x3f7f3dc9bf7bbe48,0xbf0e3f553f35bf35,0xbe483f7b3ec4bf6d,0xbf22bf463ec43f6d,0xbf75be953f553f0e
.quad 0x3f6dbec4bf80a554,0x3ec4bf6dbf353f35,0x3dc93f7f3ec4bf6d,0x3f623ef1bf0ebf55,0xbf7bbe483f353f35,0xbf0e3f553f6dbec4,0x3ef1bf62bf6d3ec4,0xbf46bf223e483f7b
.quad 0x3f353f35250dbf80,0x3f35bf35bf80a554,0xbf623ef13f6d3ec4,0x3f223f463e48bf7b,0xbe48bf7bbf353f35,0xbf553f0e3f6d3ec4,0x3f7f3dc9bec4bf6d,0xbef1bf62bf0e3f55
.quad 0xbec43f6d3f80248d,0x3f6dbec4bf35bf35,0xbf46bf22bec43f6d,0x3e953f753f55bf0e,0x3f55bf0ebf35bf35,0xbf7b3e483ec43f6d,0x3e953f753f6dbec4,0xbdc9bf7fbf7b3e48
.quad 0x250dbf8000003f80,0x250dbf8000003f80,0x3f7fbdc9bf80a554,0x3f75be95bf7b3e48,0x3e483f7b250dbf80,0x3f0e3f55bec4bf6d,0xbf753e953f80248d,0xbf223f463f55bf0e
.quad 0xbec4bf6d00003f80,0xbf6dbec43f353f35,0x3f62bef1bf80a554,0x3dc9bf7fbf0e3f55,0x3f0e3f55250dbf80,0x3f7bbe48bf6dbec4,0xbf463f223f80248d,0x3ef13f623e48bf7b
.quad 0xbf35bf3500003f80,0xbf353f353f80248d,0x3f22bf46bf80a554,0xbf62bef13e483f7b,0x3f553f0e250dbf80,0x3e48bf7bbf6d3ec4,0xbef13f623f80248d,0x3f7fbdc9bf0ebf55
.quad 0xbf6dbec400003f80,0x3ec43f6d3f35bf35,0x3e95bf75bf80a554,0xbf463f223f553f0e,0x3f7b3e48250dbf80,0xbf55bf0ebec43f6d,0xbdc93f7f3f80248d,0x3e95bf75bf7bbe48
.quad 0x250dbf8000003f80,0x250dbf8000003f80,0x3f62bef1bf6d3ec4,0x3f46bf22bf553f0e,0x3f553f0ebf35bf35,0x3f7b3e48bf6dbec4,0xbdc93f7f3ec4bf6d,0x3ef13f62be48bf7b
.quad 0xbf6d3ec43f80248d,0xbec43f6d3f35bf35,0xbf46bf223ec43f6d,0xbf753e953f7b3e48,0x3e48bf7bbf353f35,0xbf55bf0e3ec43f6d,0x3f75be95bf6dbec4,0xbdc9bf7fbf0e3f55
.quad 0x3f353f35250dbf80,0x3f35bf35bf80a554,0xbe953f753f6dbec4,0x3f7f3dc9bf0ebf55,0xbf7b3e483f353f35,0x3f0e3f553ec4bf6d,0xbf22bf46bec43f6d,0xbe953f753f7bbe48
.quad 0x3ec4bf6dbf80a554,0xbf6d3ec43f353f35,0x3f7fbdc9bec4bf6d,0xbf62bef1be483f7b,0x3f0e3f553f35bf35,0xbe48bf7bbf6d3ec4,0xbef13f623f6d3ec4,0x3f22bf46bf55bf0e
.quad 0x250dbf8000003f80,0x250dbf8000003f80,0x3f22bf46bf353f35,0x3ef1bf62bf0e3f55,0x3f7bbe48bf80a554,0x3f55bf0ebf6d3ec4,0x3f623ef1bf35bf35,0x3f7fbdc9bf7bbe48
.quad 0x3ec43f6d250dbf80,0x3f6d3ec4bf35bf35,0xbe953f753f35bf35,0x3f223f46be48bf7b,0xbf553f0e3f80248d,0x3e483f7b3ec4bf6d,0xbf7fbdc93f353f35,0xbe953f753f55bf0e
.quad 0xbf35bf3500003f80,0xbf353f353f80248d,0xbdc9bf7fbf353f35,0xbf753e953f553f0e,0x3f0ebf55bf80a554,0xbf7bbe483ec43f6d,0x3f75be95bf35bf35,0xbf46bf22be483f7b
.quad 0x3f6d3ec4250dbf80,0xbec4bf6dbf353f35,0x3ef13f623f35bf35,0x3dc9bf7fbf7b3e48,0xbe483f7b3f80248d,0x3f0ebf55bf6dbec4,0xbf463f223f353f35,0x3f62bef1bf0ebf55
.quad 0x250dbf8000003f80,0x250dbf8000003f80,0x3e95bf75bec43f6d,0x3dc9bf7fbe483f7b,0x3f0ebf55bf353f35,0x3e48bf7bbec43f6d,0x3f46bf22bf6d3ec4,0x3e95bf75bf0e3f55
.quad 0x3f6dbec4bf80a554,0x3ec4bf6dbf353f35,0x3f7fbdc9bf6dbec4,0x3ef1bf62bf553f0e,0x3f7b3e48bf35bf35,0x3f0ebf55bf6d3ec4,0x3f623ef1bec4bf6d,0x3f22bf46bf7b3e48
.quad 0x3f353f35250dbf80,0x3f35bf35bf80a554,0x3ef13f623ec4bf6d,0x3f46bf22bf7bbe48,0x3e483f7b3f35bf35,0x3f55bf0ebf6dbec4,0xbdc93f7f3f6dbec4,0x3f62bef1bf55bf0e
.quad 0xbec43f6d3f80248d,0x3f6dbec4bf35bf35,0xbf223f463f6d3ec4,0x3f75be95bf0ebf55,0xbf553f0e3f353f35,0x3f7bbe48bec4bf6d,0xbf753e953ec43f6d,0x3f7fbdc9be48bf7b
.quad 0xbf80a50d3f808000,0xbf80a50d3f808000,0xbf7f3dc93f808000,0xbf753e953f7bbe48,0xbf7b3e483f808000,0xbf553f0e3f6dbec4,0xbf753e953f808000,0xbf223f463f55bf0e
.quad 0xbf6d3ec43f808000,0xbec43f6d3f35bf35,0xbf623ef13f808000,0xbdc93f7f3f0ebf55,0xbf553f0e3f808000,0x3e483f7b3ec4bf6d,0xbf463f223f808000,0x3ef13f623e48bf7b
.quad 0xbf353f353f808000,0x3f353f35248dbf80,0xbf223f463f808000,0x3f623ef1be48bf7b,0xbf0e3f553f808000,0x3f7b3e48bec4bf6d,0xbef13f623f808000,0x3f7fbdc9bf0ebf55
.quad 0xbec43f6d3f808000,0x3f6dbec4bf35bf35,0xbe953f753f808000,0x3f46bf22bf55bf0e,0xbe483f7b3f808000,0x3f0ebf55bf6dbec4,0xbdc93f7f3f808000,0x3e95bf75bf7bbe48
.quad 0xbf80a50d3f808000,0xbf80a50d3f808000,0xbf623ef13f6dbec4,0xbf463f223f55bf0e,0xbf0e3f553f35bf35,0xbe483f7b3ec4bf6d,0xbdc93f7f3ec4bf6d,0x3ef13f62be48bf7b
.quad 0x3ec43f6d248dbf80,0x3f6d3ec4bf35bf35,0x3f463f22bec4bf6d,0x3f75be95bf7bbe48,0x3f7b3e48bf35bf35,0x3f0ebf55bf6d3ec4,0x3f75be95bf6dbec4,0xbdc9bf7fbf0e3f55
.quad 0x3f35bf35bf80a50d,0xbf35bf35a5543f80,0x3e95bf75bf6d3ec4,0xbf7fbdc93f0e3f55,0xbe48bf7bbf353f35,0xbf553f0e3f6d3ec4,0xbf22bf46bec43f6d,0xbe953f753f7bbe48
.quad 0xbf6dbec4a5543f80,0x3ec43f6d3f35bf35,0xbf7f3dc93ec43f6d,0x3f623ef13e48bf7b,0xbf553f0e3f353f35,0x3f7bbe48bec4bf6d,0xbef13f623f6d3ec4,0x3f22bf46bf55bf0e
.quad 0xbf80a50d3f808000,0xbf80a50d3f808000,0xbf223f463f35bf35,0xbef13f623f0ebf55,0x3e483f7b248dbf80,0x3f0e3f55bec4bf6d,0x3f623ef1bf35bf35,0x3f7fbdc9bf7bbe48
.quad 0x3f6dbec4bf80a50d,0x3ec4bf6dbf353f35,0x3e95bf75bf353f35,0xbf22bf463e483f7b,0xbf0ebf55a5543f80,0xbf7b3e483f6d3ec4,0xbf7fbdc93f353f35,0xbe953f753f55bf0e
.quad 0xbf353f353f808000,0x3f353f35248dbf80,0x3dc93f7f3f35bf35,0x3f75be95bf55bf0e,0x3f553f0e248dbf80,0x3e48bf7bbf6d3ec4,0x3f75be95bf35bf35,0xbf46bf22be483f7b
.quad 0x3ec4bf6dbf80a50d,0xbf6d3ec43f353f35,0xbef1bf62bf353f35,0xbdc93f7f3f7bbe48,0xbf7bbe48a5543f80,0x3f553f0e3ec4bf6d,0xbf463f223f353f35,0x3f62bef1bf0ebf55
.quad 0xbf80a50d3f808000,0xbf80a50d3f808000,0xbe953f753ec4bf6d,0xbdc93f7f3e48bf7b,0x3f553f0ebf35bf35,0x3f7b3e48bf6dbec4,0x3f46bf22bf6d3ec4,0x3e95bf75bf0e3f55
.quad 0xbec4bf6da5543f80,0xbf6dbec43f353f35,0xbf7f3dc93f6d3ec4,0xbef13f623f55bf0e,0xbe483f7b3f35bf35,0x3f553f0ebec4bf6d,0x3f623ef1bec4bf6d,0x3f22bf46bf7b3e48
.quad 0x3f35bf35bf80a50d,0xbf35bf35a5543f80,0xbef1bf62bec43f6d,0xbf463f223f7b3e48,0xbf7b3e483f353f35,0x3f0e3f553ec4bf6d,0xbdc93f7f3f6dbec4,0x3f62bef1bf55bf0e
.quad 0x3f6d3ec4248dbf80,0xbec4bf6dbf353f35,0x3f22bf46bf6dbec4,0xbf753e953f0e3f55,0xbf0ebf55bf353f35,0x3e483f7b3f6dbec4,0xbf753e953ec43f6d,0x3f7fbdc9be48bf7b
.quad 0xbf80a50d3f808000,0xbf80a50d3f808000,0x3dc93f7f248dbf80,0x3e953f75be48bf7b,0x3f7bbe48bf80a50d,0x3f55bf0ebf6d3ec4,0xbe95bf75a5543f80,0xbf46bf223f0e3f55
.quad 0xbf6d3ec43f808000,0xbec43f6d3f35bf35,0x3ef13f62248dbf80,0x3f7f3dc9bf55bf0e,0x3f55bf0ebf80a50d,0xbe48bf7bbec43f6d,0xbf22bf46a5543f80,0xbf623ef13f7b3e48
.quad 0xbf353f353f808000,0x3f353f35248dbf80,0x3f463f22248dbf80,0x3ef1bf62bf7b3e48,0x3f0ebf55bf80a50d,0xbf7bbe483ec43f6d,0xbf62bef1a5543f80,0x3dc93f7f3f55bf0e
.quad 0xbec43f6d3f808000,0x3f6dbec4bf35bf35,0x3f753e95248dbf80,0xbf22bf46bf0e3f55,0x3e48bf7bbf80a50d,0xbf0e3f553f6d3ec4,0xbf7fbdc9a5543f80,0x3f753e953e48bf7b
.quad 0xbf80a50d3f808000,0xbf80a50d3f808000,0x3ef13f62bec4bf6d,0x3f223f46bf0ebf55,0x3f0ebf55bf353f35,0x3e48bf7bbec43f6d,0xbf7fbdc93f6d3ec4,0xbf623ef13f7bbe48
.quad 0x3ec43f6d248dbf80,0x3f6d3ec4bf35bf35,0x3f22bf46bf6d3ec4,0xbe95bf75be483f7b,0xbf7bbe483f353f35,0xbf0e3f553f6dbec4,0x3e953f753ec4bf6d,0x3f7fbdc9bf55bf0e
.quad 0x3f35bf35bf80a50d,0xbf35bf35a5543f80,0xbf75be953ec43f6d,0xbdc93f7f3f55bf0e,0x3e483f7b3f35bf35,0x3f55bf0ebf6dbec4,0x3f46bf22bf6dbec4,0xbf75be953e483f7b
.quad 0xbf6dbec4a5543f80,0x3ec43f6d3f35bf35,0x3dc93f7f3f6dbec4,0x3ef1bf62bf7bbe48,0x3f55bf0ebf35bf35,0xbf7b3e483ec43f6d,0xbf62bef1bec43f6d,0x3f463f223f0ebf55
.quad 0xbf80a50d3f808000,0xbf80a50d3f808000,0x3f463f22bf35bf35,0x3f623ef1bf55bf0e,0xbe48bf7ba5543f80,0xbf0ebf553ec43f6d,0xbef13f623f35bf35,0x3dc93f7f3e48bf7b
.quad 0x3f6dbec4bf80a50d,0x3ec4bf6dbf353f35,0xbf75be953f353f35,0xbf463f223f7bbe48,0x3f0e3f55248dbf80,0x3f7bbe48bf6dbec4,0x3dc9bf7fbf353f35,0xbf75be953f0e3f55
.quad 0xbf353f353f808000,0x3f353f35248dbf80,0x3f7fbdc9bf35bf35,0xbe95bf75bf0e3f55,0xbf55bf0ea5543f80,0xbe483f7b3f6dbec4,0x3e953f753f35bf35,0x3f22bf46bf7bbe48
.quad 0x3ec4bf6dbf80a50d,0xbf6d3ec43f353f35,0xbf623ef13f353f35,0x3f7f3dc9be48bf7b,0x3f7b3e48248dbf80,0xbf55bf0ebec43f6d,0xbf22bf46bf353f35,0x3ef13f623f55bf0e
.quad 0xbf80a50d3f808000,0xbf80a50d3f808000,0x3f753e95bf6dbec4,0x3f7f3dc9bf7bbe48,0xbf55bf0e3f353f35,0xbf7bbe483f6d3ec4,0x3f223f46bec4bf6d,0x3f753e95bf55bf0e
.quad 0xbec4bf6da5543f80,0xbf6dbec43f353f35,0x3dc93f7f3ec4bf6d,0x3f623ef1bf0ebf55,0x3e48bf7bbf353f35,0xbf55bf0e3ec43f6d,0xbef13f623f6dbec4,0x3f463f22be48bf7b
.quad 0x3f35bf35bf80a50d,0xbf35bf35a5543f80,0xbf623ef13f6d3ec4,0x3f223f463e48bf7b,0x3f7bbe48bf35bf35,0xbf0ebf55bec43f6d,0xbf7fbdc93ec43f6d,0x3ef13f623f0ebf55
.quad 0x3f6d3ec4248dbf80,0xbec4bf6dbf353f35,0xbf46bf22bec43f6d,0x3e953f753f55bf0e,0x3f0e3f553f35bf35,0xbe48bf7bbf6d3ec4,0xbe95bf75bf6d3ec4,0x3dc93f7f3f7bbe48
.quad 0xbf80a50d3f808000,0xbf80a50d3f808000,0x3f7fbdc9bf80a50d,0x3f75be95bf7b3e48,0xbf7b3e483f808000,0xbf553f0e3f6dbec4,0x3f75be95bf80a50d,0x3f22bf46bf553f0e
.quad 0xbf6d3ec43f808000,0xbec43f6d3f35bf35,0x3f62bef1bf80a50d,0x3dc9bf7fbf0e3f55,0xbf553f0e3f808000,0x3e483f7b3ec4bf6d,0x3f46bf22bf80a50d,0xbef1bf62be483f7b
.quad 0xbf353f353f808000,0x3f353f35248dbf80,0x3f22bf46bf80a50d,0xbf62bef13e483f7b,0xbf0e3f553f808000,0x3f7b3e48bec4bf6d,0x3ef1bf62bf80a50d,0xbf7f3dc93f0e3f55
.quad 0xbec43f6d3f808000,0x3f6dbec4bf35bf35,0x3e95bf75bf80a50d,0xbf463f223f553f0e,0xbe483f7b3f808000,0x3f0ebf55bf6dbec4,0x3dc9bf7fbf80a50d,0xbe953f753f7b3e48
.quad 0xbf80a50d3f808000,0xbf80a50d3f808000,0x3f62bef1bf6d3ec4,0x3f46bf22bf553f0e,0xbf0e3f553f35bf35,0xbe483f7b3ec4bf6d,0x3dc9bf7fbec43f6d,0xbef1bf623e483f7b
.quad 0x3ec43f6d248dbf80,0x3f6d3ec4bf35bf35,0xbf46bf223ec43f6d,0xbf753e953f7b3e48,0x3f7b3e48bf35bf35,0x3f0ebf55bf6d3ec4,0xbf753e953f6d3ec4,0x3dc93f7f3f0ebf55
.quad 0x3f35bf35bf80a50d,0xbf35bf35a5543f80,0xbe953f753f6dbec4,0x3f7f3dc9bf0ebf55,0xbe48bf7bbf353f35,0xbf553f0e3f6d3ec4,0x3f223f463ec4bf6d,0x3e95bf75bf7b3e48
.quad 0xbf6dbec4a5543f80,0x3ec43f6d3f35bf35,0x3f7fbdc9bec4bf6d,0xbf62bef1be483f7b,0xbf553f0e3f353f35,0x3f7bbe48bec4bf6d,0x3ef1bf62bf6dbec4,0xbf223f463f553f0e
.quad 0xbf80a50d3f808000,0xbf80a50d3f808000,0x3f22bf46bf353f35,0x3ef1bf62bf0e3f55,0x3e483f7b248dbf80,0x3f0e3f55bec4bf6d,0xbf62bef13f353f35,0xbf7f3dc93f7b3e48
.quad 0x3f6dbec4bf80a50d,0x3ec4bf6dbf353f35,0xbe953f753f35bf35,0x3f223f46be48bf7b,0xbf0ebf55a5543f80,0xbf7b3e483f6d3ec4,0x3f7f3dc9bf35bf35,0x3e95bf75bf553f0e
.quad 0xbf353f353f808000,0x3f353f35248dbf80,0xbdc9bf7fbf353f35,0xbf753e953f553f0e,0x3f553f0e248dbf80,0x3e48bf7bbf6d3ec4,0xbf753e953f353f35,0x3f463f223e48bf7b
.quad 0x3ec4bf6dbf80a50d,0xbf6d3ec43f353f35,0x3ef13f623f35bf35,0x3dc9bf7fbf7b3e48,0xbf7bbe48a5543f80,0x3f553f0e3ec4bf6d,0x3f46bf22bf35bf35,0xbf623ef13f0e3f55
.quad 0xbf80a50d3f808000,0xbf80a50d3f808000,0x3e95bf75bec43f6d,0x3dc9bf7fbe483f7b,0x3f553f0ebf35bf35,0x3f7b3e48bf6dbec4,0xbf463f223f6dbec4,0xbe953f753f0ebf55
.quad 0xbec4bf6da5543f80,0xbf6dbec43f353f35,0x3f7fbdc9bf6dbec4,0x3ef1bf62bf553f0e,0xbe483f7b3f35bf35,0x3f553f0ebec4bf6d,0xbf62bef13ec43f6d,0xbf223f463f7bbe48
.quad 0x3f35bf35bf80a50d,0xbf35bf35a5543f80,0x3ef13f623ec4bf6d,0x3f46bf22bf7bbe48,0xbf7b3e483f353f35,0x3f0e3f553ec4bf6d,0x3dc9bf7fbf6d3ec4,0xbf623ef13f553f0e
.quad 0x3f6d3ec4248dbf80,0xbec4bf6dbf353f35,0xbf223f463f6d3ec4,0x3f75be95bf0ebf55,0xbf0ebf55bf353f35,0x3e483f7b3f6dbec4,0x3f75be95bec4bf6d,0xbf7f3dc93e483f7b
.quad 0xbf80a50d3f808000,0xbf80a50d3f808000,0xbdc9bf7fa5543f80,0xbe95bf753e483f7b,0x3f7bbe48bf80a50d,0x3f55bf0ebf6d3ec4,0x3e953f75248dbf80,0x3f463f22bf0ebf55
.quad 0xbf6d3ec43f808000,0xbec43f6d3f35bf35,0xbef1bf62a5543f80,0xbf7fbdc93f553f0e,0x3f55bf0ebf80a50d,0xbe48bf7bbec43f6d,0x3f223f46248dbf80,0x3f62bef1bf7bbe48
.quad 0xbf353f353f808000,0x3f353f35248dbf80,0xbf46bf22a5543f80,0xbef13f623f7bbe48,0x3f0ebf55bf80a50d,0xbf7bbe483ec43f6d,0x3f623ef1248dbf80,0xbdc9bf7fbf553f0e
.quad 0xbec43f6d3f808000,0x3f6dbec4bf35bf35,0xbf75be95a5543f80,0x3f223f463f0ebf55,0x3e48bf7bbf80a50d,0xbf0e3f553f6d3ec4,0x3f7f3dc9248dbf80,0xbf75be95be483f7b
.quad 0xbf80a50d3f808000,0xbf80a50d3f808000,0xbef1bf623ec43f6d,0xbf22bf463f0e3f55,0x3f0ebf55bf353f35,0x3e48bf7bbec43f6d,0x3f7f3dc9bf6dbec4,0x3f62bef1bf7b3e48
.quad 0x3ec43f6d248dbf80,0x3f6d3ec4bf35bf35,0xbf223f463f6dbec4,0x3e953f753e48bf7b,0xbf7bbe483f353f35,0xbf0e3f553f6dbec4,0xbe95bf75bec43f6d,0xbf7f3dc93f553f0e
.quad 0x3f35bf35bf80a50d,0xbf35bf35a5543f80,0x3f753e95bec4bf6d,0x3dc9bf7fbf553f0e,0x3e483f7b3f35bf35,0x3f55bf0ebf6dbec4,0xbf463f223f6d3ec4,0x3f753e95be48bf7b
.quad 0xbf6dbec4a5543f80,0x3ec43f6d3f35bf35,0xbdc9bf7fbf6d3ec4,0xbef13f623f7b3e48,0x3f55bf0ebf35bf35,0xbf7b3e483ec43f6d,0x3f623ef13ec4bf6d,0xbf46bf22bf0e3f55
.quad 0xbf80a50d3f808000,0xbf80a50d3f808000,0xbf46bf223f353f35,0xbf62bef13f553f0e,0xbe48bf7ba5543f80,0xbf0ebf553ec43f6d,0x3ef1bf62bf353f35,0xbdc9bf7fbe483f7b
.quad 0x3f6dbec4bf80a50d,0x3ec4bf6dbf353f35,0x3f753e95bf35bf35,0x3f46bf22bf7b3e48,0x3f0e3f55248dbf80,0x3f7bbe48bf6dbec4,0xbdc93f7f3f35bf35,0x3f753e95bf0ebf55
.quad 0xbf353f353f808000,0x3f353f35248dbf80,0xbf7f3dc93f353f35,0x3e953f753f0ebf55,0xbf55bf0ea5543f80,0xbe483f7b3f6dbec4,0xbe95bf75bf353f35,0xbf223f463f7b3e48
.quad 0x3ec4bf6dbf80a50d,0xbf6d3ec43f353f35,0x3f62bef1bf35bf35,0xbf7fbdc93e483f7b,0x3f7b3e48248dbf80,0xbf55bf0ebec43f6d,0x3f223f463f35bf35,0xbef1bf62bf553f0e
.quad 0xbf80a50d3f808000,0xbf80a50d3f808000,0xbf75be953f6d3ec4,0xbf7fbdc93f7b3e48,0xbf55bf0e3f353f35,0xbf7bbe483f6d3ec4,0xbf22bf463ec43f6d,0xbf75be953f553f0e
.quad 0xbec4bf6da5543f80,0xbf6dbec43f353f35,0xbdc9bf7fbec43f6d,0xbf62bef13f0e3f55,0x3e48bf7bbf353f35,0xbf55bf0e3ec43f6d,0x3ef1bf62bf6d3ec4,0xbf46bf223e483f7b
.quad 0x3f35bf35bf80a50d,0xbf35bf35a5543f80,0x3f62bef1bf6dbec4,0xbf22bf46be483f7b,0x3f7bbe48bf35bf35,0xbf0ebf55bec43f6d,0x3f7f3dc9bec4bf6d,0xbef1bf62bf0e3f55
.quad 0x3f6d3ec4248dbf80,0xbec4bf6dbf353f35,0x3f463f223ec4bf6d,0xbe95bf75bf553f0e,0x3f0e3f553f35bf35,0xbe48bf7bbf6d3ec4,0x3e953f753f6dbec4,0xbdc9bf7fbf7b3e48
.quad 0xbf80a55400003f80,0x3f80248d250dbf80,0xbf7f3dc900003f80,0x3f75be95be48bf7b,0xbf7b3e4800003f80,0x3f55bf0ebec4bf6d,0xbf753e9500003f80,0x3f22bf46bf0ebf55
.quad 0xbf6d3ec400003f80,0x3ec4bf6dbf35bf35,0xbf623ef100003f80,0x3dc9bf7fbf55bf0e,0xbf553f0e00003f80,0xbe48bf7bbf6dbec4,0xbf463f2200003f80,0xbef1bf62bf7bbe48
.quad 0xbf353f3500003f80,0xbf35bf35bf80a554,0xbf223f4600003f80,0xbf62bef1bf7b3e48,0xbf0e3f5500003f80,0xbf7bbe48bf6d3ec4,0xbef13f6200003f80,0xbf7f3dc9bf553f0e
.quad 0xbec43f6d00003f80,0xbf6d3ec4bf353f35,0xbe953f7500003f80,0xbf463f22bf0e3f55,0xbe483f7b00003f80,0xbf0e3f55bec43f6d,0xbdc93f7f00003f80,0xbe953f75be483f7b
.quad 0xbf80a55400003f80,0x3f80248d250dbf80,0xbf623ef13ec43f6d,0x3f46bf22bf0ebf55,0xbf0e3f553f353f35,0x3e48bf7bbf6dbec4,0xbdc93f7f3f6d3ec4,0xbef1bf62bf7b3e48
.quad 0x3ec43f6d3f80248d,0xbf6dbec4bf353f35,0x3f463f223f6dbec4,0xbf753e95be483f7b,0x3f7b3e483f35bf35,0xbf0e3f553ec43f6d,0x3f75be953ec4bf6d,0x3dc93f7f3f553f0e
.quad 0x3f35bf35250dbf80,0x3f353f353f80248d,0x3e95bf75bec4bf6d,0x3f7f3dc93f55bf0e,0xbe48bf7bbf35bf35,0x3f55bf0e3ec4bf6d,0xbf22bf46bf6dbec4,0x3e95bf75be48bf7b
.quad 0xbf6dbec4bf80a554,0xbec4bf6dbf35bf35,0xbf7f3dc9bf6d3ec4,0xbf62bef1bf7bbe48,0xbf553f0ebf353f35,0xbf7b3e48bf6d3ec4,0xbef13f62bec43f6d,0xbf223f46bf0e3f55
.quad 0xbf80a55400003f80,0x3f80248d250dbf80,0xbf223f463f353f35,0x3ef1bf62bf55bf0e,0x3e483f7b3f80248d,0xbf0ebf55bf6d3ec4,0x3f623ef13f35bf35,0xbf7f3dc9be483f7b
.quad 0x3f6dbec4250dbf80,0xbec43f6d3f353f35,0x3e95bf75bf35bf35,0x3f223f463f7bbe48,0xbf0ebf55bf80a554,0x3f7bbe483ec4bf6d,0xbf7fbdc9bf353f35,0x3e95bf75bf0ebf55
.quad 0xbf353f3500003f80,0xbf35bf35bf80a554,0x3dc93f7f3f353f35,0xbf753e95bf0e3f55,0x3f553f0e3f80248d,0xbe483f7b3ec43f6d,0x3f75be953f35bf35,0x3f463f223f7b3e48
.quad 0x3ec4bf6d250dbf80,0x3f6dbec43f35bf35,0xbef1bf62bf35bf35,0x3dc9bf7fbe48bf7b,0xbf7bbe48bf80a554,0xbf55bf0ebf6dbec4,0xbf463f22bf353f35,0xbf623ef1bf553f0e
.quad 0xbf80a55400003f80,0x3f80248d250dbf80,0xbe953f753f6d3ec4,0x3dc9bf7fbf7bbe48,0x3f553f0e3f35bf35,0xbf7bbe48bec43f6d,0x3f46bf22bec4bf6d,0xbe953f753f553f0e
.quad 0xbec4bf6dbf80a554,0x3f6d3ec43f35bf35,0xbf7f3dc9bec43f6d,0x3ef1bf62bf0ebf55,0xbe483f7b3f353f35,0xbf55bf0ebf6d3ec4,0x3f623ef13f6dbec4,0xbf223f463e483f7b
.quad 0x3f35bf35250dbf80,0x3f353f353f80248d,0xbef1bf62bf6dbec4,0x3f46bf223e48bf7b,0xbf7b3e48bf353f35,0xbf0ebf55bf6dbec4,0xbdc93f7f3ec43f6d,0xbf623ef1bf0e3f55
.quad 0x3f6d3ec43f80248d,0x3ec43f6d3f353f35,0x3f22bf463ec4bf6d,0x3f75be953f55bf0e,0xbf0ebf55bf35bf35,0xbe48bf7bbec4bf6d,0xbf753e95bf6d3ec4,0xbf7f3dc9bf7b3e48
.quad 0xbf80a55400003f80,0x3f80248d250dbf80,0x3dc93f7f3f80248d,0xbe95bf75bf7b3e48,0x3f7bbe48250dbf80,0xbf553f0e3ec43f6d,0xbe95bf75bf80a554,0x3f463f223f55bf0e
.quad 0xbf6d3ec400003f80,0x3ec4bf6dbf35bf35,0x3ef13f623f80248d,0xbf7fbdc9bf0e3f55,0x3f55bf0e250dbf80,0x3e483f7b3f6d3ec4,0xbf22bf46bf80a554,0x3f62bef13e48bf7b
.quad 0xbf353f3500003f80,0xbf35bf35bf80a554,0x3f463f223f80248d,0xbef13f623e483f7b,0x3f0ebf55250dbf80,0x3f7b3e483f6dbec4,0xbf62bef1bf80a554,0xbdc9bf7fbf0ebf55
.quad 0xbec43f6d00003f80,0xbf6d3ec4bf353f35,0x3f753e953f80248d,0x3f223f463f553f0e,0x3e48bf7b250dbf80,0x3f0ebf553ec4bf6d,0xbf7fbdc9bf80a554,0xbf75be95bf7bbe48
.quad 0xbf80a55400003f80,0x3f80248d250dbf80,0x3ef13f623f6dbec4,0xbf22bf46bf553f0e,0x3f0ebf55bf35bf35,0xbe483f7b3f6d3ec4,0xbf7fbdc9bec43f6d,0x3f62bef1be48bf7b
.quad 0x3ec43f6d3f80248d,0xbf6dbec4bf353f35,0x3f22bf46bec4bf6d,0x3e953f753f7b3e48,0xbf7bbe48bf353f35,0x3f0ebf55bec4bf6d,0x3e953f753f6d3ec4,0xbf7f3dc9bf0e3f55
.quad 0x3f35bf35250dbf80,0x3f353f353f80248d,0xbf75be95bf6d3ec4,0x3dc9bf7fbf0ebf55,0x3e483f7b3f353f35,0xbf553f0ebec43f6d,0x3f46bf223ec4bf6d,0x3f753e953f7bbe48
.quad 0xbf6dbec4bf80a554,0xbec4bf6dbf35bf35,0x3dc93f7f3ec43f6d,0xbef13f62be483f7b,0x3f55bf0e3f35bf35,0x3f7bbe483f6dbec4,0xbf62bef1bf6dbec4,0xbf46bf22bf55bf0e
.quad 0xbf80a55400003f80,0x3f80248d250dbf80,0x3f463f223f35bf35,0xbf62bef1bf0e3f55,0xbe48bf7bbf80a554,0x3f0e3f553f6dbec4,0xbef13f623f353f35,0xbdc9bf7fbf7bbe48
.quad 0x3f6dbec4250dbf80,0xbec43f6d3f353f35,0xbf75be95bf353f35,0x3f46bf22be48bf7b,0x3f0e3f553f80248d,0xbf7b3e48bec43f6d,0x3dc9bf7fbf35bf35,0x3f753e953f55bf0e
.quad 0xbf353f3500003f80,0xbf35bf35bf80a554,0x3f7fbdc93f35bf35,0x3e953f753f553f0e,0xbf55bf0ebf80a554,0x3e48bf7bbec4bf6d,0x3e953f753f353f35,0xbf223f46be483f7b
.quad 0x3ec4bf6d250dbf80,0x3f6dbec43f35bf35,0xbf623ef1bf353f35,0xbf7fbdc9bf7b3e48,0x3f7b3e483f80248d,0x3f553f0e3f6d3ec4,0xbf22bf46bf35bf35,0xbef1bf62bf0ebf55
.quad 0xbf80a55400003f80,0x3f80248d250dbf80,0x3f753e953ec4bf6d,0xbf7fbdc9be483f7b,0xbf55bf0ebf353f35,0x3f7b3e483ec4bf6d,0x3f223f463f6dbec4,0xbf75be95bf0e3f55
.quad 0xbec4bf6dbf80a554,0x3f6d3ec43f35bf35,0x3dc93f7f3f6d3ec4,0xbf62bef1bf553f0e,0x3e48bf7bbf35bf35,0x3f553f0e3f6dbec4,0xbef13f623ec43f6d,0xbf46bf22bf7b3e48
.quad 0x3f35bf35250dbf80,0x3f353f353f80248d,0xbf623ef1bec43f6d,0xbf22bf46bf7bbe48,0x3f7bbe483f35bf35,0x3f0e3f553f6d3ec4,0xbf7fbdc9bf6d3ec4,0xbef1bf62bf55bf0e
.quad 0x3f6d3ec43f80248d,0x3ec43f6d3f353f35,0xbf46bf22bf6dbec4,0xbe95bf75bf0ebf55,0x3f0e3f553f353f35,0x3e483f7b3ec43f6d,0xbe95bf75bec4bf6d,0xbdc9bf7fbe48bf7b
.quad 0xbf80a55400003f80,0x3f80248d250dbf80,0x3f7fbdc9250dbf80,0xbf753e953e483f7b,0xbf7b3e4800003f80,0x3f55bf0ebec4bf6d,0x3f75be95250dbf80,0xbf223f463f0e3f55
.quad 0xbf6d3ec400003f80,0x3ec4bf6dbf35bf35,0x3f62bef1250dbf80,0xbdc93f7f3f553f0e,0xbf553f0e00003f80,0xbe48bf7bbf6dbec4,0x3f46bf22250dbf80,0x3ef13f623f7b3e48
.quad 0xbf353f3500003f80,0xbf35bf35bf80a554,0x3f22bf46250dbf80,0x3f623ef13f7bbe48,0xbf0e3f5500003f80,0xbf7bbe48bf6d3ec4,0x3ef1bf62250dbf80,0x3f7fbdc93f55bf0e
.quad 0xbec43f6d00003f80,0xbf6d3ec4bf353f35,0x3e95bf75250dbf80,0x3f46bf223f0ebf55,0xbe483f7b00003f80,0xbf0e3f55bec43f6d,0x3dc9bf7f250dbf80,0x3e95bf753e48bf7b
.quad 0xbf80a55400003f80,0x3f80248d250dbf80,0x3f62bef1bec4bf6d,0xbf463f223f0e3f55,0xbf0e3f553f353f35,0x3e48bf7bbf6dbec4,0x3dc9bf7fbf6dbec4,0x3ef13f623f7bbe48
.quad 0x3ec43f6d3f80248d,0xbf6dbec4bf353f35,0xbf46bf22bf6d3ec4,0x3f75be953e48bf7b,0x3f7b3e483f35bf35,0xbf0e3f553ec43f6d,0xbf753e95bec43f6d,0xbdc9bf7fbf55bf0e
.quad 0x3f35bf35250dbf80,0x3f353f353f80248d,0xbe953f753ec43f6d,0xbf7fbdc9bf553f0e,0xbe48bf7bbf35bf35,0x3f55bf0e3ec4bf6d,0x3f223f463f6d3ec4,0xbe953f753e483f7b
.quad 0xbf6dbec4bf80a554,0xbec4bf6dbf35bf35,0x3f7fbdc93f6dbec4,0x3f623ef13f7b3e48,0xbf553f0ebf353f35,0xbf7b3e48bf6d3ec4,0x3ef1bf623ec4bf6d,0x3f22bf463f0ebf55
.quad 0xbf80a55400003f80,0x3f80248d250dbf80,0x3f22bf46bf35bf35,0xbef13f623f553f0e,0x3e483f7b3f80248d,0xbf0ebf55bf6d3ec4,0xbf62bef1bf353f35,0x3f7fbdc93e48bf7b
.quad 0x3f6dbec4250dbf80,0xbec43f6d3f353f35,0xbe953f753f353f35,0xbf22bf46bf7b3e48,0xbf0ebf55bf80a554,0x3f7bbe483ec4bf6d,0x3f7f3dc93f35bf35,0xbe953f753f0e3f55
.quad 0xbf353f3500003f80,0xbf35bf35bf80a554,0xbdc9bf7fbf35bf35,0x3f75be953f0ebf55,0x3f553f0e3f80248d,0xbe483f7b3ec43f6d,0xbf753e95bf353f35,0xbf46bf22bf7bbe48
.quad 0x3ec4bf6d250dbf80,0x3f6dbec43f35bf35,0x3ef13f623f353f35,0xbdc93f7f3e483f7b,0xbf7bbe48bf80a554,0xbf55bf0ebf6dbec4,0x3f46bf223f35bf35,0x3f62bef13f55bf0e
.quad 0xbf80a55400003f80,0x3f80248d250dbf80,0x3e95bf75bf6dbec4,0xbdc93f7f3f7b3e48,0x3f553f0e3f35bf35,0xbf7bbe48bec43f6d,0xbf463f223ec43f6d,0x3e95bf75bf55bf0e
.quad 0xbec4bf6dbf80a554,0x3f6d3ec43f35bf35,0x3f7fbdc93ec4bf6d,0xbef13f623f0e3f55,0xbe483f7b3f353f35,0xbf55bf0ebf6d3ec4,0xbf62bef1bf6d3ec4,0x3f22bf46be48bf7b
.quad 0x3f35bf35250dbf80,0x3f353f353f80248d,0x3ef13f623f6d3ec4,0xbf463f22be483f7b,0xbf7b3e48bf353f35,0xbf0ebf55bf6dbec4,0x3dc9bf7fbec4bf6d,0x3f62bef13f0ebf55
.quad 0x3f6d3ec43f80248d,0x3ec43f6d3f353f35,0xbf223f46bec43f6d,0xbf753e95bf553f0e,0xbf0ebf55bf35bf35,0xbe48bf7bbec4bf6d,0x3f75be953f6dbec4,0x3f7fbdc93f7bbe48
.quad 0xbf80a55400003f80,0x3f80248d250dbf80,0xbdc9bf7fbf80a554,0x3e953f753f7bbe48,0x3f7bbe48250dbf80,0xbf553f0e3ec43f6d,0x3e953f753f80248d,0xbf46bf22bf553f0e
.quad 0xbf6d3ec400003f80,0x3ec4bf6dbf35bf35,0xbef1bf62bf80a554,0x3f7f3dc93f0ebf55,0x3f55bf0e250dbf80,0x3e483f7b3f6d3ec4,0x3f223f463f80248d,0xbf623ef1be483f7b
.quad 0xbf353f3500003f80,0xbf35bf35bf80a554,0xbf46bf22bf80a554,0x3ef1bf62be48bf7b,0x3f0ebf55250dbf80,0x3f7b3e483f6dbec4,0x3f623ef13f80248d,0x3dc93f7f3f0e3f55
.quad 0xbec43f6d00003f80,0xbf6d3ec4bf353f35,0xbf75be95bf80a554,0xbf22bf46bf55bf0e,0x3e48bf7b250dbf80,0x3f0ebf553ec4bf6d,0x3f7f3dc93f80248d,0x3f753e953f7b3e48
.quad 0xbf80a55400003f80,0x3f80248d250dbf80,0xbef1bf62bf6d3ec4,0x3f223f463f55bf0e,0x3f0ebf55bf35bf35,0xbe483f7b3f6d3ec4,0x3f7f3dc93ec4bf6d,0xbf623ef13e483f7b
.quad 0x3ec43f6d3f80248d,0xbf6dbec4bf353f35,0xbf223f463ec43f6d,0xbe95bf75bf7bbe48,0xbf7bbe48bf353f35,0x3f0ebf55bec4bf6d,0xbe95bf75bf6dbec4,0x3f7fbdc93f0ebf55
.quad 0x3f35bf35250dbf80,0x3f353f353f80248d,0x3f753e953f6dbec4,0xbdc93f7f3f0e3f55,0x3e483f7b3f353f35,0xbf553f0ebec43f6d,0xbf463f22bec43f6d,0xbf75be95bf7b3e48
.quad 0xbf6dbec4bf80a554,0xbec4bf6dbf35bf35,0xbdc9bf7fbec4bf6d,0x3ef1bf623e48bf7b,0x3f55bf0e3f35bf35,0x3f7bbe483f6dbec4,0x3f623ef13f6d3ec4,0x3f463f223f553f0e
.quad 0xbf80a55400003f80,0x3f80248d250dbf80,0xbf46bf22bf353f35,0x3f623ef13f0ebf55,0xbe48bf7bbf80a554,0x3f0e3f553f6dbec4,0x3ef1bf62bf35bf35,0x3dc93f7f3f7b3e48
.quad 0x3f6dbec4250dbf80,0xbec43f6d3f353f35,0x3f753e953f35bf35,0xbf463f223e483f7b,0x3f0e3f553f80248d,0xbf7b3e48bec43f6d,0xbdc93f7f3f353f35,0xbf75be95bf553f0e
.quad 0xbf353f3500003f80,0xbf35bf35bf80a554,0xbf7f3dc9bf353f35,0xbe95bf75bf55bf0e,0xbf55bf0ebf80a554,0x3e48bf7bbec4bf6d,0xbe95bf75bf35bf35,0x3f22bf463e48bf7b
.quad 0x3ec4bf6d250dbf80,0x3f6dbec43f35bf35,0x3f62bef13f35bf35,0x3f7f3dc93f7bbe48,0x3f7b3e483f80248d,0x3f553f0e3f6d3ec4,0x3f223f463f353f35,0x3ef13f623f0e3f55
.quad 0xbf80a55400003f80,0x3f80248d250dbf80,0xbf75be95bec43f6d,0x3f7f3dc93e48bf7b,0xbf55bf0ebf353f35,0x3f7b3e483ec4bf6d,0xbf22bf46bf6d3ec4,0x3f753e953f0ebf55
.quad 0xbec4bf6dbf80a554,0x3f6d3ec43f35bf35,0xbdc9bf7fbf6dbec4,0x3f623ef13f55bf0e,0x3e48bf7bbf35bf35,0x3f553f0e3f6dbec4,0x3ef1bf62bec4bf6d,0x3f463f223f7bbe48
.quad 0x3f35bf35250dbf80,0x3f353f353f80248d,0x3f62bef13ec4bf6d,0x3f223f463f7b3e48,0x3f7bbe483f35bf35,0x3f0e3f553f6d3ec4,0x3f7f3dc93f6dbec4,0x3ef13f623f553f0e
.quad 0x3f6d3ec43f80248d,0x3ec43f6d3f353f35,0x3f463f223f6d3ec4,0x3e953f753f0e3f55,0x3f0e3f553f353f35,0x3e483f7b3ec43f6d,0x3e953f753ec43f6d,0x3dc93f7f3e483f7b
.quad 0xa5543f803f808000,0x248dbf80bf80a50d,0x3dc93f7f3f808000,0xbe95bf75bf7b3e48,0x3e483f7b3f808000,0xbf0ebf55bf6d3ec4,0x3e953f753f808000,0xbf46bf22bf553f0e
.quad 0x3ec43f6d3f808000,0xbf6dbec4bf353f35,0x3ef13f623f808000,0xbf7fbdc9bf0e3f55,0x3f0e3f553f808000,0xbf7b3e48bec43f6d,0x3f223f463f808000,0xbf623ef1be483f7b
.quad 0x3f353f353f808000,0xbf353f35a5543f80,0x3f463f223f808000,0xbef13f623e483f7b,0x3f553f0e3f808000,0xbe483f7b3ec43f6d,0x3f623ef13f808000,0x3dc93f7f3f0e3f55
.quad 0x3f6d3ec43f808000,0x3ec43f6d3f353f35,0x3f753e953f808000,0x3f223f463f553f0e,0x3f7b3e483f808000,0x3f553f0e3f6d3ec4,0x3f7f3dc93f808000,0x3f753e953f7b3e48
.quad 0xa5543f803f808000,0x248dbf80bf80a50d,0x3ef13f623f6dbec4,0xbf22bf46bf553f0e,0x3f553f0e3f35bf35,0xbf7bbe48bec43f6d,0x3f7f3dc93ec4bf6d,0xbf623ef13e483f7b
.quad 0x3f6dbec4248dbf80,0xbec43f6d3f353f35,0x3f22bf46bec4bf6d,0x3e953f753f7b3e48,0x3e48bf7bbf35bf35,0x3f553f0e3f6dbec4,0xbe95bf75bf6dbec4,0x3f7fbdc93f0ebf55
.quad 0xbf35bf35bf80a50d,0x3f35bf35248dbf80,0xbf75be95bf6d3ec4,0x3dc9bf7fbf0ebf55,0xbf7b3e48bf353f35,0xbf0ebf55bf6dbec4,0xbf463f22bec43f6d,0xbf75be95bf7b3e48
.quad 0xbec43f6da5543f80,0xbf6d3ec4bf353f35,0x3dc93f7f3ec43f6d,0xbef13f62be483f7b,0x3f0e3f553f353f35,0x3e483f7b3ec43f6d,0x3f623ef13f6d3ec4,0x3f463f223f553f0e
.quad 0xa5543f803f808000,0x248dbf80bf80a50d,0x3f463f223f35bf35,0xbf62bef1bf0e3f55,0x3f7bbe48248dbf80,0xbf553f0e3ec43f6d,0x3ef1bf62bf35bf35,0x3dc93f7f3f7b3e48
.quad 0xbec4bf6dbf80a50d,0x3f6d3ec43f35bf35,0xbf75be95bf353f35,0x3f46bf22be48bf7b,0xbf553f0ea5543f80,0xbe48bf7bbf6dbec4,0xbdc93f7f3f353f35,0xbf75be95bf553f0e
.quad 0x3f353f353f808000,0xbf353f35a5543f80,0x3f7fbdc93f35bf35,0x3e953f753f553f0e,0x3f0ebf55248dbf80,0x3f7b3e483f6dbec4,0xbe95bf75bf35bf35,0x3f22bf463e48bf7b
.quad 0xbf6dbec4bf80a50d,0xbec4bf6dbf35bf35,0xbf623ef1bf353f35,0xbf7fbdc9bf7b3e48,0xbe483f7ba5543f80,0xbf0e3f55bec43f6d,0x3f223f463f353f35,0x3ef13f623f0e3f55
.quad 0xa5543f803f808000,0x248dbf80bf80a50d,0x3f753e953ec4bf6d,0xbf7fbdc9be483f7b,0x3f0ebf55bf35bf35,0xbe483f7b3f6d3ec4,0xbf22bf46bf6d3ec4,0x3f753e953f0ebf55
.quad 0xbf6d3ec4a5543f80,0x3ec4bf6dbf35bf35,0x3dc93f7f3f6d3ec4,0xbf62bef1bf553f0e,0x3f7b3e483f35bf35,0xbf0e3f553ec43f6d,0x3ef1bf62bec4bf6d,0x3f463f223f7bbe48
.quad 0xbf35bf35bf80a50d,0x3f35bf35248dbf80,0xbf623ef1bec43f6d,0xbf22bf46bf7bbe48,0x3e483f7b3f353f35,0xbf553f0ebec43f6d,0x3f7f3dc93f6dbec4,0x3ef13f623f553f0e
.quad 0x3ec4bf6d248dbf80,0x3f6dbec43f35bf35,0xbf46bf22bf6dbec4,0xbe95bf75bf0ebf55,0xbf553f0ebf353f35,0xbf7b3e48bf6d3ec4,0x3e953f753ec43f6d,0x3dc93f7f3e483f7b
.quad 0xa5543f803f808000,0x248dbf80bf80a50d,0x3f7fbdc9248dbf80,0xbf753e953e483f7b,0xbe48bf7bbf80a50d,0x3f0e3f553f6dbec4,0xbf753e95a5543f80,0x3f22bf46bf0ebf55
.quad 0x3ec43f6d3f808000,0xbf6dbec4bf353f35,0x3f62bef1248dbf80,0xbdc93f7f3f553f0e,0xbf0ebf55bf80a50d,0x3f7bbe483ec4bf6d,0xbf463f22a5543f80,0xbef1bf62bf7bbe48
.quad 0x3f353f353f808000,0xbf353f35a5543f80,0x3f22bf46248dbf80,0x3f623ef13f7bbe48,0xbf55bf0ebf80a50d,0x3e48bf7bbec4bf6d,0xbef13f62a5543f80,0xbf7f3dc9bf553f0e
.quad 0x3f6d3ec43f808000,0x3ec43f6d3f353f35,0x3e95bf75248dbf80,0x3f46bf223f0ebf55,0xbf7bbe48bf80a50d,0xbf55bf0ebf6dbec4,0xbdc93f7fa5543f80,0xbe953f75be483f7b
.quad 0xa5543f803f808000,0x248dbf80bf80a50d,0x3f62bef1bec4bf6d,0xbf463f223f0e3f55,0xbf55bf0ebf353f35,0x3f7b3e483ec4bf6d,0xbdc93f7f3f6d3ec4,0xbef1bf62bf7b3e48
.quad 0x3f6dbec4248dbf80,0xbec43f6d3f353f35,0xbf46bf22bf6d3ec4,0x3f75be953e48bf7b,0xbe483f7b3f353f35,0xbf55bf0ebf6d3ec4,0x3f75be953ec4bf6d,0x3dc93f7f3f553f0e
.quad 0xbf35bf35bf80a50d,0x3f35bf35248dbf80,0xbe953f753ec43f6d,0xbf7fbdc9bf553f0e,0x3f7bbe483f35bf35,0x3f0e3f553f6d3ec4,0xbf22bf46bf6dbec4,0x3e95bf75be48bf7b
.quad 0xbec43f6da5543f80,0xbf6d3ec4bf353f35,0x3f7fbdc93f6dbec4,0x3f623ef13f7b3e48,0xbf0ebf55bf35bf35,0xbe48bf7bbec4bf6d,0xbef13f62bec43f6d,0xbf223f46bf0e3f55
.quad 0xa5543f803f808000,0x248dbf80bf80a50d,0x3f22bf46bf35bf35,0xbef13f623f553f0e,0xbf7b3e48a5543f80,0x3f55bf0ebec4bf6d,0x3f623ef13f35bf35,0xbf7f3dc9be483f7b
.quad 0xbec4bf6dbf80a50d,0x3f6d3ec43f35bf35,0xbe953f753f353f35,0xbf22bf46bf7b3e48,0x3f55bf0e248dbf80,0x3e483f7b3f6d3ec4,0xbf7fbdc9bf353f35,0x3e95bf75bf0ebf55
.quad 0x3f353f353f808000,0xbf353f35a5543f80,0xbdc9bf7fbf35bf35,0x3f75be953f0ebf55,0xbf0e3f55a5543f80,0xbf7bbe48bf6d3ec4,0x3f75be953f35bf35,0x3f463f223f7b3e48
.quad 0xbf6dbec4bf80a50d,0xbec4bf6dbf35bf35,0x3ef13f623f353f35,0xbdc93f7f3e483f7b,0x3e48bf7b248dbf80,0x3f0ebf553ec4bf6d,0xbf463f22bf353f35,0xbf623ef1bf553f0e
.quad 0xa5543f803f808000,0x248dbf80bf80a50d,0x3e95bf75bf6dbec4,0xbdc93f7f3f7b3e48,0xbf0e3f553f353f35,0x3e48bf7bbf6dbec4,0x3f46bf22bec4bf6d,0xbe953f753f553f0e
.quad 0xbf6d3ec4a5543f80,0x3ec4bf6dbf35bf35,0x3f7fbdc93ec4bf6d,0xbef13f623f0e3f55,0xbf7bbe48bf353f35,0x3f0ebf55bec4bf6d,0x3f623ef13f6dbec4,0xbf223f463e483f7b
.quad 0xbf35bf35bf80a50d,0x3f35bf35248dbf80,0x3ef13f623f6d3ec4,0xbf463f22be483f7b,0xbe48bf7bbf35bf35,0x3f55bf0e3ec4bf6d,0xbdc93f7f3ec43f6d,0xbf623ef1bf0e3f55
.quad 0x3ec4bf6d248dbf80,0x3f6dbec43f35bf35,0xbf223f46bec43f6d,0xbf753e95bf553f0e,0x3f55bf0e3f35bf35,0x3f7bbe483f6dbec4,0xbf753e95bf6d3ec4,0xbf7f3dc9bf7b3e48
.quad 0xa5543f803f808000,0x248dbf80bf80a50d,0xbdc9bf7fbf80a50d,0x3e953f753f7bbe48,0x3e483f7b3f808000,0xbf0ebf55bf6d3ec4,0xbe95bf75bf80a50d,0x3f463f223f55bf0e
.quad 0x3ec43f6d3f808000,0xbf6dbec4bf353f35,0xbef1bf62bf80a50d,0x3f7f3dc93f0ebf55,0x3f0e3f553f808000,0xbf7b3e48bec43f6d,0xbf22bf46bf80a50d,0x3f62bef13e48bf7b
.quad 0x3f353f353f808000,0xbf353f35a5543f80,0xbf46bf22bf80a50d,0x3ef1bf62be48bf7b,0x3f553f0e3f808000,0xbe483f7b3ec43f6d,0xbf62bef1bf80a50d,0xbdc9bf7fbf0ebf55
.quad 0x3f6d3ec43f808000,0x3ec43f6d3f353f35,0xbf75be95bf80a50d,0xbf22bf46bf55bf0e,0x3f7b3e483f808000,0x3f553f0e3f6d3ec4,0xbf7fbdc9bf80a50d,0xbf75be95bf7bbe48
.quad 0xa5543f803f808000,0x248dbf80bf80a50d,0xbef1bf62bf6d3ec4,0x3f223f463f55bf0e,0x3f553f0e3f35bf35,0xbf7bbe48bec43f6d,0xbf7fbdc9bec43f6d,0x3f62bef1be48bf7b
.quad 0x3f6dbec4248dbf80,0xbec43f6d3f353f35,0xbf223f463ec43f6d,0xbe95bf75bf7bbe48,0x3e48bf7bbf35bf35,0x3f553f0e3f6dbec4,0x3e953f753f6d3ec4,0xbf7f3dc9bf0e3f55
.quad 0xbf35bf35bf80a50d,0x3f35bf35248dbf80,0x3f753e953f6dbec4,0xbdc93f7f3f0e3f55,0xbf7b3e48bf353f35,0xbf0ebf55bf6dbec4,0x3f46bf223ec4bf6d,0x3f753e953f7bbe48
.quad 0xbec43f6da5543f80,0xbf6d3ec4bf353f35,0xbdc9bf7fbec4bf6d,0x3ef1bf623e48bf7b,0x3f0e3f553f353f35,0x3e483f7b3ec43f6d,0xbf62bef1bf6dbec4,0xbf46bf22bf55bf0e
.quad 0xa5543f803f808000,0x248dbf80bf80a50d,0xbf46bf22bf353f35,0x3f623ef13f0ebf55,0x3f7bbe48248dbf80,0xbf553f0e3ec43f6d,0xbef13f623f353f35,0xbdc9bf7fbf7bbe48
.quad 0xbec4bf6dbf80a50d,0x3f6d3ec43f35bf35,0x3f753e953f35bf35,0xbf463f223e483f7b,0xbf553f0ea5543f80,0xbe48bf7bbf6dbec4,0x3dc9bf7fbf35bf35,0x3f753e953f55bf0e
.quad 0x3f353f353f808000,0xbf353f35a5543f80,0xbf7f3dc9bf353f35,0xbe95bf75bf55bf0e,0x3f0ebf55248dbf80,0x3f7b3e483f6dbec4,0x3e953f753f353f35,0xbf223f46be483f7b
.quad 0xbf6dbec4bf80a50d,0xbec4bf6dbf35bf35,0x3f62bef13f35bf35,0x3f7f3dc93f7bbe48,0xbe483f7ba5543f80,0xbf0e3f55bec43f6d,0xbf22bf46bf35bf35,0xbef1bf62bf0ebf55
.quad 0xa5543f803f808000,0x248dbf80bf80a50d,0xbf75be95bec43f6d,0x3f7f3dc93e48bf7b,0x3f0ebf55bf35bf35,0xbe483f7b3f6d3ec4,0x3f223f463f6dbec4,0xbf75be95bf0e3f55
.quad 0xbf6d3ec4a5543f80,0x3ec4bf6dbf35bf35,0xbdc9bf7fbf6dbec4,0x3f623ef13f55bf0e,0x3f7b3e483f35bf35,0xbf0e3f553ec43f6d,0xbef13f623ec43f6d,0xbf46bf22bf7b3e48
.quad 0xbf35bf35bf80a50d,0x3f35bf35248dbf80,0x3f62bef13ec4bf6d,0x3f223f463f7b3e48,0x3e483f7b3f353f35,0xbf553f0ebec43f6d,0xbf7fbdc9bf6d3ec4,0xbef1bf62bf55bf0e
.quad 0x3ec4bf6d248dbf80,0x3f6dbec43f35bf35,0x3f463f223f6d3ec4,0x3e953f753f0e3f55,0xbf553f0ebf353f35,0xbf7b3e48bf6d3ec4,0xbe95bf75bec4bf6d,0xbdc9bf7fbe48bf7b
.quad 0xa5543f803f808000,0x248dbf80bf80a50d,0xbf7f3dc9a5543f80,0x3f75be95be48bf7b,0xbe48bf7bbf80a50d,0x3f0e3f553f6dbec4,0x3f75be95248dbf80,0xbf223f463f0e3f55
.quad 0x3ec43f6d3f808000,0xbf6dbec4bf353f35,0xbf623ef1a5543f80,0x3dc9bf7fbf55bf0e,0xbf0ebf55bf80a50d,0x3f7bbe483ec4bf6d,0x3f46bf22248dbf80,0x3ef13f623f7b3e48
.quad 0x3f353f353f808000,0xbf353f35a5543f80,0xbf223f46a5543f80,0xbf62bef1bf7b3e48,0xbf55bf0ebf80a50d,0x3e48bf7bbec4bf6d,0x3ef1bf62248dbf80,0x3f7fbdc93f55bf0e
.quad 0x3f6d3ec43f808000,0x3ec43f6d3f353f35,0xbe953f75a5543f80,0xbf463f22bf0e3f55,0xbf7bbe48bf80a50d,0xbf55bf0ebf6dbec4,0x3dc9bf7f248dbf80,0x3e95bf753e48bf7b
.quad 0xa5543f803f808000,0x248dbf80bf80a50d,0xbf623ef13ec43f6d,0x3f46bf22bf0ebf55,0xbf55bf0ebf353f35,0x3f7b3e483ec4bf6d,0x3dc9bf7fbf6dbec4,0x3ef13f623f7bbe48
.quad 0x3f6dbec4248dbf80,0xbec43f6d3f353f35,0x3f463f223f6dbec4,0xbf753e95be483f7b,0xbe483f7b3f353f35,0xbf55bf0ebf6d3ec4,0xbf753e95bec43f6d,0xbdc9bf7fbf55bf0e
.quad 0xbf35bf35bf80a50d,0x3f35bf35248dbf80,0x3e95bf75bec4bf6d,0x3f7f3dc93f55bf0e,0x3f7bbe483f35bf35,0x3f0e3f553f6d3ec4,0x3f223f463f6d3ec4,0xbe953f753e483f7b
.quad 0xbec43f6da5543f80,0xbf6d3ec4bf353f35,0xbf7f3dc9bf6d3ec4,0xbf62bef1bf7bbe48,0xbf0ebf55bf35bf35,0xbe48bf7bbec4bf6d,0x3ef1bf623ec4bf6d,0x3f22bf463f0ebf55
.quad 0xa5543f803f808000,0x248dbf80bf80a50d,0xbf223f463f353f35,0x3ef1bf62bf55bf0e,0xbf7b3e48a5543f80,0x3f55bf0ebec4bf6d,0xbf62bef1bf353f35,0x3f7fbdc93e48bf7b
.quad 0xbec4bf6dbf80a50d,0x3f6d3ec43f35bf35,0x3e95bf75bf35bf35,0x3f223f463f7bbe48,0x3f55bf0e248dbf80,0x3e483f7b3f6d3ec4,0x3f7f3dc93f35bf35,0xbe953f753f0e3f55
.quad 0x3f353f353f808000,0xbf353f35a5543f80,0x3dc93f7f3f353f35,0xbf753e95bf0e3f55,0xbf0e3f55a5543f80,0xbf7bbe48bf6d3ec4,0xbf753e95bf353f35,0xbf46bf22bf7bbe48
.quad 0xbf6dbec4bf80a50d,0xbec4bf6dbf35bf35,0xbef1bf62bf35bf35,0x3dc9bf7fbe48bf7b,0x3e48bf7b248dbf80,0x3f0ebf553ec4bf6d,0x3f46bf223f35bf35,0x3f62bef13f55bf0e
.quad 0xa5543f803f808000,0x248dbf80bf80a50d,0xbe953f753f6d3ec4,0x3dc9bf7fbf7bbe48,0xbf0e3f553f353f35,0x3e48bf7bbf6dbec4,0xbf463f223ec43f6d,0x3e95bf75bf55bf0e
.quad 0xbf6d3ec4a5543f80,0x3ec4bf6dbf35bf35,0xbf7f3dc9bec43f6d,0x3ef1bf62bf0ebf55,0xbf7bbe48bf353f35,0x3f0ebf55bec4bf6d,0xbf62bef1bf6d3ec4,0x3f22bf46be48bf7b
.quad 0xbf35bf35bf80a50d,0x3f35bf35248dbf80,0xbef1bf62bf6dbec4,0x3f46bf223e48bf7b,0xbe48bf7bbf35bf35,0x3f55bf0e3ec4bf6d,0x3dc9bf7fbec4bf6d,0x3f62bef13f0ebf55
.quad 0x3ec4bf6d248dbf80,0x3f6dbec43f35bf35,0x3f22bf463ec4bf6d,0x3f75be953f55bf0e,0x3f55bf0e3f35bf35,0x3f7bbe483f6dbec4,0x3f75be953f6dbec4,0x3f7fbdc93f7bbe48
.quad 0x3f803f803f803f80,0x3f803f803f803f80,0x3f553f6d3f7b3f80,0xbf55bf6dbf7bbf80,0x3ec43f353f6d3f80,0x3ec43f353f6d3f80,0xbe483ec43f553f80,0x3e48bec4bf55bf80
.quad 0xbf35248d3f353f80,0xbf35248d3f353f80,0xbf7bbec43f0e3f80,0x3f7b3ec4bf0ebf80,0xbf6dbf353ec43f80,0xbf6dbf353ec43f80,0xbf0ebf6d3e483f80,0x3f0e3f6dbe48bf80
.quad 0xa554bf80248d3f80,0xa554bf80248d3f80,0x3f0ebf6dbe483f80,0xbf0e3f6d3e48bf80,0x3f6dbf35bec43f80,0x3f6dbf35bec43f80,0x3f7bbec4bf0e3f80,0xbf7b3ec43f0ebf80
.quad 0x3f35a554bf353f80,0x3f35a554bf353f80,0x3e483ec4bf553f80,0xbe48bec43f55bf80,0xbec43f35bf6d3f80,0xbec43f35bf6d3f80,0xbf553f6dbf7b3f80,0x3f55bf6d3f7bbf80
.quad 0x3f803f803f803f80,0x3f803f803f803f80,0x3e483ec43f0e3f35,0xbe48bec4bf0ebf35,0xbf6dbf35bec4248d,0xbf6dbf35bec4248d,0xbf0ebf6dbf7bbf35,0x3f0e3f6d3f7b3f35
.quad 0x3f35a554bf35bf80,0x3f35a554bf35bf80,0x3f553f6d3e48bf35,0xbf55bf6dbe483f35,0xbec43f353f6da554,0xbec43f353f6da554,0xbf7bbec43f553f35,0x3f7b3ec4bf55bf35
.quad 0xa554bf80248d3f80,0xa554bf80248d3f80,0x3f7bbec4bf553f35,0xbf7b3ec43f55bf35,0x3ec43f35bf6d248d,0x3ec43f35bf6d248d,0xbf553f6dbe48bf35,0x3f55bf6d3e483f35
.quad 0xbf35248d3f35bf80,0xbf35248d3f35bf80,0x3f0ebf6d3f7bbf35,0xbf0e3f6dbf7b3f35,0x3f6dbf353ec4a554,0x3f6dbf353ec4a554,0xbe483ec4bf0e3f35,0x3e48bec43f0ebf35
.quad 0x3f803f803f803f80,0x3f803f803f803f80,0xbf0ebec4be48248d,0x3f0e3ec43e48a554,0xbec4bf35bf6dbf80,0xbec4bf35bf6dbf80,0x3f7b3f6d3f0ea554,0xbf7bbf6dbf0e248d
.quad 0xbf35248d3f353f80,0xbf35248d3f353f80,0xbe48bf6dbf55248d,0x3e483f6d3f55a554,0x3f6d3f35bec4bf80,0x3f6d3f35bec4bf80,0xbf553ec43f7ba554,0x3f55bec4bf7b248d
.quad 0xa554bf80248d3f80,0xa554bf80248d3f80,0x3f553ec4bf7b248d,0xbf55bec43f7ba554,0xbf6d3f353ec4bf80,0xbf6d3f353ec4bf80,0x3e48bf6d3f55a554,0xbe483f6dbf55248d
.quad 0x3f35a554bf353f80,0x3f35a554bf353f80,0xbf7b3f6dbf0e248d,0x3f7bbf6d3f0ea554,0x3ec4bf353f6dbf80,0x3ec4bf353f6dbf80,0x3f0ebec43e48a554,0xbf0e3ec4be48248d
.quad 0x3f803f803f803f80,0x3f803f803f803f80,0xbf7bbf6dbf55bf35,0x3f7b3f6d3f553f35,0x3f6d3f353ec4a554,0x3f6d3f353ec4a554,0xbf55bec43e483f35,0x3f553ec4be48bf35
.quad 0x3f35a554bf35bf80,0x3f35a554bf35bf80,0xbf0e3ec43f7b3f35,0x3f0ebec4bf7bbf35,0x3ec4bf35bf6d248d,0x3ec4bf35bf6d248d,0xbe483f6d3f0ebf35,0x3e48bf6dbf0e3f35
.quad 0xa554bf80248d3f80,0xa554bf80248d3f80,0x3e483f6dbf0ebf35,0xbe48bf6d3f0e3f35,0xbec4bf353f6da554,0xbec4bf353f6da554,0x3f0e3ec4bf7b3f35,0xbf0ebec43f7bbf35
.quad 0xbf35248d3f35bf80,0xbf35248d3f35bf80,0x3f55bec4be483f35,0xbf553ec43e48bf35,0xbf6d3f35bec4248d,0xbf6d3f35bec4248d,0x3f7bbf6d3f55bf35,0xbf7b3f6dbf553f35
.quad 0x0,0x0,0x3f0e3ec43e480000,0xbf0ebec4be48250d,0x3f6d3f353ec40000,0x3f6d3f353ec40000,0x3f7b3f6d3f0e0000,0xbf7bbf6dbf0e250d
.quad 0x3f353f803f350000,0x3f353f803f350000,0x3e483f6d3f550000,0xbe48bf6dbf55250d,0xbec43f353f6d0000,0xbec43f353f6d0000,0xbf553ec43f7b0000,0x3f55bec4bf7b250d
.quad 0xbf80250d3f800000,0xbf80250d3f800000,0xbf55bec43f7b0000,0x3f553ec4bf7b250d,0xbec4bf353f6d0000,0xbec4bf353f6d0000,0x3e48bf6d3f550000,0xbe483f6dbf55250d
.quad 0x3f35bf803f350000,0x3f35bf803f350000,0x3f7bbf6d3f0e0000,0xbf7b3f6dbf0e250d,0x3f6dbf353ec40000,0x3f6dbf353ec40000,0x3f0ebec43e480000,0xbf0e3ec4be48250d
.quad 0x0,0x0,0x3f7b3f6d3f553f35,0xbf7bbf6dbf55bf35,0x3ec43f353f6d3f80,0x3ec43f353f6d3f80,0xbf55bec43e483f35,0x3f553ec4be48bf35
.quad 0xbf35bf80bf35250d,0xbf35bf80bf35250d,0x3f0ebec4bf7bbf35,0xbf0e3ec43f7b3f35,0x3f6d3f35bec4bf80,0x3f6d3f35bec4bf80,0xbe483f6d3f0ebf35,0x3e48bf6dbf0e3f35
.quad 0xbf80250d3f800000,0xbf80250d3f800000,0xbe48bf6d3f0e3f35,0x3e483f6dbf0ebf35,0x3f6dbf35bec43f80,0x3f6dbf35bec43f80,0x3f0e3ec4bf7b3f35,0xbf0ebec43f7bbf35
.quad 0xbf353f80bf35250d,0xbf353f80bf35250d,0xbf553ec43e48bf35,0x3f55bec4be483f35,0x3ec4bf353f6dbf80,0x3ec4bf353f6dbf80,0x3f7bbf6d3f55bf35,0xbf7b3f6dbf553f35
.quad 0x0,0x0,0x3f553f6d3f7b3f80,0xbf55bf6dbf7bbf80,0xbf6dbf35bec4250d,0xbf6dbf35bec4250d,0x3e48bec4bf55bf80,0xbe483ec43f553f80
.quad 0x3f353f803f350000,0x3f353f803f350000,0xbf7bbec43f0e3f80,0x3f7b3ec4bf0ebf80,0x3ec4bf35bf6d250d,0x3ec4bf35bf6d250d,0x3f0e3f6dbe48bf80,0xbf0ebf6d3e483f80
.quad 0xbf80250d3f800000,0xbf80250d3f800000,0x3f0ebf6dbe483f80,0xbf0e3f6d3e48bf80,0x3ec43f35bf6d250d,0x3ec43f35bf6d250d,0xbf7b3ec43f0ebf80,0x3f7bbec4bf0e3f80
.quad 0x3f35bf803f350000,0x3f35bf803f350000,0x3e483ec4bf553f80,0xbe48bec43f55bf80,0xbf6d3f35bec4250d,0xbf6d3f35bec4250d,0x3f55bf6d3f7bbf80,0xbf553f6dbf7b3f80
.quad 0x0,0x0,0x3e483ec43f0e3f35,0xbe48bec4bf0ebf35,0xbec4bf35bf6dbf80,0xbec4bf35bf6dbf80,0x3f0e3f6d3f7b3f35,0xbf0ebf6dbf7bbf35
.quad 0xbf35bf80bf35250d,0xbf35bf80bf35250d,0x3f553f6d3e48bf35,0xbf55bf6dbe483f35,0xbf6dbf353ec43f80,0xbf6dbf353ec43f80,0x3f7b3ec4bf55bf35,0xbf7bbec43f553f35
.quad 0xbf80250d3f800000,0xbf80250d3f800000,0x3f7bbec4bf553f35,0xbf7b3ec43f55bf35,0xbf6d3f353ec4bf80,0xbf6d3f353ec4bf80,0x3f55bf6d3e483f35,0xbf553f6dbe48bf35
.quad 0xbf353f80bf35250d,0xbf353f80bf35250d,0x3f0ebf6d3f7bbf35,0xbf0e3f6dbf7b3f35,0xbec43f35bf6d3f80,0xbec43f35bf6d3f80,0x3e48bec43f0ebf35,0xbe483ec4bf0e3f35
.quad 0x8000800080008000,0x8000800080008000,0xbf0ebec4be488000,0x3f0e3ec43e48a50d,0xbf6dbf35bec48000,0xbf6dbf35bec48000,0xbf7bbf6dbf0e8000,0x3f7b3f6d3f0ea50d
.quad 0xbf35bf80bf358000,0xbf35bf80bf358000,0xbe48bf6dbf558000,0x3e483f6d3f55a50d,0x3ec4bf35bf6d8000,0x3ec4bf35bf6d8000,0x3f55bec4bf7b8000,0xbf553ec43f7ba50d
.quad 0x3f80a50dbf808000,0x3f80a50dbf808000,0x3f553ec4bf7b8000,0xbf55bec43f7ba50d,0x3ec43f35bf6d8000,0x3ec43f35bf6d8000,0xbe483f6dbf558000,0x3e48bf6d3f55a50d
.quad 0xbf353f80bf358000,0xbf353f80bf358000,0xbf7b3f6dbf0e8000,0x3f7bbf6d3f0ea50d,0xbf6d3f35bec48000,0xbf6d3f35bec48000,0xbf0e3ec4be488000,0x3f0ebec43e48a50d
.quad 0x8000800080008000,0x8000800080008000,0xbf7bbf6dbf55bf35,0x3f7b3f6d3f553f35,0xbec4bf35bf6dbf80,0xbec4bf35bf6dbf80,0x3f553ec4be48bf35,0xbf55bec43e483f35
.quad 0x3f353f803f35a50d,0x3f353f803f35a50d,0xbf0e3ec43f7b3f35,0x3f0ebec4bf7bbf35,0xbf6dbf353ec43f80,0xbf6dbf353ec43f80,0x3e48bf6dbf0e3f35,0xbe483f6d3f0ebf35
.quad 0x3f80a50dbf808000,0x3f80a50dbf808000,0x3e483f6dbf0ebf35,0xbe48bf6d3f0e3f35,0xbf6d3f353ec4bf80,0xbf6d3f353ec4bf80,0xbf0ebec43f7bbf35,0x3f0e3ec4bf7b3f35
.quad 0x3f35bf803f35a50d,0x3f35bf803f35a50d,0x3f55bec4be483f35,0xbf553ec43e48bf35,0xbec43f35bf6d3f80,0xbec43f35bf6d3f80,0xbf7b3f6dbf553f35,0x3f7bbf6d3f55bf35
.quad 0x8000800080008000,0x8000800080008000,0xbf55bf6dbf7bbf80,0x3f553f6d3f7b3f80,0x3f6d3f353ec4a50d,0x3f6d3f353ec4a50d,0xbe483ec43f553f80,0x3e48bec4bf55bf80
.quad 0xbf35bf80bf358000,0xbf35bf80bf358000,0x3f7b3ec4bf0ebf80,0xbf7bbec43f0e3f80,0xbec43f353f6da50d,0xbec43f353f6da50d,0xbf0ebf6d3e483f80,0x3f0e3f6dbe48bf80
.quad 0x3f80a50dbf808000,0x3f80a50dbf808000,0xbf0e3f6d3e48bf80,0x3f0ebf6dbe483f80,0xbec4bf353f6da50d,0xbec4bf353f6da50d,0x3f7bbec4bf0e3f80,0xbf7b3ec43f0ebf80
.quad 0xbf353f80bf358000,0xbf353f80bf358000,0xbe48bec43f55bf80,0x3e483ec4bf553f80,0x3f6dbf353ec4a50d,0x3f6dbf353ec4a50d,0xbf553f6dbf7b3f80,0x3f55bf6d3f7bbf80
.quad 0x8000800080008000,0x8000800080008000,0xbe48bec4bf0ebf35,0x3e483ec43f0e3f35,0x3ec43f353f6d3f80,0x3ec43f353f6d3f80,0xbf0ebf6dbf7bbf35,0x3f0e3f6d3f7b3f35
.quad 0x3f353f803f35a50d,0x3f353f803f35a50d,0xbf55bf6dbe483f35,0x3f553f6d3e48bf35,0x3f6d3f35bec4bf80,0x3f6d3f35bec4bf80,0xbf7bbec43f553f35,0x3f7b3ec4bf55bf35
.quad 0x3f80a50dbf808000,0x3f80a50dbf808000,0xbf7b3ec43f55bf35,0x3f7bbec4bf553f35,0x3f6dbf35bec43f80,0x3f6dbf35bec43f80,0xbf553f6dbe48bf35,0x3f55bf6d3e483f35
.quad 0x3f35bf803f35a50d,0x3f35bf803f35a50d,0xbf0e3f6dbf7b3f35,0x3f0ebf6d3f7bbf35,0x3ec4bf353f6dbf80,0x3ec4bf353f6dbf80,0xbe483ec4bf0e3f35,0x3e48bec43f0ebf35
.quad 0xbf803f80bf803f80,0xbf803f80bf803f80,0xbf553f6dbf7b3f80,0x3f55bf6d3f7bbf80,0xbec43f35bf6d3f80,0xbec43f35bf6d3f80,0x3e483ec4bf553f80,0xbe48bec43f55bf80
.quad 0x3f35248dbf353f80,0x3f35248dbf353f80,0x3f7bbec4bf0e3f80,0xbf7b3ec43f0ebf80,0x3f6dbf35bec43f80,0x3f6dbf35bec43f80,0x3f0ebf6dbe483f80,0xbf0e3f6d3e48bf80
.quad 0x248dbf80a5543f80,0x248dbf80a5543f80,0xbf0ebf6d3e483f80,0x3f0e3f6dbe48bf80,0xbf6dbf353ec43f80,0xbf6dbf353ec43f80,0xbf7bbec43f0e3f80,0x3f7b3ec4bf0ebf80
.quad 0xbf35a5543f353f80,0xbf35a5543f353f80,0xbe483ec43f553f80,0x3e48bec4bf55bf80,0x3ec43f353f6d3f80,0x3ec43f353f6d3f80,0x3f553f6d3f7b3f80,0xbf55bf6dbf7bbf80
.quad 0xbf803f80bf803f80,0xbf803f80bf803f80,0xbe483ec4bf0e3f35,0x3e48bec43f0ebf35,0x3f6dbf353ec4248d,0x3f6dbf353ec4248d,0x3f0ebf6d3f7bbf35,0xbf0e3f6dbf7b3f35
.quad 0xbf35a5543f35bf80,0xbf35a5543f35bf80,0xbf553f6dbe48bf35,0x3f55bf6d3e483f35,0x3ec43f35bf6da554,0x3ec43f35bf6da554,0x3f7bbec4bf553f35,0xbf7b3ec43f55bf35
.quad 0x248dbf80a5543f80,0x248dbf80a5543f80,0xbf7bbec43f553f35,0x3f7b3ec4bf55bf35,0xbec43f353f6d248d,0xbec43f353f6d248d,0x3f553f6d3e48bf35,0xbf55bf6dbe483f35
.quad 0x3f35248dbf35bf80,0x3f35248dbf35bf80,0xbf0ebf6dbf7bbf35,0x3f0e3f6d3f7b3f35,0xbf6dbf35bec4a554,0xbf6dbf35bec4a554,0x3e483ec43f0e3f35,0xbe48bec4bf0ebf35
.quad 0xbf803f80bf803f80,0xbf803f80bf803f80,0x3f0ebec43e48248d,0xbf0e3ec4be48a554,0x3ec4bf353f6dbf80,0x3ec4bf353f6dbf80,0xbf7b3f6dbf0ea554,0x3f7bbf6d3f0e248d
.quad 0x3f35248dbf353f80,0x3f35248dbf353f80,0x3e48bf6d3f55248d,0xbe483f6dbf55a554,0xbf6d3f353ec4bf80,0xbf6d3f353ec4bf80,0x3f553ec4bf7ba554,0xbf55bec43f7b248d
.quad 0x248dbf80a5543f80,0x248dbf80a5543f80,0xbf553ec43f7b248d,0x3f55bec4bf7ba554,0x3f6d3f35bec4bf80,0x3f6d3f35bec4bf80,0xbe48bf6dbf55a554,0x3e483f6d3f55248d
.quad 0xbf35a5543f353f80,0xbf35a5543f353f80,0x3f7b3f6d3f0e248d,0xbf7bbf6dbf0ea554,0xbec4bf35bf6dbf80,0xbec4bf35bf6dbf80,0xbf0ebec4be48a554,0x3f0e3ec43e48248d
.quad 0xbf803f80bf803f80,0xbf803f80bf803f80,0x3f7bbf6d3f55bf35,0xbf7b3f6dbf553f35,0xbf6d3f35bec4a554,0xbf6d3f35bec4a554,0x3f55bec4be483f35,0xbf553ec43e48bf35
.quad 0xbf35a5543f35bf80,0xbf35a5543f35bf80,0x3f0e3ec4bf7b3f35,0xbf0ebec43f7bbf35,0xbec4bf353f6d248d,0xbec4bf353f6d248d,0x3e483f6dbf0ebf35,0xbe48bf6d3f0e3f35
.quad 0x248dbf80a5543f80,0x248dbf80a5543f80,0xbe483f6d3f0ebf35,0x3e48bf6dbf0e3f35,0x3ec4bf35bf6da554,0x3ec4bf35bf6da554,0xbf0e3ec43f7b3f35,0x3f0ebec4bf7bbf35
.quad 0x3f35248dbf35bf80,0x3f35248dbf35bf80,0xbf55bec43e483f35,0x3f553ec4be48bf35,0x3f6d3f353ec4248d,0x3f6d3f353ec4248d,0xbf7bbf6dbf55bf35,0x3f7b3f6d3f553f35
.quad 0x250d0000250d0000,0x250d0000250d0000,0xbf0e3ec4be480000,0x3f0ebec43e48250d,0xbf6d3f35bec40000,0xbf6d3f35bec40000,0xbf7b3f6dbf0e0000,0x3f7bbf6d3f0e250d
.quad 0xbf353f80bf350000,0xbf353f80bf350000,0xbe483f6dbf550000,0x3e48bf6d3f55250d,0x3ec43f35bf6d0000,0x3ec43f35bf6d0000,0x3f553ec4bf7b0000,0xbf55bec43f7b250d
.quad 0x3f80250dbf800000,0x3f80250dbf800000,0x3f55bec4bf7b0000,0xbf553ec43f7b250d,0x3ec4bf35bf6d0000,0x3ec4bf35bf6d0000,0xbe48bf6dbf550000,0x3e483f6d3f55250d
.quad 0xbf35bf80bf350000,0xbf35bf80bf350000,0xbf7bbf6dbf0e0000,0x3f7b3f6d3f0e250d,0xbf6dbf35bec40000,0xbf6dbf35bec40000,0xbf0ebec4be480000,0x3f0e3ec43e48250d
.quad 0x250d0000250d0000,0x250d0000250d0000,0xbf7b3f6dbf553f35,0x3f7bbf6d3f55bf35,0xbec43f35bf6d3f80,0xbec43f35bf6d3f80,0x3f55bec4be483f35,0xbf553ec43e48bf35
.quad 0x3f35bf803f35250d,0x3f35bf803f35250d,0xbf0ebec43f7bbf35,0x3f0e3ec4bf7b3f35,0xbf6d3f353ec4bf80,0xbf6d3f353ec4bf80,0x3e483f6dbf0ebf35,0xbe48bf6d3f0e3f35
.quad 0x3f80250dbf800000,0x3f80250dbf800000,0x3e48bf6dbf0e3f35,0xbe483f6d3f0ebf35,0xbf6dbf353ec43f80,0xbf6dbf353ec43f80,0xbf0e3ec43f7b3f35,0x3f0ebec4bf7bbf35
.quad 0x3f353f803f35250d,0x3f353f803f35250d,0x3f553ec4be48bf35,0xbf55bec43e483f35,0xbec4bf35bf6dbf80,0xbec4bf35bf6dbf80,0xbf7bbf6dbf55bf35,0x3f7b3f6d3f553f35
.quad 0x250d0000250d0000,0x250d0000250d0000,0xbf553f6dbf7b3f80,0x3f55bf6d3f7bbf80,0x3f6dbf353ec4250d,0x3f6dbf353ec4250d,0xbe48bec43f55bf80,0x3e483ec4bf553f80
.quad 0xbf353f80bf350000,0xbf353f80bf350000,0x3f7bbec4bf0e3f80,0xbf7b3ec43f0ebf80,0xbec4bf353f6d250d,0xbec4bf353f6d250d,0xbf0e3f6d3e48bf80,0x3f0ebf6dbe483f80
.quad 0x3f80250dbf800000,0x3f80250dbf800000,0xbf0ebf6d3e483f80,0x3f0e3f6dbe48bf80,0xbec43f353f6d250d,0xbec43f353f6d250d,0x3f7b3ec4bf0ebf80,0xbf7bbec43f0e3f80
.quad 0xbf35bf80bf350000,0xbf35bf80bf350000,0xbe483ec43f553f80,0x3e48bec4bf55bf80,0x3f6d3f353ec4250d,0x3f6d3f353ec4250d,0xbf55bf6dbf7bbf80,0x3f553f6d3f7b3f80
.quad 0x250d0000250d0000,0x250d0000250d0000,0xbe483ec4bf0e3f35,0x3e48bec43f0ebf35,0x3ec4bf353f6dbf80,0x3ec4bf353f6dbf80,0xbf0e3f6dbf7b3f35,0x3f0ebf6d3f7bbf35
.quad 0x3f35bf803f35250d,0x3f35bf803f35250d,0xbf553f6dbe48bf35,0x3f55bf6d3e483f35,0x3f6dbf35bec43f80,0x3f6dbf35bec43f80,0xbf7b3ec43f55bf35,0x3f7bbec4bf553f35
.quad 0x3f80250dbf800000,0x3f80250dbf800000,0xbf7bbec43f553f35,0x3f7b3ec4bf55bf35,0x3f6d3f35bec4bf80,0x3f6d3f35bec4bf80,0xbf55bf6dbe483f35,0x3f553f6d3e48bf35
.quad 0x3f353f803f35250d,0x3f353f803f35250d,0xbf0ebf6dbf7bbf35,0x3f0e3f6d3f7b3f35,0x3ec43f353f6d3f80,0x3ec43f353f6d3f80,0xbe48bec4bf0ebf35,0x3e483ec43f0e3f35
.quad 0xa50d8000a50d8000,0xa50d8000a50d8000,0x3f0ebec43e488000,0xbf0e3ec4be48a50d,0x3f6dbf353ec48000,0x3f6dbf353ec48000,0x3f7bbf6d3f0e8000,0xbf7b3f6dbf0ea50d
.quad 0x3f35bf803f358000,0x3f35bf803f358000,0x3e48bf6d3f558000,0xbe483f6dbf55a50d,0xbec4bf353f6d8000,0xbec4bf353f6d8000,0xbf55bec43f7b8000,0x3f553ec4bf7ba50d
.quad 0xbf80a50d3f808000,0xbf80a50d3f808000,0xbf553ec43f7b8000,0x3f55bec4bf7ba50d,0xbec43f353f6d8000,0xbec43f353f6d8000,0x3e483f6d3f558000,0xbe48bf6dbf55a50d
.quad 0x3f353f803f358000,0x3f353f803f358000,0x3f7b3f6d3f0e8000,0xbf7bbf6dbf0ea50d,0x3f6d3f353ec48000,0x3f6d3f353ec48000,0x3f0e3ec43e488000,0xbf0ebec4be48a50d
.quad 0xa50d8000a50d8000,0xa50d8000a50d8000,0x3f7bbf6d3f55bf35,0xbf7b3f6dbf553f35,0x3ec4bf353f6dbf80,0x3ec4bf353f6dbf80,0xbf553ec43e48bf35,0x3f55bec4be483f35
.quad 0xbf353f80bf35a50d,0xbf353f80bf35a50d,0x3f0e3ec4bf7b3f35,0xbf0ebec43f7bbf35,0x3f6dbf35bec43f80,0x3f6dbf35bec43f80,0xbe48bf6d3f0e3f35,0x3e483f6dbf0ebf35
.quad 0xbf80a50d3f808000,0xbf80a50d3f808000,0xbe483f6d3f0ebf35,0x3e48bf6dbf0e3f35,0x3f6d3f35bec4bf80,0x3f6d3f35bec4bf80,0x3f0ebec4bf7bbf35,0xbf0e3ec43f7b3f35
.quad 0xbf35bf80bf35a50d,0xbf35bf80bf35a50d,0xbf55bec43e483f35,0x3f553ec4be48bf35,0x3ec43f353f6d3f80,0x3ec43f353f6d3f80,0x3f7b3f6d3f553f35,0xbf7bbf6dbf55bf35
.quad 0xa50d8000a50d8000,0xa50d8000a50d8000,0x3f55bf6d3f7bbf80,0xbf553f6dbf7b3f80,0xbf6d3f35bec4a50d,0xbf6d3f35bec4a50d,0x3e483ec4bf553f80,0xbe48bec43f55bf80
.quad 0x3f35bf803f358000,0x3f35bf803f358000,0xbf7b3ec43f0ebf80,0x3f7bbec4bf0e3f80,0x3ec43f35bf6da50d,0x3ec43f35bf6da50d,0x3f0ebf6dbe483f80,0xbf0e3f6d3e48bf80
.quad 0xbf80a50d3f808000,0xbf80a50d3f808000,0x3f0e3f6dbe48bf80,0xbf0ebf6d3e483f80,0x3ec4bf35bf6da50d,0x3ec4bf35bf6da50d,0xbf7bbec43f0e3f80,0x3f7b3ec4bf0ebf80
.quad 0x3f353f803f358000,0x3f353f803f358000,0x3e48bec4bf55bf80,0xbe483ec43f553f80,0xbf6dbf35bec4a50d,0xbf6dbf35bec4a50d,0x3f553f6d3f7b3f80,0xbf55bf6dbf7bbf80
.quad 0xa50d8000a50d8000,0xa50d8000a50d8000,0x3e48bec43f0ebf35,0xbe483ec4bf0e3f35,0xbec43f35bf6d3f80,0xbec43f35bf6d3f80,0x3f0ebf6d3f7bbf35,0xbf0e3f6dbf7b3f35
.quad 0xbf353f80bf35a50d,0xbf353f80bf35a50d,0x3f55bf6d3e483f35,0xbf553f6dbe48bf35,0xbf6d3f353ec4bf80,0xbf6d3f353ec4bf80,0x3f7bbec4bf553f35,0xbf7b3ec43f55bf35
.quad 0xbf80a50d3f808000,0xbf80a50d3f808000,0x3f7b3ec4bf55bf35,0xbf7bbec43f553f35,0xbf6dbf353ec43f80,0xbf6dbf353ec43f80,0x3f553f6d3e48bf35,0xbf55bf6dbe483f35
.quad 0xbf35bf80bf35a50d,0xbf35bf80bf35a50d,0x3f0e3f6d3f7b3f35,0xbf0ebf6dbf7bbf35,0xbec4bf35bf6dbf80,0xbec4bf35bf6dbf80,0x3e483ec43f0e3f35,0xbe48bec4bf0ebf35
.quad 0x800000003f800000,0x800000003f800000,0x800000003f800000,0xbb490fc63f7fffb1,0x800000003f800000,0xbbc90f883f7ffec4,0x800000003f800000,0xbc16cb583f7ffd39
.quad 0x800000003f800000,0xbc490e903f7ffb11,0x800000003f800000,0xbc7b514b3f7ff84a,0x800000003f800000,0xbc96c9b63f7ff4e6,0x800000003f800000,0xbcafea693f7ff0e3
.quad 0x800000003f800000,0xbcc90ab03f7fec43,0x800000003f800000,0xbce22a7a3f7fe705,0x800000003f800000,0xbcfb49ba3f7fe129,0x800000003f800000,0xbd0a342f3f7fdaaf
.quad 0x800000003f800000,0xbd16c32c3f7fd397,0x800000003f800000,0xbd2351cb3f7fcbe2,0x800000003f800000,0xbd2fe0073f7fc38f,0x800000003f800000,0xbd3c6dd53f7fba9e
.quad 0x800000003f800000,0x800000003f800000,0xbc490e903f7ffb11,0xbc7b514b3f7ff84a,0xbcc90ab03f7fec43,0xbcfb49ba3f7fe129,0xbd16c32c3f7fd397,0xbd3c6dd53f7fba9e
.quad 0xbd48fb303f7fb10f,0xbd7b2b743f7f84ab,0xbd7b2b743f7f84ab,0xbd9cecf93f7f3f54,0xbd96a9053f7f4e6d,0xbdbc3ac33f7eea9d,0xbdafb6803f7f0e58,0xbddb7d373f7e868b
.quad 0xbdc8bd363f7ec46d,0xbdfab2733f7e1324,0xbde1bc2e3f7e70b0,0xbe0cec4a3f7d906e,0xbdfab2733f7e1324,0xbe1c76de3f7cfe73,0xbe09cf863f7dabcc,0xbe2bf8043f7c5d3a
.quad 0xbe1640833f7d3aac,0xbe3b6ecf3f7baccd,0xbe22abb63f7cbfc9,0xbe4ada4f3f7aed37,0xbe2f10a23f7c3b28,0xbe5a39973f7a1e84,0xbe3b6ecf3f7baccd,0xbe698bba3f7940c0
.quad 0x800000003f800000,0x800000003f800000,0xbcc90ab03f7fec43,0xbce22a7a3f7fe705,0xbd48fb303f7fb10f,0xbd6214693f7f9c18,0xbd96a9053f7f4e6d,0xbda973ba3f7f1f49
.quad 0xbdc8bd363f7ec46d,0xbde1bc2e3f7e70b0,0xbdfab2733f7e1324,0xbe0cec4a3f7d906e,0xbe1640833f7d3aac,0xbe28defc3f7c7eb0,0xbe2f10a23f7c3b28,0xbe44b0b93f7b3bab
.quad 0xbe47c5c23f7b14be,0xbe605c133f79c79d,0xbe605c133f79c79d,0xbe7bdba43f7822d1,0xbe78cfcc3f7853f8,0xbe8b95073f764d97,0xbe888e933f76ba07,0xbe9920fe3f74484b
.quad 0xbe94a0313f74fa0b,0xbea68f123f721352,0xbea09ae53f731447,0xbeb3dca53f6faf1b,0xbeac7cd43f710908,0xbec1071e3f6d1c1d,0xbeb8442a3f6ed89e,0xbece0bea3f6a5ad9
.quad 0x800000003f800000,0x800000003f800000,0xbd16c32c3f7fd397,0xbd2351cb3f7fcbe2,0xbd96a9053f7f4e6d,0xbda3308c3f7f2f9d,0xbde1bc2e3f7e70b0,0xbdf475c03f7e2b72
.quad 0xbe1640833f7d3aac,0xbe22abb63f7cbfc9,0xbe3b6ecf3f7baccd,0xbe4ada4f3f7aed37,0xbe605c133f79c79d,0xbe72b6513f78b47b,0xbe827dc03f778bc5,0xbe8d17c03f76167a
.quad 0xbe94a0313f74fa0b,0xbea09ae53f731447,0xbea68f123f721352,0xbeb3dca53f6faf1b,0xbeb8442a3f6ed89e,0xbec6d5293f6be858,0xbec9b9533f6b4b0c,0xbed97cb93f67c187
.quad 0xbedae8803f676bd8,0xbeebcbbb3f633c5a,0xbeebcbbb3f633c5a,0xbefdbabb3f5e5aa6,0xbefc5d273f5ebe05,0xbf07a1363f591e6a,0xbf064b823f59f26a,0xbf102dd53f5389c7
.quad 0x800000003f800000,0x800000003f800000,0xbbc90f883f7ffec4,0xbc16cb583f7ffd39,0xbc490e903f7ffb11,0xbc96c9b63f7ff4e6,0xbc96c9b63f7ff4e6,0xbce22a7a3f7fe705
.quad 0xbcc90ab03f7fec43,0xbd16c32c3f7fd397,0xbcfb49ba3f7fe129,0xbd3c6dd53f7fba9e,0xbd16c32c3f7fd397,0xbd6214693f7f9c18,0xbd2fe0073f7fc38f,0xbd83db0a3f7f7808
.quad 0xbd48fb303f7fb10f,0xbd96a9053f7f4e6d,0xbd6214693f7f9c18,0xbda973ba3f7f1f49,0xbd7b2b743f7f84ab,0xbdbc3ac33f7eea9d,0xbd8a200a3f7f6ac7,0xbdcefdb73f7eb069
.quad 0xbd96a9053f7f4e6d,0xbde1bc2e3f7e70b0,0xbda3308c3f7f2f9d,0xbdf475c03f7e2b72,0xbdafb6803f7f0e58,0xbe0395023f7de0b1,0xbdbc3ac33f7eea9d,0xbe0cec4a3f7d906e
.quad 0x800000003f800000,0x800000003f800000,0xbc96c9b63f7ff4e6,0xbcafea693f7ff0e3,0xbd16c32c3f7fd397,0xbd2fe0073f7fc38f,0xbd6214693f7f9c18,0xbd83db0a3f7f7808
.quad 0xbd96a9053f7f4e6d,0xbdafb6803f7f0e58,0xbdbc3ac33f7eea9d,0xbddb7d373f7e868b,0xbde1bc2e3f7e70b0,0xbe0395023f7de0b1,0xbe0395023f7de0b1,0xbe195be03f7d1cdd
.quad 0xbe1640833f7d3aac,0xbe2f10a23f7c3b28,0xbe28defc3f7c7eb0,0xbe44b0b93f7b3bab,0xbe3b6ecf3f7baccd,0xbe5a39973f7a1e84,0xbe4dee603f7ac516,0xbe6fa8b23f78e3d6
.quad 0xbe605c133f79c79d,0xbe827dc03f778bc5,0xbe72b6513f78b47b,0xbe8d17c03f76167a,0xbe827dc03f778bc5,0xbe97a1173f748422,0xbe8b95073f764d97,0xbea218873f72d4eb
.quad 0x800000003f800000,0x800000003f800000,0xbcfb49ba3f7fe129,0xbd0a342f3f7fdaaf,0xbd7b2b743f7f84ab,0xbd8a200a3f7f6ac7,0xbdbc3ac33f7eea9d,0xbdcefdb73f7eb069
.quad 0xbdfab2733f7e1324,0xbe09cf863f7dabcc,0xbe1c76de3f7cfe73,0xbe2bf8043f7c5d3a,0xbe3b6ecf3f7baccd,0xbe4dee603f7ac516,0xbe5a39973f7a1e84,0xbe6fa8b23f78e3d6
.quad 0xbe78cfcc3f7853f8,0xbe888e933f76ba07,0xbe8b95073f764d97,0xbe9920fe3f74484b,0xbe9aa0863f740bdd,0xbea986c43f718f57,0xbea986c43f718f57,0xbeb9bb1e3f6e8ff8
.quad 0xbeb8442a3f6ed89e,0xbec9b9533f6b4b0c,0xbec6d5293f6be858,0xbed97cb93f67c187,0xbed536413f68bf3c,0xbee900b73f63f473,0xbee363fa3f655e0b,0xbef840c83f5fe4e9
.quad 0x800000003f800000,0x800000003f800000,0xbd2fe0073f7fc38f,0xbd3c6dd53f7fba9e,0xbdafb6803f7f0e58,0xbdbc3ac33f7eea9d,0xbe0395023f7de0b1,0xbe0cec4a3f7d906e
.quad 0xbe2f10a23f7c3b28,0xbe3b6ecf3f7baccd,0xbe5a39973f7a1e84,0xbe698bba3f7940c0,0xbe827dc03f778bc5,0xbe8b95073f764d97,0xbe97a1173f748422,0xbea218873f72d4eb
.quad 0xbeac7cd43f710908,0xbeb8442a3f6ed89e,0xbec1071e3f6d1c1d,0xbece0bea3f6a5ad9,0xbed536413f68bf3c,0xbee363fa3f655e0b,0xbee900b73f63f473,0xbef840c83f5fe4e9
.quad 0xbefc5d273f5ebe05,0xbf064b823f59f26a,0xbf07a1363f591e6a,0xbf102dd53f5389c7,0xbf10d3cd3f531849,0xbf19c2003f4cae79,0xbf19c2003f4cae79,0xbf2302d33f456439
.quad 0x800000003f800000,0x800000003f800000,0xbd48fb303f7fb10f,0xbd55880e3f7fa6e3,0xbdc8bd363f7ec46d,0xbdd53db93f7e9bc9,0xbe1640833f7d3aac,0xbe1f917b3f7cdf6c
.quad 0xbe47c5c23f7b14be,0xbe5415013f7a7302,0xbe78cfcc3f7853f8,0xbe8402703f77583a,0xbe94a0313f74fa0b,0xbe9d9e783f73913f,0xbeac7cd43f710908,0xbeb6ccc33f6f20b0
.quad 0xbec3ef153f6c835e,0xbecf7bca3f6a09a7,0xbedae8803f676bd8,0xbee79a5d3f644fac,0xbef15aea3f61c598,0xbeff17b23f5df6be,0xbf039c3d3f5b941a,0xbf0af1b73f570348
.quad 0xbf0e39da3f54db31,0xbf15f6d93f4f7a1f,0xbf187fc03f4d9f02,0xbf2093933f476085,0xbf2267993f45e403,0xbf2ac0823f3ebc1b,0xbf2beb4a3f3daef9,0xbf34768f3f3592e7
.quad 0x800000003f800000,0x800000003f800000,0xbd7b2b743f7f84ab,0xbd83db0a3f7f7808,0xbdfab2733f7e1324,0xbe0395023f7de0b1,0xbe3b6ecf3f7baccd,0xbe44b0b93f7b3bab
.quad 0xbe78cfcc3f7853f8,0xbe827dc03f778bc5,0xbe9aa0863f740bdd,0xbea218873f72d4eb,0xbeb8442a3f6ed89e,0xbec1071e3f6d1c1d,0xbed536413f68bf3c,0xbedf28a93f666771
.quad 0xbef15aea3f61c598,0xbefc5d273f5ebe05,0xbf064b823f59f26a,0xbf0c42c93f5627fe,0xbf13682a3f514d3d,0xbf19c2003f4cae79,0xbf1ff6cb3f47de65,0xbf269de33f425b89
.quad 0xbf2beb4a3f3daef9,0xbf32c8c93f373a23,0xbf373a233f32c8c9,0xbf3e35c53f2b561b,0xbf41d8703f273656,0xbf48d8b33f1ebc12,0xbf4bbbf83f1b02c6,0xbf52a6493f11796b
.quad 0x800000003f800000,0x800000003f800000,0xbd96a9053f7f4e6d,0xbd9cecf93f7f3f54,0xbe1640833f7d3aac,0xbe1c76de3f7cfe73,0xbe605c133f79c79d,0xbe698bba3f7940c0
.quad 0xbe94a0313f74fa0b,0xbe9aa0863f740bdd,0xbeb8442a3f6ed89e,0xbebf926f3f6d67a1,0xbedae8803f676bd8,0xbee363fa3f655e0b,0xbefc5d273f5ebe05,0xbf02ef9f3f5bfb34
.quad 0xbf0e39da3f54db31,0xbf13682a3f514d3d,0xbf1d7fd13f49d112,0xbf2302d33f456439,0xbf2beb4a3f3daef9,0xbf31a81d3f385216,0xbf3968423f3085bb,0xbf3f41fc3f2a2a80
.quad 0xbf45e4033f226799,0xbf4bbbf83f1b02c6,0xbf514d3d3f13682a,0xbf5703483f0af1b7,0xbf5b941a3f039c3d,0xbf6106f23ef41f07,0xbf64aa593ee63375,0xbf69b7e43ed0eb2a
.quad 0x800000003f800000,0x800000003f800000,0xbdafb6803f7f0e58,0xbdb5f8da3f7efcc9,0xbe2f10a23f7c3b28,0xbe3540983f7bf531,0xbe827dc03f778bc5,0xbe870ada3f76ef5b
.quad 0xbeac7cd43f710908,0xbeb263ef3f6ff573,0xbed536413f68bf3c,0xbedc53c13f671599,0xbefc5d273f5ebe05,0xbf0242b13f5c61c7,0xbf10d3cd3f531849,0xbf1553b73f4fefa8
.quad 0xbf2267993f45e403,0xbf2736563f41d870,0xbf32c8c93f373a23,0xbf37c6553f3238aa,0xbf41d8703f273656,0xbf46e22a3f212ff9,0xbf4f7a1f3f15f6d9,0xbf546b3b3f0ee0db
.quad 0xbf5b941a3f039c3d,0xbf6046213ef6e0cb,0xbf660f883ee0924f,0xbf6a5ad93ece0bea,0xbf6ed89e3eb8442a,0xbf7294f83ea395c5,0xbf75dec63e8e9a22,0xbf78e3d63e6fa8b2
.quad 0x800000003f800000,0x800000003f800000,0xbd6214693f7f9c18,0xbd6ea0383f7f90b1,0xbde1bc2e3f7e70b0,0xbdee38763f7e4323,0xbe28defc3f7c7eb0,0xbe3228d43f7c187a
.quad 0xbe605c133f79c79d,0xbe6c9a7f3f791298,0xbe8b95073f764d97,0xbe931f353f75341d,0xbea68f123f721352,0xbeaf713a3f708066,0xbec1071e3f6d1c1d,0xbecb2aae3f6afb8c
.quad 0xbedae8803f676bd8,0xbee633753f64aa59,0xbef41f073f6106f2,0xbf003a063f5d924d,0xbf064b823f59f26a,0xbf0cead03f55b993,0xbf121eb03f5233c6,0xbf19210f3f4d26fd
.quad 0xbf1d7fd13f49d112,0xbf24d2253f43e200,0xbf2866053f40d0da,0xbf2ff3e63f39f2ac,0xbf32c8c93f373a23,0xbf3a7ca43f2f61a5,0xbf3ca0033f2d1469,0xbf4463373f24381a
.quad 0x800000003f800000,0x800000003f800000,0xbd8a200a3f7f6ac7,0xbd9064b43f7f5ce9,0xbe09cf863f7dabcc,0xbe1008b73f7d7474,0xbe4dee603f7ac516,0xbe57278f3f7a4910
.quad 0xbe888e933f76ba07,0xbe8e9a223f75dec6,0xbea986c43f718f57,0xbeb0eacb3f703b37,0xbec9b9533f6b4b0c,0xbed25a093f696591,0xbee900b73f63f473,0xbef2bd433f61668a
.quad 0xbf039c3d3f5b941a,0xbf08f59b3f584853,0xbf121eb03f5233c6,0xbf17de123f4e1689,0xbf1ff6cb3f47de65,0xbf26050a3f42de29,0xbf2d14693f3ca003,0xbf33587a3f36ad7f
.quad 0xbf3968423f3085bb,0xbf3fc7673f299415,0xbf44e3f53f239da9,0xbf4b41fa3f1ba299,0xbf4f7a1f3f15f6d9,0xbf55b9933f0cead0,0xbf591e6a3f07a136,0xbf5f20db3efafef7
.quad 0x800000003f800000,0x800000003f800000,0xbda3308c3f7f2f9d,0xbda973ba3f7f1f49,0xbe22abb63f7cbfc9,0xbe28defc3f7c7eb0,0xbe72b6513f78b47b,0xbe7bdba43f7822d1
.quad 0xbea09ae53f731447,0xbea68f123f721352,0xbec6d5293f6be858,0xbece0bea3f6a5ad9,0xbeebcbbb3f633c5a,0xbef41f073f6106f2,0xbf07a1363f591e6a,0xbf0c42c93f5627fe
.quad 0xbf187fc03f4d9f02,0xbf1d7fd13f49d112,0xbf2866053f40d0da,0xbf2da8593f3c17d9,0xbf373a233f32c8c9,0xbf3ca0033f2d1469,0xbf44e3f53f239da9,0xbf4a4c873f1ce11f
.quad 0xbf514d3d3f13682a,0xbf5695e53f0b9a6b,0xbf5c61c73f0242b1,0xbf61668a3ef2bd43,0xbf660f883ee0924f,0xbf6aab7b3ecc9b8b,0xbf6e46be3ebb31a0,0xbf7254703ea5129f
.quad 0x800000003f800000,0x800000003f800000,0xbdbc3ac33f7eea9d,0xbdc27c393f7ed7d4,0xbe3b6ecf3f7baccd,0xbe419b373f7b61fc,0xbe8b95073f764d97,0xbe901c2c3f75a67b
.quad 0xbeb8442a3f6ed89e,0xbebe1d4a3f6db293,0xbee363fa3f655e0b,0xbeea66813f6398ac,0xbf064b823f59f26a,0xbf0a48ad3f577026,0xbf19c2003f4cae79,0xbf1e1e223f495521
.quad 0xbf2beb4a3f3daef9,0xbf3085bb3f396842,0xbf3ca0033f2d1469,0xbf4154e13f27ce61,0xbf4bbbf83f1b02c6,0xbf5064af3f14b039,0xbf591e6a3f07a136,0xbf5d924d3f003a06
.quad 0xbf64aa593ee63375,0xbf68bf3c3ed53641,0xbf6e46be3ebb31a0,0xbf71d19f3ea80b1f,0xbf75dec63e8e9a22,0xbf78b47b3e72b651,0xbf7b61fc3e419b37,0xbf7d57de3e1324ca
.quad 0x800000003f800000,0xbd48fb303f7fb10f,0x800000003f800000,0xbd55880e3f7fa6e3,0x800000003f800000,0xbd6214693f7f9c18,0x800000003f800000,0xbd6ea0383f7f90b1
.quad 0x800000003f800000,0xbd7b2b743f7f84ab,0x800000003f800000,0xbd83db0a3f7f7808,0x800000003f800000,0xbd8a200a3f7f6ac7,0x800000003f800000,0xbd9064b43f7f5ce9
.quad 0x800000003f800000,0xbd96a9053f7f4e6d,0x800000003f800000,0xbd9cecf93f7f3f54,0x800000003f800000,0xbda3308c3f7f2f9d,0x800000003f800000,0xbda973ba3f7f1f49
.quad 0x800000003f800000,0xbdafb6803f7f0e58,0x800000003f800000,0xbdb5f8da3f7efcc9,0x800000003f800000,0xbdbc3ac33f7eea9d,0x800000003f800000,0xbdc27c393f7ed7d4
.quad 0xbe47c5c23f7b14be,0xbe78cfcc3f7853f8,0xbe5415013f7a7302,0xbe8402703f77583a,0xbe605c133f79c79d,0xbe8b95073f764d97,0xbe6c9a7f3f791298,0xbe931f353f75341d
.quad 0xbe78cfcc3f7853f8,0xbe9aa0863f740bdd,0xbe827dc03f778bc5,0xbea218873f72d4eb,0xbe888e933f76ba07,0xbea986c43f718f57,0xbe8e9a223f75dec6,0xbeb0eacb3f703b37
.quad 0xbe94a0313f74fa0b,0xbeb8442a3f6ed89e,0xbe9aa0863f740bdd,0xbebf926f3f6d67a1,0xbea09ae53f731447,0xbec6d5293f6be858,0xbea68f123f721352,0xbece0bea3f6a5ad9
.quad 0xbeac7cd43f710908,0xbed536413f68bf3c,0xbeb263ef3f6ff573,0xbedc53c13f671599,0xbeb8442a3f6ed89e,0xbee363fa3f655e0b,0xbebe1d4a3f6db293,0xbeea66813f6398ac
.quad 0xbec3ef153f6c835e,0xbedae8803f676bd8,0xbecf7bca3f6a09a7,0xbee79a5d3f644fac,0xbedae8803f676bd8,0xbef41f073f6106f2,0xbee633753f64aa59,0xbf003a063f5d924d
.quad 0xbef15aea3f61c598,0xbf064b823f59f26a,0xbefc5d273f5ebe05,0xbf0c42c93f5627fe,0xbf039c3d3f5b941a,0xbf121eb03f5233c6,0xbf08f59b3f584853,0xbf17de123f4e1689
.quad 0xbf0e39da3f54db31,0xbf1d7fd13f49d112,0xbf13682a3f514d3d,0xbf2302d33f456439,0xbf187fc03f4d9f02,0xbf2866053f40d0da,0xbf1d7fd13f49d112,0xbf2da8593f3c17d9
.quad 0xbf2267993f45e403,0xbf32c8c93f373a23,0xbf2736563f41d870,0xbf37c6553f3238aa,0xbf2beb4a3f3daef9,0xbf3ca0033f2d1469,0xbf3085bb3f396842,0xbf4154e13f27ce61
.quad 0xbf0e39da3f54db31,0xbf187fc03f4d9f02,0xbf15f6d93f4f7a1f,0xbf2093933f476085,0xbf1d7fd13f49d112,0xbf2866053f40d0da,0xbf24d2253f43e200,0xbf2ff3e63f39f2ac
.quad 0xbf2beb4a3f3daef9,0xbf373a233f32c8c9,0xbf32c8c93f373a23,0xbf3e35c53f2b561b,0xbf3968423f3085bb,0xbf44e3f53f239da9,0xbf3fc7673f299415,0xbf4b41fa3f1ba299
.quad 0xbf45e4033f226799,0xbf514d3d3f13682a,0xbf4bbbf83f1b02c6,0xbf5703483f0af1b7,0xbf514d3d3f13682a,0xbf5c61c73f0242b1,0xbf5695e53f0b9a6b,0xbf61668a3ef2bd43
.quad 0xbf5b941a3f039c3d,0xbf660f883ee0924f,0xbf6046213ef6e0cb,0xbf6a5ad93ece0bea,0xbf64aa593ee63375,0xbf6e46be3ebb31a0,0xbf68bf3c3ed53641,0xbf71d19f3ea80b1f
.quad 0xbdc8bd363f7ec46d,0xbe1640833f7d3aac,0xbdd53db93f7e9bc9,0xbe1f917b3f7cdf6c,0xbde1bc2e3f7e70b0,0xbe28defc3f7c7eb0,0xbdee38763f7e4323,0xbe3228d43f7c187a
.quad 0xbdfab2733f7e1324,0xbe3b6ecf3f7baccd,0xbe0395023f7de0b1,0xbe44b0b93f7b3bab,0xbe09cf863f7dabcc,0xbe4dee603f7ac516,0xbe1008b73f7d7474,0xbe57278f3f7a4910
.quad 0xbe1640833f7d3aac,0xbe605c133f79c79d,0xbe1c76de3f7cfe73,0xbe698bba3f7940c0,0xbe22abb63f7cbfc9,0xbe72b6513f78b47b,0xbe28defc3f7c7eb0,0xbe7bdba43f7822d1
.quad 0xbe2f10a23f7c3b28,0xbe827dc03f778bc5,0xbe3540983f7bf531,0xbe870ada3f76ef5b,0xbe3b6ecf3f7baccd,0xbe8b95073f764d97,0xbe419b373f7b61fc,0xbe901c2c3f75a67b
.quad 0xbe94a0313f74fa0b,0xbeac7cd43f710908,0xbe9d9e783f73913f,0xbeb6ccc33f6f20b0,0xbea68f123f721352,0xbec1071e3f6d1c1d,0xbeaf713a3f708066,0xbecb2aae3f6afb8c
.quad 0xbeb8442a3f6ed89e,0xbed536413f68bf3c,0xbec1071e3f6d1c1d,0xbedf28a93f666771,0xbec9b9533f6b4b0c,0xbee900b73f63f473,0xbed25a093f696591,0xbef2bd433f61668a
.quad 0xbedae8803f676bd8,0xbefc5d273f5ebe05,0xbee363fa3f655e0b,0xbf02ef9f3f5bfb34,0xbeebcbbb3f633c5a,0xbf07a1363f591e6a,0xbef41f073f6106f2,0xbf0c42c93f5627fe
.quad 0xbefc5d273f5ebe05,0xbf10d3cd3f531849,0xbf0242b13f5c61c7,0xbf1553b73f4fefa8,0xbf064b823f59f26a,0xbf19c2003f4cae79,0xbf0a48ad3f577026,0xbf1e1e223f495521
.quad 0xbef15aea3f61c598,0xbf039c3d3f5b941a,0xbeff17b23f5df6be,0xbf0af1b73f570348,0xbf064b823f59f26a,0xbf121eb03f5233c6,0xbf0cead03f55b993,0xbf19210f3f4d26fd
.quad 0xbf13682a3f514d3d,0xbf1ff6cb3f47de65,0xbf19c2003f4cae79,0xbf269de33f425b89,0xbf1ff6cb3f47de65,0xbf2d14693f3ca003,0xbf26050a3f42de29,0xbf33587a3f36ad7f
.quad 0xbf2beb4a3f3daef9,0xbf3968423f3085bb,0xbf31a81d3f385216,0xbf3f41fc3f2a2a80,0xbf373a233f32c8c9,0xbf44e3f53f239da9,0xbf3ca0033f2d1469,0xbf4a4c873f1ce11f
.quad 0xbf41d8703f273656,0xbf4f7a1f3f15f6d9,0xbf46e22a3f212ff9,0xbf546b3b3f0ee0db,0xbf4bbbf83f1b02c6,0xbf591e6a3f07a136,0xbf5064af3f14b039,0xbf5d924d3f003a06
.quad 0xbf2267993f45e403,0xbf2beb4a3f3daef9,0xbf2ac0823f3ebc1b,0xbf34768f3f3592e7,0xbf32c8c93f373a23,0xbf3ca0033f2d1469,0xbf3a7ca43f2f61a5,0xbf4463373f24381a
.quad 0xbf41d8703f273656,0xbf4bbbf83f1b02c6,0xbf48d8b33f1ebc12,0xbf52a6493f11796b,0xbf4f7a1f3f15f6d9,0xbf591e6a3f07a136,0xbf55b9933f0cead0,0xbf5f20db3efafef7
.quad 0xbf5b941a3f039c3d,0xbf64aa593ee63375,0xbf6106f23ef41f07,0xbf69b7e43ed0eb2a,0xbf660f883ee0924f,0xbf6e46be3ebb31a0,0xbf6aab7b3ecc9b8b,0xbf7254703ea5129f
.quad 0xbf6ed89e3eb8442a,0xbf75dec63e8e9a22,0xbf7294f83ea395c5,0xbf78e3d63e6fa8b2,0xbf75dec63e8e9a22,0xbf7b61fc3e419b37,0xbf78b47b3e72b651,0xbf7d57de3e1324ca
.quad 0xbf3504f33f3504f3,0xbf3daef93f2beb4a,0xbf3daef93f2beb4a,0xbf4663543f21cbfb,0xbf45e4033f226799,0xbf4e8d903f173c07,0xbf4d9f023f187fc0,0xbf5627fe3f0c42c9
.quad 0xbf54db313f0e39da,0xbf5d2d533f00e7e4,0xbf5b941a3f039c3d,0xbf6398ac3eea6681,0xbf61c5983ef15aea,0xbf6965913ed25a09,0xbf676bd83edae880,0xbf6e8ff83eb9bb1e
.quad 0xbf6c835e3ec3ef15,0xbf7314473ea09ae5,0xbf7109083eac7cd4,0xbf76ef5b3e870ada,0xbf74fa0b3e94a031,0xbf7a1e843e5a3997,0xbf7853f83e78cfcc,0xbf7c9f8a3e25c58c
.quad 0xbf7b14be3e47c5c2,0xbf7e70b03de1bc2e,0xbf7d3aac3e164083,0xbf7f90b13d6ea038,0xbf7ec46d3dc8bd36,0xbf7ffec43bc90f88,0xbf7fb10f3d48fb30,0xbf7fba9ebd3c6dd5
.quad 0xbf54db313f0e39da,0xbf5b941a3f039c3d,0xbf5d2d533f00e7e4,0xbf6398ac3eea6681,0xbf64aa593ee63375,0xbf6aab7b3ecc9b8b,0xbf6b4b0c3ec9b953,0xbf70c5013eadf73c
.quad 0xbf7109083eac7cd4,0xbf75dec63e8e9a22,0xbf75dec63e8e9a22,0xbf79f35e3e5d4b1a,0xbf79c79d3e605c13,0xbf7cfe733e1c76de,0xbf7cbfc93e22abb6,0xbf7efcc93db5f8da
.quad 0xbf7ec46d3dc8bd36,0xbf7fec433cc90ab0,0xbf7fd3973d16c32c,0xbf7fcbe2bd2351cb,0xbf7fec43bcc90ab0,0xbf7e9bc9bdd53db9,0xbf7f0e58bdafb680,0xbf7c5d3abe2bf804
.quad 0xbf7d3aacbe164083,0xbf791298be6c9a7f,0xbf7a7302be541501,0xbf74bf62be9620d2,0xbf76ba07be888e93,0xbf6f6830beb554ec,0xbf721352bea68f12,0xbf6912aebed3c867
.quad 0xbf6c835e3ec3ef15,0xbf7109083eac7cd4,0xbf7314473ea09ae5,0xbf76ef5b3e870ada,0xbf7853f83e78cfcc,0xbf7b61fc3e419b37,0xbf7c3b283e2f10a2,0xbf7e5a383de7fa9a
.quad 0xbf7ec46d3dc8bd36,0xbf7fd3973d16c32c,0xbf7fec433cc90ab0,0xbf7fcbe2bd2351cb,0xbf7fb10fbd48fb30,0xbf7e4323bdee3876,0xbf7e1324bdfab273,0xbf7b3babbe44b0b9
.quad 0xbf7b14bebe47c5c2,0xbf76ba07be888e93,0xbf76ba07be888e93,0xbf70c501beadf73c,0xbf710908beac7cd4,0xbf696591bed25a09,0xbf6a09a7becf7bca,0xbf60a6cfbef58035
.quad 0xbf61c598bef15aea,0xbf5695e5bf0b9a6b,0xbf584853bf08f59b,0xbf4b41fabf1ba299,0xbf4d9f02bf187fc0,0xbf3ebc1bbf2ac082,0xbf41d870bf273656,0xbf311722bf38dd65
.quad 0xbf7b14be3e47c5c2,0xbf7d3aac3e164083,0xbf7e70b03de1bc2e,0xbf7f90b13d6ea038,0xbf7fec433cc90ab0,0xbf7fe129bcfb49ba,0xbf7f84abbd7b2b74,0xbf7e2b72bdf475c0
.quad 0xbf7d3aacbe164083,0xbf7a7302be541501,0xbf791298be6c9a7f,0xbf74bf62be9620d2,0xbf731447bea09ae5,0xbf6d1c1dbec1071e,0xbf6b4b0cbec9b953,0xbf6398acbeea6681
.quad 0xbf61c598bef15aea,0xbf584853bf08f59b,0xbf5695e5bf0b9a6b,0xbf4b41fabf1ba299,0xbf49d112bf1d7fd1,0xbf3ca003bf2d1469,0xbf3b8f3bbf2e3bde,0xbf2c800fbf3d27b8
.quad 0xbf2beb4abf3daef9,0xbf1b02c6bf4bbbf8,0xbf1b02c6bf4bbbf8,0xbf084b92bf58b3a1,0xbf08f59bbf584853,0xbee900b7bf63f473,0xbeebcbbbbf633c5a,0xbebf926fbf6d67a1
.quad 0xbf45e4033f226799,0xbf4d9f023f187fc0,0xbf4e8d903f173c07,0xbf5627fe3f0c42c9,0xbf5695e53f0b9a6b,0xbf5df6be3eff17b2,0xbf5df6be3eff17b2,0xbf6504793ee4cbfe
.quad 0xbf64aa593ee63375,0xbf6b4b0c3ec9b953,0xbf6aab7b3ecc9b8b,0xbf70c5013eadf73c,0xbf6ff5733eb263ef,0xbf756d973e919ddd,0xbf7484223e97a117,0xbf7940c03e698bba
.quad 0xbf7853f83e78cfcc,0xbf7c3b283e2f10a2,0xbf7b61fc3e419b37,0xbf7e5a383de7fa9a,0xbf7dabcc3e09cf86,0xbf7f9c183d621469,0xbf7f2f9d3da3308c,0xbf7fffb1bb490fc6
.quad 0xbf7fec433cc90ab0,0xbf7f84abbd7b2b74,0xbf7fe129bcfb49ba,0xbf7e2b72bdf475c0,0xbf7f0e58bdafb680,0xbf7bf531be354098,0xbf7d7474be1008b7,0xbf78e3d6be6fa8b2
.quad 0xbf61c5983ef15aea,0xbf676bd83edae880,0xbf6965913ed25a09,0xbf6e8ff83eb9bb1e,0xbf6ff5733eb263ef,0xbf7484223e97a117,0xbf756d973e919ddd,0xbf7940c03e698bba
.quad 0xbf79c79d3e605c13,0xbf7cbfc93e22abb6,0xbf7cfe733e1c76de,0xbf7efcc93db5f8da,0xbf7f0e583dafb680,0xbf7ff4e63c96c9b6,0xbf7ff4e63c96c9b6,0xbf7fa6e3bd55880e
.quad 0xbf7fb10fbd48fb30,0xbf7e1324bdfab273,0xbf7e4323bdee3876,0xbf7b3babbe44b0b9,0xbf7baccdbe3b6ecf,0xbf772417be8586ce,0xbf77f110be7ee6e1,0xbf71d19fbea80b1f
.quad 0xbf731447bea09ae5,0xbf6b4b0cbec9b953,0xbf6d1c1dbec1071e,0xbf6398acbeea6681,0xbf660f88bee0924f,0xbf5ac450bf04f484,0xbf5df6bebeff17b2,0xbf50d937bf140c5f
.quad 0xbf74fa0b3e94a031,0xbf7853f83e78cfcc,0xbf7a1e843e5a3997,0xbf7c9f8a3e25c58c,0xbf7dabcc3e09cf86,0xbf7f2f9d3da3308c,0xbf7f9c183d621469,0xbf7fffb1bb490fc6
.quad 0xbf7fec43bcc90ab0,0xbf7f0e58bdafb680,0xbf7e9bc9bdd53db9,0xbf7c5d3abe2bf804,0xbf7baccdbe3b6ecf,0xbf77f110be7ee6e1,0xbf772417be8586ce,0xbf71d19fbea80b1f
.quad 0xbf710908beac7cd4,0xbf6a09a7becf7bca,0xbf696591bed25a09,0xbf60a6cfbef58035,0xbf604621bef6e0cb,0xbf55b993bf0cead0,0xbf55b993bf0cead0,0xbf495521bf1e1e22
.quad 0xbf49d112bf1d7fd1,0xbf3b8f3bbf2e3bde,0xbf3ca003bf2d1469,0xbf2c800fbf3d27b8,0xbf2e3bdebf3b8f3b,0xbf1c420cbf4ac77f,0xbf1ebc12bf48d8b3,0xbf0af1b7bf570348
.quad 0xbf7ec46d3dc8bd36,0xbf7fb10f3d48fb30,0xbf7ffec43bc90f88,0xbf7fba9ebd3c6dd5,0xbf7f0e58bdafb680,0xbf7d7474be1008b7,0xbf7bf531be354098,0xbf78e3d6be6fa8b2
.quad 0xbf76ba07be888e93,0xbf721352bea68f12,0xbf6f6830beb554ec,0xbf6912aebed3c867,0xbf660f88bee0924f,0xbf5df6bebeff17b2,0xbf5ac450bf04f484,0xbf50d937bf140c5f
.quad 0xbf4d9f02bf187fc0,0xbf41d870bf273656,0xbf3ebc1bbf2ac082,0xbf311722bf38dd65,0xbf2e3bdebf3b8f3b,0xbf1ebc12bf48d8b3,0xbf1c420cbf4ac77f,0xbf0af1b7bf570348
.quad 0xbf08f59bbf584853,0xbeebcbbbbf633c5a,0xbee900b7bf63f473,0xbebf926fbf6d67a1,0xbebe1d4abf6db293,0xbe919dddbf756d97,0xbe919dddbf756d97,0xbe44b0b9bf7b3bab
.quad 0x800000003f800000,0xbdc8bd363f7ec46d,0x800000003f800000,0xbdcefdb73f7eb069,0x800000003f800000,0xbdd53db93f7e9bc9,0x800000003f800000,0xbddb7d373f7e868b
.quad 0x800000003f800000,0xbde1bc2e3f7e70b0,0x800000003f800000,0xbde7fa9a3f7e5a38,0x800000003f800000,0xbdee38763f7e4323,0x800000003f800000,0xbdf475c03f7e2b72
.quad 0x800000003f800000,0xbdfab2733f7e1324,0x800000003f800000,0xbe0077453f7dfa38,0x800000003f800000,0xbe0395023f7de0b1,0x800000003f800000,0xbe06b26e3f7dc68c
.quad 0x800000003f800000,0xbe09cf863f7dabcc,0x800000003f800000,0xbe0cec4a3f7d906e,0x800000003f800000,0xbe1008b73f7d7474,0x800000003f800000,0xbe1324ca3f7d57de
.quad 0xbec3ef153f6c835e,0xbef15aea3f61c598,0xbec9b9533f6b4b0c,0xbef840c83f5fe4e9,0xbecf7bca3f6a09a7,0xbeff17b23f5df6be,0xbed536413f68bf3c,0xbf02ef9f3f5bfb34
.quad 0xbedae8803f676bd8,0xbf064b823f59f26a,0xbee0924f3f660f88,0xbf099f4e3f57dc7f,0xbee633753f64aa59,0xbf0cead03f55b993,0xbeebcbbb3f633c5a,0xbf102dd53f5389c7
.quad 0xbef15aea3f61c598,0xbf13682a3f514d3d,0xbef6e0cb3f604621,0xbf16999f3f4f0417,0xbefc5d273f5ebe05,0xbf19c2003f4cae79,0xbf00e7e43f5d2d53,0xbf1ce11f3f4a4c87
.quad 0xbf039c3d3f5b941a,0xbf1ff6cb3f47de65,0xbf064b823f59f26a,0xbf2302d33f456439,0xbf08f59b3f584853,0xbf26050a3f42de29,0xbf0b9a6b3f5695e5,0xbf28fd413f404c5c
.quad 0xbf3504f33f3504f3,0xbf45e4033f226799,0xbf3968423f3085bb,0xbf4a4c873f1ce11f,0xbf3daef93f2beb4a,0xbf4e8d903f173c07,0xbf41d8703f273656,0xbf52a6493f11796b
.quad 0xbf45e4033f226799,0xbf5695e53f0b9a6b,0xbf49d1123f1d7fd1,0xbf5a5ba03f05a02c,0xbf4d9f023f187fc0,0xbf5df6be3eff17b2,0xbf514d3d3f13682a,0xbf61668a3ef2bd43
.quad 0xbf54db313f0e39da,0xbf64aa593ee63375,0xbf5848533f08f59b,0xbf67c1873ed97cb9,0xbf5b941a3f039c3d,0xbf6aab7b3ecc9b8b,0xbf5ebe053efc5d27,0xbf6d67a13ebf926f
.quad 0xbf61c5983ef15aea,0xbf6ff5733eb263ef,0xbf64aa593ee63375,0xbf7254703ea5129f,0xbf676bd83edae880,0xbf7484223e97a117,0xbf6a09a73ecf7bca,0xbf76841b3e8a11f7
.quad 0xbf6c835e3ec3ef15,0xbf74fa0b3e94a031,0xbf6ff5733eb263ef,0xbf77beb73e80f8c0,0xbf7314473ea09ae5,0xbf7a1e843e5a3997,0xbf75dec63e8e9a22,0xbf7c187a3e3228d4
.quad 0xbf7853f83e78cfcc,0xbf7dabcc3e09cf86,0xbf7a73023e541501,0xbf7ed7d43dc27c39,0xbf7c3b283e2f10a2,0xbf7f9c183d621469,0xbf7dabcc3e09cf86,0xbf7ff84a3c7b514b
.quad 0xbf7ec46d3dc8bd36,0xbf7fec43bcc90ab0,0xbf7f84ab3d7b2b74,0xbf7f7808bd83db0a,0xbf7fec433cc90ab0,0xbf7e9bc9bdd53db9,0xbf7ffb11bc490e90,0xbf7d57debe1324ca
.quad 0xbf7fb10fbd48fb30,0xbf7baccdbe3b6ecf,0xbf7f0e58bdafb680,0xbf799b43be636c83,0xbf7e1324bdfab273,0xbf772417be8586ce,0xbf7cbfc9be22abb6,0xbf74484bbe9920fe
.quad 0xbe47c5c23f7b14be,0xbe94a0313f74fa0b,0xbe4dee603f7ac516,0xbe9920fe3f74484b,0xbe5415013f7a7302,0xbe9d9e783f73913f,0xbe5a39973f7a1e84,0xbea218873f72d4eb
.quad 0xbe605c133f79c79d,0xbea68f123f721352,0xbe667c663f796e4e,0xbeab02013f714c7a,0xbe6c9a7f3f791298,0xbeaf713a3f708066,0xbe72b6513f78b47b,0xbeb3dca53f6faf1b
.quad 0xbe78cfcc3f7853f8,0xbeb8442a3f6ed89e,0xbe7ee6e13f77f110,0xbebca7af3f6dfcf2,0xbe827dc03f778bc5,0xbec1071e3f6d1c1d,0xbe8586ce3f772417,0xbec5625c3f6c3624
.quad 0xbe888e933f76ba07,0xbec9b9533f6b4b0c,0xbe8b95073f764d97,0xbece0bea3f6a5ad9,0xbe8e9a223f75dec6,0xbed25a093f696591,0xbe919ddd3f756d97,0xbed6a3993f686b39
.quad 0xbf0e39da3f54db31,0xbf2267993f45e403,0xbf121eb03f5233c6,0xbf269de33f425b89,0xbf15f6d93f4f7a1f,0xbf2ac0823f3ebc1b,0xbf19c2003f4cae79,0xbf2ecef73f3b0629
.quad 0xbf1d7fd13f49d112,0xbf32c8c93f373a23,0xbf212ff93f46e22a,0xbf36ad7f3f33587a,0xbf24d2253f43e200,0xbf3a7ca43f2f61a5,0xbf2866053f40d0da,0xbf3e35c53f2b561b
.quad 0xbf2beb4a3f3daef9,0xbf41d8703f273656,0xbf2f61a53f3a7ca4,0xbf4564393f2302d3,0xbf32c8c93f373a23,0xbf48d8b33f1ebc12,0xbf36206c3f33e7bc,0xbf4c35783f1a6293
.quad 0xbf3968423f3085bb,0xbf4f7a1f3f15f6d9,0xbf3ca0033f2d1469,0xbf52a6493f11796b,0xbf3fc7673f299415,0xbf55b9933f0cead0,0xbf42de293f26050a,0xbf58b3a13f084b92
.quad 0xbf54db313f0e39da,0xbf61c5983ef15aea,0xbf591e6a3f07a136,0xbf65b7103ee1fb6a,0xbf5d2d533f00e7e4,0xbf6965913ed25a09,0xbf6106f23ef41f07,0xbf6cd0073ec27b55
.quad 0xbf64aa593ee63375,0xbf6ff5733eb263ef,0xbf6816a83ed8106b,0xbf72d4eb3ea21887,0xbf6b4b0c3ec9b953,0xbf756d973e919ddd,0xbf6e46be3ebb31a0,0xbf77beb73e80f8c0
.quad 0xbf7109083eac7cd4,0xbf79c79d3e605c13,0xbf73913f3e9d9e78,0xbf7b87b23e3e853e,0xbf75dec63e8e9a22,0xbf7cfe733e1c76de,0xbf77f1103e7ee6e1,0xbf7e2b723df475c0
.quad 0xbf79c79d3e605c13,0xbf7f0e583dafb680,0xbf7b61fc3e419b37,0xbf7fa6e33d55880e,0xbf7cbfc93e22abb6,0xbf7ff4e63c96c9b6,0xbf7de0b13e039502,0xbf7ff84abc7b514b
.quad 0xbf7b14be3e47c5c2,0xbf7ec46d3dc8bd36,0xbf7cfe733e1c76de,0xbf7fa6e33d55880e,0xbf7e70b03de1bc2e,0xbf7ffec43bc90f88,0xbf7f6ac73d8a200a,0xbf7fcbe2bd2351cb
.quad 0xbf7fec433cc90ab0,0xbf7f0e58bdafb680,0xbf7ff4e6bc96c9b6,0xbf7dc68cbe06b26e,0xbf7f84abbd7b2b74,0xbf7bf531be354098,0xbf7e9bc9bdd53db9,0xbf799b43be636c83
.quad 0xbf7d3aacbe164083,0xbf76ba07be888e93,0xbf7b61fcbe419b37,0xbf73530ebe9f1cdf,0xbf791298be6c9a7f,0xbf6f6830beb554ec,0xbf764d97be8b9507,0xbf6afb8cbecb2aae
.quad 0xbf731447bea09ae5,0xbf660f88bee0924f,0xbf6f6830beb554ec,0xbf60a6cfbef58035,0xbf6b4b0cbec9b953,0xbf5ac450bf04f484,0xbf66beccbeddbe79,0xbf546b3bbf0ee0db
.quad 0xbf800000248d3132,0xbf7ec46dbdc8bd36,0xbf7fb10fbd48fb30,0xbf7d1cddbe195be0,0xbf7ec46dbdc8bd36,0xbf7ac516be4dee60,0xbf7d3aacbe164083,0xbf77beb7be80f8c0
.quad 0xbf7b14bebe47c5c2,0xbf740bddbe9aa086,0xbf7853f8be78cfcc,0xbf6faf1bbeb3dca5,0xbf74fa0bbe94a031,0xbf6aab7bbecc9b8b,0xbf710908beac7cd4,0xbf650479bee4cbfe
.quad 0xbf6c835ebec3ef15,0xbf5ebe05befc5d27,0xbf676bd8bedae880,0xbf57dc7fbf099f4e,0xbf61c598bef15aea,0xbf5064afbf14b039,0xbf5b941abf039c3d,0xbf485bcabf1f599f
.quad 0xbf54db31bf0e39da,0xbf3fc767bf299415,0xbf4d9f02bf187fc0,0xbf36ad7fbf33587a,0xbf45e403bf226799,0xbf2d1469bf3ca003,0xbf3daef9bf2beb4a,0xbf2302d3bf456439
.quad 0xbf6c835ebec3ef15,0xbf61c598bef15aea,0xbf660f88bee0924f,0xbf5988adbf06f686,0xbf5ebe05befc5d27,0xbf5064afbf14b039,0xbf5695e5bf0b9a6b,0xbf466354bf21cbfb
.quad 0xbf4d9f02bf187fc0,0xbf3b8f3bbf2e3bde,0xbf43e200bf24d225,0xbf2ff3e6bf39f2ac,0xbf396842bf3085bb,0xbf239da9bf44e3f5,0xbf2e3bdebf3b8f3b,0xbf16999fbf4f0417
.quad 0xbf226799bf45e403,0xbf08f59bbf584853,0xbf15f6d9bf4f7a1f,0xbef58035bf60a6cf,0xbf08f59bbf584853,0xbed8106bbf6816a8,0xbef6e0cbbf604621,0xbeb9bb1ebf6e8ff8
.quad 0xbedae880bf676bd8,0xbe9aa086bf740bdd,0xbebe1d4abf6db293,0xbe75c35abf788486,0xbea09ae5bf731447,0xbe354098bf7bf531,0xbe827dc0bf778bc5,0xbde7fa9abf7e5a38
.quad 0xbf3504f3bf3504f3,0xbf226799bf45e403,0xbf273656bf41d870,0xbf12c39abf51c0c2,0xbf187fc0bf4d9f02,0xbf0242b1bf5c61c7,0xbf08f59bbf584853,0xbee1fb6abf65b710
.quad 0xbef15aeabf61c598,0xbebe1d4abf6db293,0xbecf7bcabf6a09a7,0xbe9920febf74484b,0xbeac7cd4bf710908,0xbe667c66bf796e4e,0xbe888e93bf76ba07,0xbe195be0bf7d1cdd
.quad 0xbe47c5c2bf7b14be,0xbd96a905bf7f4e6d,0xbdfab273bf7e1324,0x3b490fc6bf7fffb1,0xbd48fb30bf7fb10f,0x3da3308cbf7f2f9d,0x3cc90ab0bf7fec43,0x3e1f917bbf7cdf6c
.quad 0x3dc8bd36bf7ec46d,0x3e6c9a7fbf791298,0x3e2f10a2bf7c3b28,0x3e9c1fafbf73ced9,0x3e78cfccbf7853f8,0x3ec1071ebf6d1c1d,0x3ea09ae5bf731447,0x3ee4cbfebf650479
.quad 0xbec3ef15bf6c835e,0xbe94a031bf74fa0b,0xbe9aa086bf740bdd,0xbe5101f1bf7a9c59,0xbe605c13bf79c79d,0xbdee3876bf7e4323,0xbe09cf86bf7dabcc,0xbce22a7abf7fe705
.quad 0xbd48fb30bf7fb10f,0x3d7b2b74bf7f84ab,0x3d16c32cbf7fd397,0x3e195be0bf7d1cdd,0x3dfab273bf7e1324,0x3e72b651bf78b47b,0x3e541501bf7a7302,0x3ea5129fbf725470
.quad 0x3e94a031bf74fa0b,0x3ecf7bcabf6a09a7,0x3ebe1d4abf6db293,0x3ef840c8bf5fe4e9,0x3ee63375bf64aa59,0x3f0f8784bf53fac3,0x3f064b82bf59f26a,0x3f21cbfbbf466354
.quad 0x3f187fc0bf4d9f02,0x3f32c8c9bf373a23,0x3f299415bf3fc767,0x3f425b89bf269de3,0x3f396842bf3085bb,0x3f5064afbf14b039,0x3f47de65bf1ff6cb,0x3f5cc7d1bf019573
.quad 0xbf7b14bebe47c5c2,0xbf74fa0bbe94a031,0xbf77f110be7ee6e1,0xbf703b37beb0eacb,0xbf740bddbe9aa086,0xbf6aab7bbecc9b8b,0xbf6f6830beb554ec,0xbf644facbee79a5d
.quad 0xbf6a09a7becf7bca,0xbf5d2d53bf00e7e4,0xbf63f473bee900b7,0xbf554aa4bf0d9281,0xbf5d2d53bf00e7e4,0xbf4cae79bf19c200,0xbf55b993bf0cead0,0xbf436051bf256bcb
.quad 0xbf4d9f02bf187fc0,0xbf396842bf3085bb,0xbf44e3f5bf239da9,0xbf2ecef7bf3b0629,0xbf3b8f3bbf2e3bde,0xbf239da9bf44e3f5,0xbf31a81dbf385216,0xbf17de12bf4e1689
.quad 0xbf273656bf41d870,0xbf0b9a6bbf5695e5,0xbf1c420cbf4ac77f,0xbefdbabbbf5e5aa6,0xbf10d3cdbf531849,0xbee363fabf655e0b,0xbf04f484bf5ac450,0xbec8477cbf6b99fb
.quad 0xbf54db31bf0e39da,0xbf45e403bf226799,0xbf4ac77fbf1c420c,0xbf39f2acbf2ff3e6,0xbf3fc767bf299415,0xbf2d1469bf3ca003,0xbf33e7bcbf36206c,0xbf1f599fbf485bca
.quad 0xbf273656bf41d870,0xbf10d3cdbf531849,0xbf19c200bf4cae79,0xbf019573bf5cc7d1,0xbf0b9a6bbf5695e5,0xbee363fabf655e0b,0xbef9a02dbf5f8327,0xbec27b55bf6cd007
.quad 0xbedae880bf676bd8,0xbea09ae5bf731447,0xbebb31a0bf6e46be,0xbe7bdba4bf7822d1,0xbe9aa086bf740bdd,0xbe354098bf7bf531,0xbe72b651bf78b47b,0xbddb7d37bf7e868b
.quad 0xbe2f10a2bf7c3b28,0xbd16c32cbf7fd397,0xbdd53db9bf7e9bc9,0x3d0a342fbf7fdaaf,0xbd16c32cbf7fd397,0x3dd53db9bf7e9bc9,0x3cfb49babf7fe129,0x3e3228d4bf7c187a
.quad 0xbf0e39dabf54db31,0xbef15aeabf61c598,0xbef9a02dbf5f8327,0xbecb2aaebf6afb8c,0xbed53641bf68bf3c,0xbea395c5bf7294f8,0xbeaf713abf708066,0xbe75c35abf788486
.quad 0xbe888e93bf76ba07,0xbe22abb6bf7cbfc9,0xbe419b37bf7b61fc,0xbd9cecf9bf7f3f54,0xbde1bc2ebf7e70b0,0x3bc90f88bf7ffec4,0xbcfb49babf7fe129,0x3db5f8dabf7efcc9
.quad 0x3d48fb30bf7fb10f,0x3e2f10a2bf7c3b28,0x3e039502bf7de0b1,0x3e80f8c0bf77beb7,0x3e541501bf7a7302,0x3ea986c4bf718f57,0x3e919dddbf756d97,0x3ed0eb2abf69b7e4
.quad 0x3eb8442abf6ed89e,0x3ef6e0cbbf604621,0x3eddbe79bf66becc,0x3f0d9281bf554aa4,0x3f00e7e4bf5d2d53,0x3f1ebc12bf48d8b3,0x3f121eb0bf5233c6,0x3f2ecef7bf3b0629
.quad 0xbe47c5c2bf7b14be,0xbdc8bd36bf7ec46d,0xbdd53db9bf7e9bc9,0xbb490fc6bf7fffb1,0xbc490e90bf7ffb11,0x3dbc3ac3bf7eea9d,0x3da3308cbf7f2f9d,0x3e3e853ebf7b87b2
.quad 0x3e2f10a2bf7c3b28,0x3e8e9a22bf75dec6,0x3e8586cebf772417,0x3ebca7afbf6dfcf2,0x3eb263efbf6ff573,0x3ee900b7bf63f473,0x3eddbe79bf66becc,0x3f099f4ebf57dc7f
.quad 0x3f039c3dbf5b941a,0x3f1d7fd1bf49d112,0x3f173c07bf4e8d90,0x3f2ff3e6bf39f2ac,0x3f299415bf3fc767,0x3f40d0dabf286605,0x3f3a7ca4bf2f61a5,0x3f4fefa8bf1553b7
.quad 0x3f49d112bf1d7fd1,0x3f5d2d53bf00e7e4,0x3f577026bf0a48ad,0x3f686b39bed6a399,0x3f633c5abeebcbbb,0x3f718f57bea986c4,0x3f6d1c1dbec1071e,0x3f788486be75c35a
.quad 0x800000003f800000,0xbe1640833f7d3aac,0x800000003f800000,0xbe195be03f7d1cdd,0x800000003f800000,0xbe1c76de3f7cfe73,0x800000003f800000,0xbe1f917b3f7cdf6c
.quad 0x800000003f800000,0xbe22abb63f7cbfc9,0x800000003f800000,0xbe25c58c3f7c9f8a,0x800000003f800000,0xbe28defc3f7c7eb0,0x800000003f800000,0xbe2bf8043f7c5d3a
.quad 0x800000003f800000,0xbe2f10a23f7c3b28,0x800000003f800000,0xbe3228d43f7c187a,0x800000003f800000,0xbe3540983f7bf531,0x800000003f800000,0xbe3857ec3f7bd14d
.quad 0x800000003f800000,0xbe3b6ecf3f7baccd,0x800000003f800000,0xbe3e853e3f7b87b2,0x800000003f800000,0xbe419b373f7b61fc,0x800000003f800000,0xbe44b0b93f7b3bab
.quad 0xbf0e39da3f54db31,0xbf2beb4a3f3daef9,0xbf10d3cd3f531849,0xbf2ecef73f3b0629,0xbf13682a3f514d3d,0xbf31a81d3f385216,0xbf15f6d93f4f7a1f,0xbf34768f3f3592e7
.quad 0xbf187fc03f4d9f02,0xbf373a233f32c8c9,0xbf1b02c63f4bbbf8,0xbf39f2ac3f2ff3e6,0xbf1d7fd13f49d112,0xbf3ca0033f2d1469,0xbf1ff6cb3f47de65,0xbf3f41fc3f2a2a80
.quad 0xbf2267993f45e403,0xbf41d8703f273656,0xbf24d2253f43e200,0xbf4463373f24381a,0xbf2736563f41d870,0xbf46e22a3f212ff9,0xbf2994153f3fc767,0xbf4955213f1e1e22
.quad 0xbf2beb4a3f3daef9,0xbf4bbbf83f1b02c6,0xbf2e3bde3f3b8f3b,0xbf4e16893f17de12,0xbf3085bb3f396842,0xbf5064af3f14b039,0xbf32c8c93f373a23,0xbf52a6493f11796b
.quad 0xbf6c835e3ec3ef15,0xbf7853f83e78cfcc,0xbf6ed89e3eb8442a,0xbf79f35e3e5d4b1a,0xbf7109083eac7cd4,0xbf7b61fc3e419b37,0xbf7314473ea09ae5,0xbf7c9f8a3e25c58c
.quad 0xbf74fa0b3e94a031,0xbf7dabcc3e09cf86,0xbf76ba073e888e93,0xbf7e868b3ddb7d37,0xbf7853f83e78cfcc,0xbf7f2f9d3da3308c,0xbf79c79d3e605c13,0xbf7fa6e33d55880e
.quad 0xbf7b14be3e47c5c2,0xbf7fec433cc90ab0,0xbf7c3b283e2f10a2,0xbf7fffb1bb490fc6,0xbf7d3aac3e164083,0xbf7fe129bcfb49ba,0xbf7e13243dfab273,0xbf7f90b1bd6ea038
.quad 0xbf7ec46d3dc8bd36,0xbf7f0e58bdafb680,0xbf7f4e6d3d96a905,0xbf7e5a38bde7fa9a,0xbf7fb10f3d48fb30,0xbf7d7474be1008b7,0xbf7fec433cc90ab0,0xbf7c5d3abe2bf804
.quad 0xbf7b14bebe47c5c2,0xbf710908beac7cd4,0xbf791298be6c9a7f,0xbf6d67a1bebf926f,0xbf76ba07be888e93,0xbf696591bed25a09,0xbf740bddbe9aa086,0xbf650479bee4cbfe
.quad 0xbf710908beac7cd4,0xbf604621bef6e0cb,0xbf6db293bebe1d4a,0xbf5b2c79bf044889,0xbf6a09a7becf7bca,0xbf55b993bf0cead0,0xbf660f88bee0924f,0xbf4fefa8bf1553b7
.quad 0xbf61c598bef15aea,0xbf49d112bf1d7fd1,0xbf5d2d53bf00e7e4,0xbf436051bf256bcb,0xbf584853bf08f59b,0xbf3ca003bf2d1469,0xbf531849bf10d3cd,0xbf3592e7bf34768f
.quad 0xbf4d9f02bf187fc0,0xbf2e3bdebf3b8f3b,0xbf47de65bf1ff6cb,0xbf269de3bf425b89,0xbf41d870bf273656,0xbf1ebc12bf48d8b3,0xbf3b8f3bbf2e3bde,0xbf16999fbf4f0417
.quad 0xbe94a0313f74fa0b,0xbedae8803f676bd8,0xbe97a1173f748422,0xbedf28a93f666771,0xbe9aa0863f740bdd,0xbee363fa3f655e0b,0xbe9d9e783f73913f,0xbee79a5d3f644fac
.quad 0xbea09ae53f731447,0xbeebcbbb3f633c5a,0xbea395c53f7294f8,0xbeeff7fb3f62241a,0xbea68f123f721352,0xbef41f073f6106f2,0xbea986c43f718f57,0xbef840c83f5fe4e9
.quad 0xbeac7cd43f710908,0xbefc5d273f5ebe05,0xbeaf713a3f708066,0xbf003a063f5d924d,0xbeb263ef3f6ff573,0xbf0242b13f5c61c7,0xbeb554ec3f6f6830,0xbf0448893f5b2c79
.quad 0xbeb8442a3f6ed89e,0xbf064b823f59f26a,0xbebb31a03f6e46be,0xbf084b923f58b3a1,0xbebe1d4a3f6db293,0xbf0a48ad3f577026,0xbec1071e3f6d1c1d,0xbf0c42c93f5627fe
.quad 0xbf45e4033f226799,0xbf5b941a3f039c3d,0xbf48d8b33f1ebc12,0xbf5e5aa63efdbabb,0xbf4bbbf83f1b02c6,0xbf6106f23ef41f07,0xbf4e8d903f173c07,0xbf6398ac3eea6681
.quad 0xbf514d3d3f13682a,0xbf660f883ee0924f,0xbf53fac33f0f8784,0xbf686b393ed6a399,0xbf5695e53f0b9a6b,0xbf6aab7b3ecc9b8b,0xbf591e6a3f07a136,0xbf6cd0073ec27b55
.quad 0xbf5b941a3f039c3d,0xbf6ed89e3eb8442a,0xbf5df6be3eff17b2,0xbf70c5013eadf73c,0xbf6046213ef6e0cb,0xbf7294f83ea395c5,0xbf6282103eee9479,0xbf74484b3e9920fe
.quad 0xbf64aa593ee63375,0xbf75dec63e8e9a22,0xbf66becc3eddbe79,0xbf77583a3e840270,0xbf68bf3c3ed53641,0xbf78b47b3e72b651,0xbf6aab7b3ecc9b8b,0xbf79f35e3e5d4b1a
.quad 0xbf7ec46d3dc8bd36,0xbf7fb10fbd48fb30,0xbf7f6ac73d8a200a,0xbf7f1f49bda973ba,0xbf7fd3973d16c32c,0xbf7e4323bdee3876,0xbf7ffec43bc90f88,0xbf7d1cddbe195be0
.quad 0xbf7fec43bcc90ab0,0xbf7baccdbe3b6ecf,0xbf7f9c18bd621469,0xbf79f35ebe5d4b1a,0xbf7f0e58bdafb680,0xbf77f110be7ee6e1,0xbf7e4323bdee3876,0xbf75a67bbe901c2c
.quad 0xbf7d3aacbe164083,0xbf731447bea09ae5,0xbf7bf531be354098,0xbf703b37beb0eacb,0xbf7a7302be541501,0xbf6d1c1dbec1071e,0xbf78b47bbe72b651,0xbf69b7e4bed0eb2a
.quad 0xbf76ba07be888e93,0xbf660f88bee0924f,0xbf748422be97a117,0xbf62241abeeff7fb,0xbf721352bea68f12,0xbf5df6bebeff17b2,0xbf6f6830beb554ec,0xbf5988adbf06f686
.quad 0xbf61c598bef15aea,0xbf4d9f02bf187fc0,0xbf5c61c7bf0242b1,0xbf466354bf21cbfb,0xbf5695e5bf0b9a6b,0xbf3ebc1bbf2ac082,0xbf5064afbf14b039,0xbf36ad7fbf33587a
.quad 0xbf49d112bf1d7fd1,0xbf2e3bdebf3b8f3b,0xbf42de29bf26050a,0xbf256bcbbf436051,0xbf3b8f3bbf2e3bde,0xbf1c420cbf4ac77f,0xbf33e7bcbf36206c,0xbf12c39abf51c0c2
.quad 0xbf2beb4abf3daef9,0xbf08f59bbf584853,0xbf239da9bf44e3f5,0xbefdbabbbf5e5aa6,0xbf1b02c6bf4bbbf8,0xbee900b7bf63f473,0xbf121eb0bf5233c6,0xbed3c867bf6912ae
.quad 0xbf08f59bbf584853,0xbebe1d4abf6db293,0xbeff17b2bf5df6be,0xbea80b1fbf71d19f,0xbeebcbbbbf633c5a,0xbe919dddbf756d97,0xbed8106bbf6816a8,0xbe75c35abf788486
.quad 0xbf3504f3bf3504f3,0xbf187fc0bf4d9f02,0xbf2beb4abf3daef9,0xbf0d9281bf554aa4,0xbf226799bf45e403,0xbf0242b1bf5c61c7,0xbf187fc0bf4d9f02,0xbeed3063bf62df7b
.quad 0xbf0e39dabf54db31,0xbed53641bf68bf3c,0xbf039c3dbf5b941a,0xbebca7afbf6dfcf2,0xbef15aeabf61c598,0xbea395c5bf7294f8,0xbedae880bf676bd8,0xbe8a11f7bf76841b
.quad 0xbec3ef15bf6c835e,0xbe605c13bf79c79d,0xbeac7cd4bf710908,0xbe2bf804bf7c5d3a,0xbe94a031bf74fa0b,0xbdee3876bf7e4323,0xbe78cfccbf7853f8,0xbd83db0abf7f7808
.quad 0xbe47c5c2bf7b14be,0xbc490e90bf7ffb11,0xbe164083bf7d3aac,0x3d2351cbbf7fcbe2,0xbdc8bd36bf7ec46d,0x3dbc3ac3bf7eea9d,0xbd48fb30bf7fb10f,0x3e1324cabf7d57de
.quad 0xbe47c5c2bf7b14be,0xbd48fb30bf7fb10f,0xbe09cf86bf7dabcc,0x3c7b514bbf7ff84a,0xbd96a905bf7f4e6d,0x3da3308cbf7f2f9d,0xbc490e90bf7ffb11,0x3e1324cabf7d57de
.quad 0x3d48fb30bf7fb10f,0x3e541501bf7a7302,0x3de1bc2ebf7e70b0,0x3e8a11f7bf76841b,0x3e2f10a2bf7c3b28,0x3ea986c4bf718f57,0x3e6c9a7fbf791298,0x3ec8477cbf6b99fb
.quad 0x3e94a031bf74fa0b,0x3ee63375bf64aa59,0x3eb263efbf6ff573,0x3f019573bf5cc7d1,0x3ecf7bcabf6a09a7,0x3f0f8784bf53fac3,0x3eebcbbbbf633c5a,0x3f1ce11fbf4a4c87
.quad 0x3f039c3dbf5b941a,0x3f299415bf3fc767,0x3f10d3cdbf531849,0x3f3592e7bf34768f,0x3f1d7fd1bf49d112,0x3f40d0dabf286605,0x3f299415bf3fc767,0x3f4b41fabf1ba299
.quad 0x3ec3ef15bf6c835e,0x3f039c3dbf5b941a,0x3ee63375bf64aa59,0x3f140c5fbf50d937,0x3f039c3dbf5b941a,0x3f239da9bf44e3f5,0x3f13682abf514d3d,0x3f3238aabf37c655
.quad 0x3f226799bf45e403,0x3f3fc767bf299415,0x3f3085bbbf396842,0x3f4c3578bf1a6293,0x3f3daef9bf2beb4a,0x3f577026bf0a48ad,0x3f49d112bf1d7fd1,0x3f61668abef2bd43
.quad 0x3f54db31bf0e39da,0x3f6a09a7becf7bca,0x3f5ebe05befc5d27,0x3f714c7abeab0201,0x3f676bd8bedae880,0x3f772417be8586ce,0x3f6ed89ebeb8442a,0x3f7b87b2be3e853e
.quad 0x3f74fa0bbe94a031,0x3f7e70b0bde1bc2e,0x3f79c79dbe605c13,0x3f7fdaafbd0a342f,0x3f7d3aacbe164083,0x3f7fc38f3d2fe007,0x3f7f4e6dbd96a905,0x3f7e2b723df475c0
.quad 0x3f54db31bf0e39da,0x3f676bd8bedae880,0x3f604621bef6e0cb,0x3f703b37beb0eacb,0x3f6a09a7becf7bca,0x3f772417be8586ce,0x3f721352bea68f12,0x3f7c187abe3228d4
.quad 0x3f7853f8be78cfcc,0x3f7f0e58bdafb680,0x3f7cbfc9be22abb6,0x3f7fffb13b490fc6,0x3f7f4e6dbd96a905,0x3f7eea9d3dbc3ac3,0x3f7ffb113c490e90,0x3f7bd14d3e3857ec
.quad 0x3f7ec46d3dc8bd36,0x3f76ba073e888e93,0x3f7baccd3e3b6ecf,0x3f6faf1b3eb3dca5,0x3f76ba073e888e93,0x3f66becc3eddbe79,0x3f6ff5733eb263ef,0x3f5bfb343f02ef9f
.quad 0x3f676bd83edae880,0x3f4f7a1f3f15f6d9,0x3f5d2d533f00e7e4,0x3f4154e13f27ce61,0x3f514d3d3f13682a,0x3f31a81d3f385216,0x3f43e2003f24d225,0x3f2093933f476085
.quad 0xbef15aeabf61c598,0xbeac7cd4bf710908,0xbed8106bbf6816a8,0xbe901c2cbf75a67b,0xbebe1d4abf6db293,0xbe667c66bf796e4e,0xbea395c5bf7294f8,0xbe2bf804bf7c5d3a
.quad 0xbe888e93bf76ba07,0xbde1bc2ebf7e70b0,0xbe5a3997bf7a1e84,0xbd55880ebf7fa6e3,0xbe22abb6bf7cbfc9,0x3bc90f88bf7ffec4,0xbdd53db9bf7e9bc9,0x3d83db0abf7f7808
.quad 0xbd48fb30bf7fb10f,0x3dfab273bf7e1324,0x3bc90f88bf7ffec4,0x3e3857ecbf7bd14d,0x3d7b2b74bf7f84ab,0x3e72b651bf78b47b,0x3dee3876bf7e4323,0x3e9620d2bf74bf62
.quad 0x3e2f10a2bf7c3b28,0x3eb263efbf6ff573,0x3e667c66bf796e4e,0x3ece0beabf6a5ad9,0x3e8e9a22bf75dec6,0x3ee900b7bf63f473,0x3ea986c4bf718f57,0x3f019573bf5cc7d1
.quad 0x3dc8bd36bf7ec46d,0x3e78cfccbf7853f8,0x3e28defcbf7c7eb0,0x3e9f1cdfbf73530e,0x3e6c9a7fbf791298,0x3ec1071ebf6d1c1d,0x3e97a117bf748422,0x3ee1fb6abf65b710
.quad 0x3eb8442abf6ed89e,0x3f00e7e4bf5d2d53,0x3ed8106bbf6816a8,0x3f102dd5bf5389c7,0x3ef6e0cbbf604621,0x3f1ebc12bf48d8b3,0x3f0a48adbf577026,0x3f2c800fbf3d27b8
.quad 0x3f187fc0bf4d9f02,0x3f396842bf3085bb,0x3f26050abf42de29,0x3f456439bf2302d3,0x3f32c8c9bf373a23,0x3f5064afbf14b039,0x3f3ebc1bbf2ac082,0x3f5a5ba0bf05a02c
.quad 0x3f49d112bf1d7fd1,0x3f633c5abeebcbbb,0x3f53fac3bf0f8784,0x3f6afb8cbecb2aae,0x3f5d2d53bf00e7e4,0x3f718f57bea986c4,0x3f655e0bbee363fa,0x3f76ef5bbe870ada
.quad 0x3f226799bf45e403,0x3f3daef9bf2beb4a,0x3f31a81dbf385216,0x3f4b41fabf1ba299,0x3f3fc767bf299415,0x3f577026bf0a48ad,0x3f4cae79bf19c200,0x3f62241abeeff7fb
.quad 0x3f584853bf08f59b,0x3f6b4b0cbec9b953,0x3f628210beee9479,0x3f72d4ebbea21887,0x3f6b4b0cbec9b953,0x3f78b47bbe72b651,0x3f7294f8bea395c5,0x3f7cdf6cbe1f917b
.quad 0x3f7853f8be78cfcc,0x3f7f4e6dbd96a905,0x3f7c7eb0be28defc,0x3f7ffd393c16cb58,0x3f7f0e58bdafb680,0x3f7eea9d3dbc3ac3,0x3f7ffec4bbc90f88,0x3f7c187a3e3228d4
.quad 0x3f7f4e6d3d96a905,0x3f778bc53e827dc0,0x3f7cfe733e1c76de,0x3f714c7a3eab0201,0x3f7912983e6c9a7f,0x3f6965913ed25a09,0x3f73913f3e9d9e78,0x3f5fe4e93ef840c8
.quad 0x3f74fa0bbe94a031,0x3f7d3aacbe164083,0x3f7ac516be4dee60,0x3f7fa6e3bd55880e,0x3f7e70b0bde1bc2e,0x3f7fc38f3d2fe007,0x3f7ff4e6bc96c9b6,0x3f7d906e3e0cec4a
.quad 0x3f7f4e6d3d96a905,0x3f7912983e6c9a7f,0x3f7c7eb03e28defc,0x3f7254703ea5129f,0x3f778bc53e827dc0,0x3f6965913ed25a09,0x3f7080663eaf713a,0x3f5e5aa63efdbabb
.quad 0x3f676bd83edae880,0x3f514d3d3f13682a,0x3f5c61c73f0242b1,0x3f425b893f269de3,0x3f4f7a1f3f15f6d9,0x3f31a81d3f385216,0x3f40d0da3f286605,0x3f1f599f3f485bca
.quad 0x3f3085bb3f396842,0x3f0b9a6b3f5695e5,0x3f1ebc123f48d8b3,0x3eed30633f62df7b,0x3f0b9a6b3f5695e5,0x3ec1071e3f6d1c1d,0x3eee94793f628210,0x3e931f353f75341d
.quad 0x3f803f803f803f80,0x3f803f803f803f80,0x3f723f7a3f7e3f80,0x3f353f483f593f67,0x3f483f673f7a3f80,0x248d3e643ede3f20,0x3f083f483f723f80,0xbf35bedebde53e64
.quad 0x3e643f203f673f80,0xbf80bf67bf20be64,0xbde53ede3f593f80,0xbf35bf7abf72bf20,0xbede3e643f483f80,0xa554bf20bf7abf67,0xbf35248d3f353f80,0x3f35a554bf35bf80
.quad 0xbf67be643f203f80,0x3f803f20be64bf67,0xbf7ebede3f083f80,0x3f353f7a3ea9bf20,0xbf7abf203ede3f80,0x248d3f673f48be64,0xbf59bf483ea93f80,0xbf353ede3f7e3e64
.quad 0xbf20bf673e643f80,0xbf80be643f673f20,0xbea9bf7a3de53f80,0xbf35bf483f083f67,0xa554bf80248d3f80,0xa554bf80248d3f80,0x3ea9bf7abde53f80,0x3f35bf48bf083f67
.quad 0x3f803f803f803f80,0x3f803f803f803f80,0x3ea93ede3f083f20,0xbde5248d3de53e64,0xbf48bf20bedebe64,0xbf7abf80bf7abf67,0xbf59bf7abf7ebf67,0x3ea9a554bea9bf20
.quad 0x3e64be64bf20bf67,0x3f673f803f673f20,0x3f7e3f483ea9be64,0xbf08248d3f083f67,0x3ede3f673f7a3f20,0xbf48bf80bf48be64,0xbf35248d3f353f80,0x3f35a554bf35bf80
.quad 0xbf67bf67be643f20,0x3f203f803f20be64,0x3de5bf48bf72be64,0xbf59248d3f593f67,0x3f7a3e64bf48bf67,0xbedebf80bede3f20,0x3f083f7a3de5bf67,0x3f72a554bf72bf20
.quad 0xbf203f203f67be64,0x3e643f803e64bf67,0xbf72bede3f593f20,0xbf7e248d3f7e3e64,0xa554bf80248d3f80,0xa554bf80248d3f80,0x3f72bedebf593f20,0x3f7ea554bf7e3e64
.quad 0x3f803f803f803f80,0x3f803f803f803f80,0xbf08bedebea9be64,0xbf59bf48bf35bf20,0xbedebf20bf48bf67,0x3ede3e64a554be64,0x3f7e3f7a3f593f20,0x3de53ede3f353f67
.quad 0xbf20be643e643f20,0xbf20bf67bf80bf67,0xbea9bf48bf7ebf67,0x3f723f7a3f353e64,0x3f7a3f673edebe64,0xbf7abf20248d3f20,0xbf35248d3f353f80,0x3f35a554bf35bf80
.quad 0xbe64bf67bf67be64,0xbe643f203f803f20,0x3f723f48bde5bf67,0xbea9bf7abf353e64,0xbf483e643f7a3f20,0x3f483f67a554bf67,0xbde5bf7abf083f20,0xbf7ebede3f353f67
.quad 0x3f673f20bf20bf67,0x3f67be64bf80be64,0xbf593ede3f72be64,0xbf083f483f35bf20,0xa554bf80248d3f80,0xa554bf80248d3f80,0x3f593edebf72be64,0x3f083f48bf35bf20
.quad 0x3f803f803f803f80,0x3f803f803f803f80,0xbf7ebf7abf72bf67,0xbf72bf7abf7ebf80,0x3f7a3f673f483f20,0x3f483f673f7a3f80,0xbf72bf48bf08be64,0xbf08bf48bf72bf80
.quad 0x3f673f203e64be64,0x3e643f203f673f80,0xbf59bede3de53f20,0x3de5bedebf59bf80,0x3f483e64bedebf67,0xbede3e643f483f80,0xbf35248d3f353f80,0x3f35a554bf35bf80
.quad 0x3f20be64bf67bf67,0xbf67be643f203f80,0xbf083ede3f7e3f20,0x3f7e3edebf08bf80,0x3edebf20bf7abe64,0xbf7abf203ede3f80,0xbea93f483f59be64,0x3f593f48bea9bf80
.quad 0x3e64bf67bf203f20,0xbf20bf673e643f80,0xbde53f7a3ea9bf67,0x3ea93f7abde5bf80,0xa554bf80248d3f80,0xa554bf80248d3f80,0x3de53f7abea9bf67,0xbea93f7a3de5bf80
.quad 0x3f803f803f803f80,0x3f803f803f803f80,0xbf35bf48bf59bf67,0xbea9bedebf08bf20,0x248d3e643ede3f20,0xbf48bf20bedebe64,0x3f353ede3de5be64,0x3f593f7a3f7e3f67
.quad 0xbf80bf67bf20be64,0x3e64be64bf20bf67,0x3f353f7a3f723f20,0xbf7ebf48bea93e64,0xa554bf20bf7abf67,0x3ede3f673f7a3f20,0xbf35248d3f353f80,0x3f35a554bf35bf80
.quad 0x3f803f20be64bf67,0xbf67bf67be643f20,0xbf35bf7abea93f20,0xbde53f483f723e64,0x248d3f673f48be64,0x3f7a3e64bf48bf67,0x3f35bedebf7ebe64,0xbf08bf7abde53f67
.quad 0xbf80be643f673f20,0xbf203f203f67be64,0x3f353f48bf08bf67,0x3f723edebf59bf20,0xa554bf80248d3f80,0xa554bf80248d3f80,0xbf353f483f08bf67,0xbf723ede3f59bf20
.quad 0x3f803f803f803f80,0x3f803f803f803f80,0x3de5a554bde5be64,0x3f083ede3ea93e64,0xbf7abf80bf7abf67,0xbedebf20bf48bf67,0xbea9248d3ea93f20,0xbf7ebf7abf59bf20
.quad 0x3f673f803f673f20,0xbf20be643e643f20,0x3f08a554bf08bf67,0x3ea93f483f7e3f67,0xbf48bf80bf48be64,0x3f7a3f673edebe64,0xbf35248d3f353f80,0x3f35a554bf35bf80
.quad 0x3f203f803f20be64,0xbe64bf67bf67be64,0x3f59a554bf59bf67,0xbf72bf483de53f67,0xbedebf80bede3f20,0xbf483e643f7a3f20,0xbf72248d3f723f20,0x3de53f7a3f08bf20
.quad 0x3e643f803e64bf67,0x3f673f20bf20bf67,0x3f7ea554bf7ebe64,0x3f59bedebf723e64,0xa554bf80248d3f80,0xa554bf80248d3f80,0xbf7e248d3f7ebe64,0xbf59bede3f723e64
.quad 0x3f803f803f803f80,0x3f803f803f803f80,0x3f593f483f353f20,0x3f7e3f7a3f723f67,0x3ede3e64a554be64,0x3f7a3f673f483f20,0xbde5bedebf35bf67,0x3f723f483f083e64
.quad 0xbf20bf67bf80bf67,0x3f673f203e64be64,0xbf72bf7abf35be64,0x3f593edebde5bf20,0xbf7abf20248d3f20,0x3f483e64bedebf67,0xbf35248d3f353f80,0x3f35a554bf35bf80
.quad 0xbe643f203f803f20,0x3f20be64bf67bf67,0x3ea93f7a3f35be64,0x3f08bedebf7ebf20,0x3f483f67a554bf67,0x3edebf20bf7abe64,0x3f7e3edebf35bf67,0x3ea9bf48bf593e64
.quad 0x3f67be64bf80be64,0x3e64bf67bf203f20,0x3f08bf48bf353f20,0x3de5bf7abea93f67,0xa554bf80248d3f80,0xa554bf80248d3f80,0xbf08bf483f353f20,0xbde5bf7a3ea93f67
.quad 0x0,0x0,0x0,0x0,0x0,0x0,0x0,0x0
.quad 0x0,0x0,0x0,0x0,0x0,0x0,0x0,0x0
.quad 0x0,0x0,0x0,0x0,0x0,0x0,0x0,0x0
.quad 0x0,0x0,0x0,0x0,0x0,0x0,0x0,0x0
.quad 0x8000800080008000,0x8000800080008000,0xbea9be64bde58000,0xbf35bf20bf08bede,0xbf20bedebe648000,0xbf80bf7abf67bf48,0xbf59bf20bea98000,0xbf35bf67bf7ebf7a
.quad 0xbf7abf48bede8000,0xa50dbedebf48bf7a,0xbf7ebf67bf088000,0x3f353e64bea9bf48,0xbf67bf7abf208000,0x3f803f483e64bede,0xbf35bf80bf358000,0x3f353f803f35a50d
.quad 0xbedebf7abf488000,0x80003f483f7a3ede,0xbde5bf67bf598000,0xbf353e643f723f48,0x3e64bf48bf678000,0xbf80bede3f203f7a,0x3f08bf20bf728000,0xbf35bf673de53f7a
.quad 0x3f48bedebf7a8000,0xa50dbf7abede3f48,0x3f72be64bf7e8000,0x3f35bf20bf593ede,0x3f80a50dbf808000,0x3f80a50dbf808000,0x3f723e64bf7e8000,0x3f353f20bf59bede
.quad 0x8000800080008000,0x8000800080008000,0xbf72bf67bf59bf48,0xbf7ebf80bf7ebf7a,0xbf20bf48bf67bf7a,0x3e64a50dbe64bede,0x3f083e64bde5bede,0x3f723f803f723f48
.quad 0x3f7a3f7a3f483ede,0xbede80003ede3f48,0x3de53f203f723f7a,0xbf59bf80bf59bede,0xbf67bede3e643f48,0x3f20a50dbf20bf7a,0xbf35bf80bf358000,0x3f353f803f35a50d
.quad 0x3edebedebf7abf48,0xbf4880003f483f7a,0x3f7e3f20bea9bf7a,0xbf08bf80bf083ede,0x3e643f7a3f20bede,0x3f67a50dbf67bf48,0xbf593e643f7e3ede,0x3ea93f803ea9bf48
.quad 0xbf48bf483ede3f7a,0xbf7a80003f7a3ede,0x3ea9bf67bf083f48,0xbde5bf80bde53f7a,0x3f80a50dbf808000,0x3f80a50dbf808000,0x3ea93f67bf08bf48,0xbde53f80bde5bf7a
.quad 0x8000800080008000,0x8000800080008000,0xbf59bf67bf72bf7a,0xbf08bf20bf35bf48,0x3f673f483f203ede,0x3f673f7a3f803f7a,0xbde53e643f083f48,0xbf7ebf67bf35bede
.quad 0xbf48bf7abf7abf48,0x3f483edea50dbede,0x3f723f203de5bede,0xbea93e643f353f7a,0xbe643ede3f673f7a,0xbe64bf48bf80bf48,0xbf35bf80bf358000,0x3f353f803f35a50d
.quad 0x3f7a3edebedebf7a,0xbf7abf4880003f48,0xbea93f203f7e3ede,0x3f723e64bf35bf7a,0xbf20bf7abe643f48,0xbf203ede3f803ede,0x3f7e3e64bf59bf48,0x3de5bf67bf353ede
.quad 0xbede3f483f48bede,0x3ede3f7aa50dbf7a,0xbf08bf673ea93f7a,0xbf59bf203f353f48,0x3f80a50dbf808000,0x3f80a50dbf808000,0xbf083f673ea9bf7a,0xbf593f203f35bf48
.quad 0x8000800080008000,0x8000800080008000,0xbde5be64bea9bede,0x3ea93e643de5a50d,0x3e643ede3f203f48,0xbf20bedebe648000,0xbea9bf20bf59bf7a,0x3f593f203ea9a50d
.quad 0x3ede3f483f7a3f7a,0xbf7abf48bede8000,0xbf08bf67bf7ebf48,0x3f7e3f673f08a50d,0x3f203f7a3f673ede,0xbf67bf7abf208000,0xbf35bf80bf358000,0x3f353f803f35a50d
.quad 0x3f483f7a3edebede,0xbedebf7abf488000,0xbf59bf67bde53f48,0x3de53f673f59a50d,0x3f673f48be64bf7a,0x3e64bf48bf678000,0xbf72bf203f083f7a,0xbf083f203f72a50d
.quad 0x3f7a3edebf48bf48,0x3f48bedebf7a8000,0xbf7ebe643f723ede,0xbf723e643f7ea50d,0x3f80a50dbf808000,0x3f80a50dbf808000,0xbf7e3e643f72bede,0xbf72be643f7ea50d
.quad 0x8000800080008000,0x8000800080008000,0x3f353f203f083ede,0x3f723f673f593f48,0xbf80bf7abf67bf48,0xbf20bf48bf67bf7a,0x3f353f673f7e3f7a,0xbf08be643de53ede
.quad 0xa50dbedebf48bf7a,0x3f7a3f7a3f483ede,0xbf35be643ea93f48,0xbde5bf20bf72bf7a,0x3f803f483e64bede,0xbf67bede3e643f48,0xbf35bf80bf358000,0x3f353f803f35a50d
.quad 0x80003f483f7a3ede,0x3edebedebf7abf48,0x3f35be64bf72bf48,0xbf7ebf203ea93f7a,0xbf80bede3f203f7a,0x3e643f7a3f20bede,0x3f353f67bde5bf7a,0x3f59be64bf7ebede
.quad 0xa50dbf7abede3f48,0xbf48bf483ede3f7a,0xbf353f203f59bede,0xbea93f673f08bf48,0x3f80a50dbf808000,0x3f80a50dbf808000,0xbf35bf203f593ede,0xbea9bf673f083f48
.quad 0x8000800080008000,0x8000800080008000,0x3f7e3f803f7e3f7a,0x3f593f673f723f7a,0x3e64a50dbe64bede,0x3f673f483f203ede,0xbf72bf80bf72bf48,0x3de5be64bf08bf48
.quad 0xbede80003ede3f48,0xbf48bf7abf7abf48,0x3f593f803f593ede,0xbf72bf20bde53ede,0x3f20a50dbf20bf7a,0xbe643ede3f673f7a,0xbf35bf80bf358000,0x3f353f803f35a50d
.quad 0xbf4880003f483f7a,0x3f7a3edebedebf7a,0x3f083f803f08bede,0x3ea9bf20bf7ebede,0x3f67a50dbf67bf48,0xbf20bf7abe643f48,0xbea9bf80bea93f48,0xbf7ebe643f593f48
.quad 0xbf7a80003f7a3ede,0xbede3f483f48bede,0x3de53f803de5bf7a,0x3f083f67bea9bf7a,0x3f80a50dbf808000,0x3f80a50dbf808000,0x3de5bf803de53f7a,0x3f08bf67bea93f7a
.quad 0x8000800080008000,0x8000800080008000,0x3f083f203f353f48,0x3de53e643ea93ede,0x3f673f7a3f803f7a,0x3e643ede3f203f48,0x3f7e3f673f353ede,0x3ea93f203f593f7a
.quad 0x3f483edea50dbede,0x3ede3f483f7a3f7a,0x3ea9be64bf35bf7a,0x3f083f673f7e3f48,0xbe64bf48bf80bf48,0x3f203f7a3f673ede,0xbf35bf80bf358000,0x3f353f803f35a50d
.quad 0xbf7abf4880003f48,0x3f483f7a3edebede,0xbf72be643f353f7a,0x3f593f673de5bf48,0xbf203ede3f803ede,0x3f673f48be64bf7a,0xbde53f673f35bede,0x3f723f20bf08bf7a
.quad 0x3ede3f7aa50dbf7a,0x3f7a3edebf48bf48,0x3f593f20bf35bf48,0x3f7e3e64bf72bede,0x3f80a50dbf808000,0x3f80a50dbf808000,0x3f59bf20bf353f48,0x3f7ebe64bf723ede
.quad 0x0,0x0,0x0,0x0,0x0,0x0,0x0,0x0
.quad 0x0,0x0,0x0,0x0,0x0,0x0,0x0,0x0
.quad 0x0,0x0,0x0,0x0,0x0,0x0,0x0,0x0
.quad 0x0,0x0,0x0,0x0,0x0,0x0,0x0,0x0
.quad 0x3f20bf67be643f80,0x3f80be64bf673f20,0x3f59bf48bea93f80,0x3f353edebf7e3e64,0x3f7abf20bede3f80,0x248d3f67bf48be64,0x3f7ebedebf083f80,0xbf353f7abea9bf20
.quad 0x3f67be64bf203f80,0xbf803f203e64bf67,0x3f35a554bf353f80,0xbf35248d3f35bf80,0x3ede3e64bf483f80,0xa554bf203f7abf67,0x3de53edebf593f80,0x3f35bf7a3f72bf20
.quad 0xbe643f20bf673f80,0x3f80bf673f20be64,0xbf083f48bf723f80,0x3f35bede3de53e64,0xbf483f67bf7a3f80,0x248d3e64bede3f20,0xbf723f7abf7e3f80,0xbf353f48bf593f67
.quad 0xbf803f80bf803f80,0xbf803f80bf803f80,0x0,0x0,0x0,0x0,0x0,0x0
.quad 0x3f203f20bf67be64,0xbe643f80be64bf67,0xbf083f7abde5bf67,0xbf72248d3f72bf20,0xbf7a3e643f48bf67,0x3edebf803ede3f20,0xbde5bf483f72be64,0x3f59a554bf593f67
.quad 0x3f67bf673e643f20,0xbf203f80bf20be64,0x3f35a554bf353f80,0xbf35248d3f35bf80,0xbede3f67bf7a3f20,0x3f48bf803f48be64,0xbf7e3f48bea9be64,0x3f08a554bf083f67
.quad 0xbe64be643f20bf67,0xbf673f80bf673f20,0x3f59bf7a3f7ebf67,0xbea9248d3ea9bf20,0x3f48bf203edebe64,0x3f7abf803f7abf67,0xbea93edebf083f20,0x3de5a554bde53e64
.quad 0xbf803f80bf803f80,0xbf803f80bf803f80,0x0,0x0,0x0,0x0,0x0,0x0
.quad 0xbf673f203f20bf67,0xbf67be643f80be64,0x3de5bf7a3f083f20,0x3f7ebedebf353f67,0x3f483e64bf7a3f20,0xbf483f67a554bf67,0xbf723f483de5bf67,0x3ea9bf7a3f353e64
.quad 0x3e64bf673f67be64,0x3e643f20bf803f20,0x3f35a554bf353f80,0xbf35248d3f35bf80,0xbf7a3f67bedebe64,0x3f7abf20248d3f20,0x3ea9bf483f7ebf67,0xbf723f7abf353e64
.quad 0x3f20be64be643f20,0x3f20bf673f80bf67,0xbf7e3f7abf593f20,0xbde53edebf353f67,0x3edebf203f48bf67,0xbede3e64a554be64,0x3f08bede3ea9be64,0x3f59bf483f35bf20
.quad 0xbf803f80bf803f80,0xbf803f80bf803f80,0x0,0x0,0x0,0x0,0x0,0x0
.quad 0xbe64bf673f203f20,0x3f20bf67be643f80,0x3ea93f48bf59be64,0xbf593f483ea9bf80,0xbedebf203f7abe64,0x3f7abf20bede3f80,0x3f083edebf7e3f20,0xbf7e3ede3f08bf80
.quad 0xbf20be643f67bf67,0x3f67be64bf203f80,0x3f35a554bf353f80,0xbf35248d3f35bf80,0xbf483e643edebf67,0x3ede3e64bf483f80,0x3f59bedebde53f20,0xbde5bede3f59bf80
.quad 0xbf673f20be64be64,0xbe643f20bf673f80,0x3f72bf483f08be64,0x3f08bf483f72bf80,0xbf7a3f67bf483f20,0xbf483f67bf7a3f80,0x3f7ebf7a3f72bf67,0x3f72bf7a3f7ebf80
.quad 0xbf803f80bf803f80,0xbf803f80bf803f80,0x0,0x0,0x0,0x0,0x0,0x0
.quad 0x3f80be64bf673f20,0x3f203f20bf67be64,0xbf35bede3f7ebe64,0x3f08bf7a3de53f67,0x248d3f67bf48be64,0xbf7a3e643f48bf67,0x3f35bf7a3ea93f20,0x3de53f48bf723e64
.quad 0xbf803f203e64bf67,0x3f67bf673e643f20,0x3f35a554bf353f80,0xbf35248d3f35bf80,0xa554bf203f7abf67,0xbede3f67bf7a3f20,0xbf353f7abf723f20,0x3f7ebf483ea93e64
.quad 0x3f80bf673f20be64,0xbe64be643f20bf67,0xbf353edebde5be64,0xbf593f7abf7e3f67,0x248d3e64bede3f20,0x3f48bf203edebe64,0x3f35bf483f59bf67,0x3ea9bede3f08bf20
.quad 0xbf803f80bf803f80,0xbf803f80bf803f80,0x0,0x0,0x0,0x0,0x0,0x0
.quad 0xbe643f80be64bf67,0xbf673f203f20bf67,0x3f72a554bf723f20,0xbde53f7abf08bf20,0x3edebf803ede3f20,0x3f483e64bf7a3f20,0xbf59248d3f59bf67,0x3f72bf48bde53f67
.quad 0xbf203f80bf20be64,0x3e64bf673f67be64,0x3f35a554bf353f80,0xbf35248d3f35bf80,0x3f48bf803f48be64,0xbf7a3f67bedebe64,0xbf08248d3f08bf67,0xbea93f48bf7e3f67
.quad 0xbf673f80bf673f20,0x3f20be64be643f20,0x3ea9a554bea93f20,0x3f7ebf7a3f59bf20,0x3f7abf803f7abf67,0x3edebf203f48bf67,0xbde5248d3de5be64,0xbf083edebea93e64
.quad 0xbf803f80bf803f80,0xbf803f80bf803f80,0x0,0x0,0x0,0x0,0x0,0x0
.quad 0xbf67be643f80be64,0xbe64bf673f203f20,0xbf7e3ede3f35bf67,0xbea9bf483f593e64,0xbf483f67a554bf67,0xbedebf203f7abe64,0xbea93f7abf35be64,0xbf08bede3f7ebf20
.quad 0x3e643f20bf803f20,0xbf20be643f67bf67,0x3f35a554bf353f80,0xbf35248d3f35bf80,0x3f7abf20248d3f20,0xbf483e643edebf67,0x3f72bf7a3f35be64,0xbf593ede3de5bf20
.quad 0x3f20bf673f80bf67,0xbf673f20be64be64,0x3de5bede3f35bf67,0xbf723f48bf083e64,0xbede3e64a554be64,0xbf7a3f67bf483f20,0xbf593f48bf353f20,0xbf7e3f7abf723f67
.quad 0xbf803f80bf803f80,0xbf803f80bf803f80,0x0,0x0,0x0,0x0,0x0,0x0
.quad 0x0,0x0,0x0,0x0,0x0,0x0,0x0,0x0
.quad 0x0,0x0,0x0,0x0,0x0,0x0,0x0,0x0
.quad 0x0,0x0,0x0,0x0,0x0,0x0,0x0,0x0
.quad 0x0,0x0,0x0,0x0,0x0,0x0,0x0,0x0
.quad 0x3f483edebf7a8000,0x80003f7abedebf48,0x3f083f20bf728000,0xbf353f673de5bf7a,0x3e643f48bf678000,0xbf803ede3f20bf7a,0xbde53f67bf598000,0xbf35be643f72bf48
.quad 0xbede3f7abf488000,0xa50dbf483f7abede,0xbf353f80bf358000,0x3f35bf803f35a50d,0xbf673f7abf208000,0x3f80bf483e643ede,0xbf7e3f67bf088000,0x3f35be64bea93f48
.quad 0xbf7a3f48bede8000,0x80003edebf483f7a,0xbf593f20bea98000,0xbf353f67bf7e3f7a,0xbf203edebe648000,0xbf803f7abf673f48,0xbea93e64bde58000,0xbf353f20bf083ede
.quad 0xa50d8000a50d8000,0xa50d8000a50d8000,0x0,0x0,0x0,0x0,0x0,0x0
.quad 0xbf483f483edebf7a,0xbf7a80003f7abede,0xbf59be643f7ebede,0x3ea9bf803ea93f48,0x3e64bf7a3f203ede,0x3f67a50dbf673f48,0x3f7ebf20bea93f7a,0xbf083f80bf08bede
.quad 0x3ede3edebf7a3f48,0xbf4880003f48bf7a,0xbf353f80bf358000,0x3f35bf803f35a50d,0xbf673ede3e64bf48,0x3f20a50dbf203f7a,0x3de5bf203f72bf7a,0xbf593f80bf593ede
.quad 0x3f7abf7a3f48bede,0xbede80003edebf48,0x3f08be64bde53ede,0x3f72bf803f72bf48,0xbf203f48bf673f7a,0x3e64a50dbe643ede,0xbf723f67bf593f48,0xbf7e3f80bf7e3f7a
.quad 0xa50d8000a50d8000,0xa50d8000a50d8000,0x0,0x0,0x0,0x0,0x0,0x0
.quad 0xbedebf483f483ede,0x3edebf7a80003f7a,0x3f7ebe64bf593f48,0x3de53f67bf35bede,0xbf203f7abe64bf48,0xbf20bede3f80bede,0xbea9bf203f7ebede,0x3f72be64bf353f7a
.quad 0x3f7abedebede3f7a,0xbf7a3f48a50dbf48,0xbf353f80bf358000,0x3f35bf803f35a50d,0xbe64bede3f67bf7a,0xbe643f48bf803f48,0x3f72bf203de53ede,0xbea9be643f35bf7a
.quad 0xbf483f7abf7a3f48,0x3f48bede80003ede,0xbde5be643f08bf48,0xbf7e3f67bf353ede,0x3f67bf483f20bede,0x3f67bf7a3f80bf7a,0xbf593f67bf723f7a,0xbf083f20bf353f48
.quad 0xa50d8000a50d8000,0xa50d8000a50d8000,0x0,0x0,0x0,0x0,0x0,0x0
.quad 0x3f7abedebf483f48,0x3f483edebf7a8000,0xbf723f203f08bf7a,0xbf08bf203f72a50d,0x3f67bf48be643f7a,0x3e643f48bf678000,0xbf593f67bde5bf48,0x3de5bf673f59a50d
.quad 0x3f48bf7a3ede3ede,0xbede3f7abf488000,0xbf353f80bf358000,0x3f35bf803f35a50d,0x3f20bf7a3f67bede,0xbf673f7abf208000,0xbf083f67bf7e3f48,0x3f7ebf673f08a50d
.quad 0x3edebf483f7abf7a,0xbf7a3f48bede8000,0xbea93f20bf593f7a,0x3f59bf203ea9a50d,0x3e64bede3f20bf48,0xbf203edebe648000,0xbde53e64bea93ede,0x3ea9be643de5a50d
.quad 0xa50d8000a50d8000,0xa50d8000a50d8000,0x0,0x0,0x0,0x0,0x0,0x0
.quad 0x80003f7abedebf48,0xbf483f483edebf7a,0x3f35bf67bde53f7a,0x3f593e64bf7e3ede,0xbf803ede3f20bf7a,0x3e64bf7a3f203ede,0x3f353e64bf723f48,0xbf7e3f203ea9bf7a
.quad 0xa50dbf483f7abede,0x3ede3edebf7a3f48,0xbf353f80bf358000,0x3f35bf803f35a50d,0x3f80bf483e643ede,0xbf673ede3e64bf48,0xbf353e643ea9bf48,0xbde53f20bf723f7a
.quad 0x80003edebf483f7a,0x3f7abf7a3f48bede,0x3f35bf673f7ebf7a,0xbf083e643de5bede,0xbf803f7abf673f48,0xbf203f48bf673f7a,0x3f35bf203f08bede,0x3f72bf673f59bf48
.quad 0xa50d8000a50d8000,0xa50d8000a50d8000,0x0,0x0,0x0,0x0,0x0,0x0
.quad 0xbf7a80003f7abede,0xbedebf483f483ede,0xbea93f80bea9bf48,0xbf7e3e643f59bf48,0x3f67a50dbf673f48,0xbf203f7abe64bf48,0x3f08bf803f083ede,0x3ea93f20bf7e3ede
.quad 0xbf4880003f48bf7a,0x3f7abedebede3f7a,0xbf353f80bf358000,0x3f35bf803f35a50d,0x3f20a50dbf203f7a,0xbe64bede3f67bf7a,0x3f59bf803f59bede,0xbf723f20bde5bede
.quad 0xbede80003edebf48,0xbf483f7abf7a3f48,0xbf723f80bf723f48,0x3de53e64bf083f48,0x3e64a50dbe643ede,0x3f67bf483f20bede,0x3f7ebf803f7ebf7a,0x3f59bf673f72bf7a
.quad 0xa50d8000a50d8000,0xa50d8000a50d8000,0x0,0x0,0x0,0x0,0x0,0x0
.quad 0x3edebf7a80003f7a,0x3f7abedebf483f48,0xbde5bf673f353ede,0x3f72bf20bf083f7a,0xbf20bede3f80bede,0x3f67bf48be643f7a,0xbf723e643f35bf7a,0x3f59bf673de53f48
.quad 0xbf7a3f48a50dbf48,0x3f48bf7a3ede3ede,0xbf353f80bf358000,0x3f35bf803f35a50d,0xbe643f48bf803f48,0x3f20bf7a3f67bede,0x3ea93e64bf353f7a,0x3f08bf673f7ebf48
.quad 0x3f48bede80003ede,0x3edebf483f7abf7a,0x3f7ebf673f35bede,0x3ea9bf203f59bf7a,0x3f67bf7a3f80bf7a,0x3e64bede3f20bf48,0x3f08bf203f35bf48,0x3de5be643ea9bede
.quad 0xa50d8000a50d8000,0xa50d8000a50d8000,0x0,0x0,0x0,0x0,0x0,0x0
.quad 0x0,0x0,0x0,0x0,0x0,0x0,0x0,0x0
.quad 0x0,0x0,0x0,0x0,0x0,0x0,0x0,0x0
.quad 0x0,0x0,0x0,0x0,0x0,0x0,0x0,0x0
.quad 0x0,0x0,0x0,0x0,0x0,0x0,0x0,0x0
.quad 0x800000003f800000,0x800000003f800000,0x800000003f800000,0x800000003f800000,0x800000003f800000,0x800000003f800000,0x800000003f800000,0x0
.quad 0xbc65c70c3f7ff98e,0xbce5c1433f7fe638,0xbd2c49b73f7fc600,0xbd65aa203f7f98e6,0xbd8f7f7c3f7f5eee,0xbdac22ae3f7f181a,0xbdc8bd363f7ec46d,0x0
.quad 0xbce5c1433f7fe638,0xbd65aa203f7f98e6,0xbdac22ae3f7f181a,0xbde54da23f7e63ec,0xbe0f25333f7d7c83,0xbe2b86c03f7c620b,0xbe47c5c23f7b14be,0x0
.quad 0xbd2c49b73f7fc600,0xbdac22ae3f7f181a,0xbe00e9413f7df69c,0xbe2b86c03f7c620b,0xbe55d6873f7a5b1d,0xbe7fc5683f77e2bd,0xbe94a0313f74fa0b,0x0
.quad 0xbd65aa203f7f98e6,0xbde54da23f7e63ec,0xbe2b86c03f7c620b,0xbe63dc873f7994e0,0xbe8dbd623f75fead,0xbea91a563f71a257,0xbec3ef153f6c835e,0x0
.quad 0xbd8f7f7c3f7f5eee,0xbe0f25333f7d7c83,0xbe55d6873f7a5b1d,0xbe8dbd623f75fead,0xbeafdd253f706cb1,0xbed11f9b3f69ac2a,0xbef15aea3f61c598,0x0
.quad 0xbdac22ae3f7f181a,0xbe2b86c03f7c620b,0xbe7fc5683f77e2bd,0xbea91a563f71a257,0xbed11f9b3f69ac2a,0xbef7aa013f600ea4,0xbf0e39da3f54db31,0x0
.quad 0xbdc8bd363f7ec46d,0xbe47c5c23f7b14be,0xbe94a0313f74fa0b,0xbec3ef153f6c835e,0xbef15aea3f61c598,0xbf0e39da3f54db31,0xbf2267993f45e403,0x0
.quad 0xbde54da23f7e63ec,0xbe63dc873f7994e0,0xbea91a563f71a257,0xbede26023f66a5e5,0xbf0833413f58c2eb,0xbf1f9d073f48261c,0xbf3504f33f3504f3,0x0
.quad 0xbe00e9413f7df69c,0xbe7fc5683f77e2bd,0xbebd47db3f6ddd24,0xbef7aa013f600ea4,0xbf170daa3f4eaf7a,0xbf2fdf083f3a0669,0xbf45e4033f226799,0x0
.quad 0xbe0f25333f7d7c83,0xbe8dbd623f75fead,0xbed11f9b3f69ac2a,0xbf0833413f58c2eb,0xbf2529fe3f4397f4,0xbf3ee2683f2a95b0,0xbf54db313f0e39da,0x0
.quad 0xbe1d59f03f7cf5a5,0xbe9b7b853f73e912,0xbee498983f65114d,0xbf1423cd3f50c899,0xbf32767c3f378a4d,0xbf4c8bf33f19efeb,0xbf61c5983ef15aea,0x0
.quad 0xbe2b86c03f7c620b,0xbea91a563f71a257,0xbef7aa013f600ea4,0xbf1f9d073f48261c,0xbf3ee2683f2a95b0,0xbf58c2eb3f083341,0xbf6c835e3ec3ef15,0x0
.quad 0xbe39aaee3f7bc1bb,0xbeb697193f6f2af0,0xbf0525983f5aa675,0xbf2a95b03f3ee268,0xbf4a5e203f1cca6b,0xbf63712c3eeaffac,0xbf74fa0b3e94a031,0x0
.quad 0xbe47c5c23f7b14be,0xbec3ef153f6c835e,0xbf0e39da3f54db31,0xbf3504f33f3504f3,0xbf54db313f0e39da,0xbf6c835e3ec3ef15,0xbf7b14be3e47c5c2,0x0
.quad 0xbe55d6873f7a5b1d,0xbed11f9b3f69ac2a,0xbf170daa3f4eaf7a,0xbf3ee2683f2a95b0,0xbf5e4c693efdec9f,0xbf73e9123e9b7b85,0xbf7ec46d3dc8bd36,0x0
.quad 0xbe63dc873f7994e0,0xbede26023f66a5e5,0xbf1f9d073f48261c,0xbf48261c3f1f9d07,0xbf66a5e53ede2602,0xbf7994e03e63dc87,0xbf800000248d3132,0x0
.quad 0xbe71d70e3f78c212,0xbeeaffac3f63712c,0xbf27e4113f41420b,0xbf50c8993f1423cd,0xbf6ddd243ebd47db,0xbf7d7c833e0f2533,0xbf7ec46dbdc8bd36,0x0
.quad 0xbe7fc5683f77e2bd,0xbef7aa013f600ea4,0xbf2fdf083f3a0669,0xbf58c2eb3f083341,0xbf73e9123e9b7b85,0xbf7f98e63d65aa20,0xbf7b14bebe47c5c2,0x0
.quad 0xbe86d3703f76f6ed,0xbf02113a3f5c7efc,0xbf378a4d3f32767c,0xbf600ea43ef7aa01,0xbf78c2123e71d70e,0xbf7fe638bce5c143,0xbf74fa0bbe94a031,0x0
.quad 0xbe8dbd623f75fead,0xbf0833413f58c2eb,0xbf3ee2683f2a95b0,0xbf66a5e53ede2602,0xbf7c620b3e2b86c0,0xbf7e63ecbde54da2,0xbf6c835ebec3ef15,0x0
.quad 0xbe94a0313f74fa0b,0xbf0e39da3f54db31,0xbf45e4033f226799,0xbf6c835e3ec3ef15,0xbf7ec46d3dc8bd36,0xbf7b14bebe47c5c2,0xbf61c598bef15aea,0x0
.quad 0xbe9b7b853f73e912,0xbf1423cd3f50c899,0xbf4c8bf33f19efeb,0xbf71a2573ea91a56,0xbf7fe6383ce5c143,0xbf75feadbe8dbd62,0xbf54db31bf0e39da,0x0
.quad 0xbea24f043f72cbd1,0xbf19efeb3f4c8bf3,0xbf52d7343f11327b,0xbf75fead3e8dbd62,0xbf7fc600bd2c49b7,0xbf6f2af0beb69719,0xbf45e403bf226799,0x0
.quad 0xbea91a563f71a257,0xbf1f9d073f48261c,0xbf58c2eb3f083341,0xbf7994e03e63dc87,0xbf7e63ecbde54da2,0xbf66a5e5bede2602,0xbf3504f3bf3504f3,0x0
.quad 0xbeafdd253f706cb1,0xbf2529fe3f4397f4,0xbf5e4c693efdec9f,0xbf7c620b3e2b86c0,0xbf7bc1bbbe39aaee,0xbf5c7efcbf02113a,0xbf226799bf45e403,0x0
.quad 0xbeb697193f6f2af0,0xbf2a95b03f3ee268,0xbf63712c3eeaffac,0xbf7e63ec3de54da2,0xbf77e2bdbe7fc568,0xbf50c899bf1423cd,0xbf0e39dabf54db31,0x0
.quad 0xbebd47db3f6ddd24,0xbf2fdf083f3a0669,0xbf682ee03ed7a83d,0xbf7f98e63d65aa20,0xbf72cbd1bea24f04,0xbf4397f4bf2529fe,0xbef15aeabf61c598,0x0
.quad 0xbec3ef153f6c835e,0xbf3504f33f3504f3,0xbf6c835e3ec3ef15,0xbf800000248d3132,0xbf6c835ebec3ef15,0xbf3504f3bf3504f3,0xbec3ef15bf6c835e,0x0
.quad 0xbeca8c723f6b1db0,0xbf3a06693f2fdf08,0xbf706cb13eafdd25,0xbf7f98e6bd65aa20,0xbf65114dbee49898,0xbf2529febf4397f4,0xbe94a031bf74fa0b,0x0
.quad 0xbed11f9b3f69ac2a,0xbf3ee2683f2a95b0,0xbf73e9123e9b7b85,0xbf7e63ecbde54da2,0xbf5c7efcbf02113a,0xbf1423cdbf50c899,0xbe47c5c2bf7b14be,0x0
.quad 0xbed7a83d3f682ee0,0xbf4397f43f2529fe,0xbf76f6ed3e86d370,0xbf7c620bbe2b86c0,0xbf52d734bf11327b,0xbf02113abf5c7efc,0xbdc8bd36bf7ec46d,0x0
.quad 0x8000361280003592,0x8000361280003612,0xb483361180003592,0xb541360ab502360f,0xb502360f80003592,0xb5b635e5b57e3604,0xb541360a80003592,0xb5f8359cb5b635e5
.quad 0xb57e360480003592,0xb60f3502b5e535b6,0xb59c35f880003592,0xb611b483b604357e,0xb5b635e580003592,0xb604b57eb60f3502,0xb5cf35cf80003592,0xb5cfb5cfb6121b21
.quad 0xb5e535b680003592,0xb57eb604b60fb502,0xb5f8359c80003592,0xb483b611b604b57e,0xb604357e80003592,0x3502b60fb5e5b5b6,0xb60a354180003592,0x359cb5f8b5b6b5e5
.quad 0xb60f350280003592,0x35e5b5b6b57eb604,0xb611348380003592,0x360ab541b502b60f,0xb6121b2180003592,0x36129bf29ba1b612,0xb611b48380003592,0x360a35413502b60f
.quad 0xb60fb50280003592,0x35e535b6357eb604,0xb60ab54180003592,0x359c35f835b6b5e5,0xb604b57e80003592,0x3502360f35e5b5b6,0xb5f8b59c80003592,0xb48336113604b57e
.quad 0xb5e5b5b680003592,0xb57e3604360fb502,0xb5cfb5cf80003592,0xb5cf35cf36129bf2,0xb5b6b5e580003592,0xb604357e360f3502,0xb59cb5f880003592,0xb61134833604357e
.quad 0xb57eb60480003592,0xb60fb50235e535b6,0xb541b60a80003592,0xb5f8b59c35b635e5,0xb502b60f80003592,0xb5b6b5e5357e3604,0xb483b61180003592,0xb541b60a3502360f
.quad 0x9ba1b61280003592,0x9ba1b61280003612,0x3483b61180003592,0x3541b60ab502360f,0x3502b60f80003592,0x35b6b5e5b57e3604,0x3541b60a80003592,0x35f8b59cb5b635e5
.quad 0x8000361280003612,0x8000361280003612,0xb59c35f8b57e3604,0xb5cf35cfb5b635e5,0xb604357eb5e535b6,0xb6121b21b60f3502,0xb611b483b60f3502,0xb5cfb5cfb604b57e
.quad 0xb5e5b5b6b60fb502,0x9ba1b612b57eb604,0xb541b60ab5e5b5b6,0x35cfb5cf3502b60f,0x3502b60fb57eb604,0x36129bf235e5b5b6,0x35cfb5cf9ba1b612,0x35cf35cf36129bf2
.quad 0x360fb502357eb604,0x8000361235e535b6,0x360a354135e5b5b6,0xb5cf35cf3502360f,0x35b635e5360fb502,0xb6121b21b57e3604,0x34833611360f3502,0xb5cfb5cfb604357e
.quad 0xb57e360435e535b6,0x9ba1b612b60fb502,0xb5f8359c357e3604,0x35cfb5cfb5b6b5e5,0xb6121b2180003612,0x36129bf29ba1b612,0xb5f8b59cb57e3604,0x35cf35cf35b6b5e5
.quad 0xb57eb604b5e535b6,0x80003612360fb502,0x3483b611b60f3502,0xb5cf35cf3604357e,0x35b6b5e5b60fb502,0xb6121b21357e3604,0x360ab541b5e5b5b6,0xb5cfb5cfb502360f
.quad 0x360f3502b57eb604,0x9ba1b612b5e535b6,0x35cf35cf9ba1b612,0x35cfb5cfb6121b21,0x3502360f357eb604,0x36129bf2b5e5b5b6,0xb541360a35e5b5b6,0x35cf35cfb502b60f
.quad 0xb5e535b6360fb502,0x80003612357eb604,0xb6113483360f3502,0xb5cf35cf3604b57e,0xb604b57e35e535b6,0xb6121b21360f3502,0xb59cb5f8357e3604,0xb5cfb5cf35b635e5
.quad 0x9ba1b61280003612,0x9ba1b61280003612,0x359cb5f8b57e3604,0x35cfb5cfb5b635e5,0x3604b57eb5e535b6,0x36129bf2b60f3502,0x36113483b60f3502,0x35cf35cfb604b57e
.quad 0x8000361280003612,0x8000361280003612,0xb5f8359cb5e535b6,0xb60a3541b604357e,0xb604b57eb60fb502,0xb5b6b5e5b5e5b5b6,0xb483b611b57eb604,0x359cb5f83502b60f
.quad 0x35e5b5b6357eb604,0x360f3502360fb502,0x360a3541360fb502,0x3483361135b635e5,0x3502360f35e535b6,0xb604357eb57e3604,0xb5cf35cf80003612,0xb5cfb5cfb6121b21
.quad 0xb60fb502b5e535b6,0x357eb604b57eb604,0xb541b60ab60fb502,0x3611348335b6b5e5,0x35b6b5e5b57eb604,0x3502360f360f3502,0x36113483357eb604,0xb5f8359c3502360f
.quad 0x357e3604360fb502,0xb5e5b5b6b5e535b6,0xb59c35f835e535b6,0x3541b60ab604b57e,0xb6121b2180003612,0x36129bf29ba1b612,0xb59cb5f8b5e535b6,0x3541360a3604b57e
.quad 0x357eb604b60fb502,0xb5e535b635e535b6,0x3611b483b57eb604,0xb5f8b59cb502360f,0x35b635e5357eb604,0x3502b60fb60f3502,0xb541360a360fb502,0x3611b483b5b6b5e5
.quad 0xb60f350235e535b6,0x357e3604357eb604,0xb5cfb5cf80003612,0xb5cf35cf36129bf2,0x3502b60fb5e535b6,0xb604b57e357e3604,0x360ab541b60fb502,0x3483b611b5b635e5
.quad 0x35e535b6b57eb604,0x360fb502b60fb502,0xb4833611357eb604,0x359c35f8b502b60f,0xb604357e360fb502,0xb5b635e535e5b5b6,0xb5f8b59c35e535b6,0xb60ab5413604357e
.quad 0x9ba1b61280003612,0x9ba1b61280003612,0x35f8b59cb5e535b6,0x360ab541b604357e,0x3604357eb60fb502,0x35b635e5b5e5b5b6,0x34833611b57eb604,0xb59c35f83502b60f
.quad 0x8000361280003612,0x8000361280003612,0xb6113483b60f3502,0xb611b483b6121b21,0xb502b60fb57eb604,0x3502b60f9ba1b612,0x360ab54135e5b5b6,0x360a354136129bf2
.quad 0x357e360435e535b6,0xb57e360480003612,0xb5f8359cb57e3604,0xb5f8b59cb6121b21,0xb5b6b5e5b60fb502,0x35b6b5e59ba1b612,0x35cfb5cf9ba1b612,0x35cf35cf36129bf2
.quad 0x35e535b6360fb502,0xb5e535b680003612,0xb59c35f8357e3604,0xb59cb5f8b6121b21,0xb604b57eb5e535b6,0x3604b57e9ba1b612,0x3541b60ab5e5b5b6,0x3541360a36129bf2
.quad 0x360f3502357eb604,0xb60f350280003612,0xb4833611360f3502,0xb483b611b6121b21,0xb6121b2180003612,0x36129bf29ba1b612,0xb483b611b60f3502,0xb483361136129bf2
.quad 0x360fb502b57eb604,0xb60fb50280003612,0x3541360a35e5b5b6,0x3541b60ab6121b21,0xb604357e35e535b6,0x3604357e9ba1b612,0xb59cb5f8b57e3604,0xb59c35f836129bf2
.quad 0x35e5b5b6b60fb502,0xb5e5b5b680003612,0x35cf35cf9ba1b612,0x35cfb5cfb6121b21,0xb5b635e5360fb502,0x35b635e59ba1b612,0xb5f8b59c357e3604,0xb5f8359c36129bf2
.quad 0x357eb604b5e535b6,0xb57eb60480003612,0x360a3541b5e5b5b6,0x360ab541b6121b21,0xb502360f357eb604,0x3502360f9ba1b612,0xb611b483360f3502,0xb611348336129bf2
.quad 0x9ba1b61280003612,0x9ba1b61280003612,0x3611b483b60f3502,0x36113483b6121b21,0x3502360fb57eb604,0xb502360f9ba1b612,0xb60a354135e5b5b6,0xb60ab54136129bf2
.quad 0x8000361280003612,0x8000361280003612,0xb60ab541b60fb502,0xb5f8b59cb604b57e,0x35b6b5e5357eb604,0x3604b57e35e5b5b6,0x359c35f835e535b6,0xb48336113502360f
.quad 0xb60f3502b5e535b6,0xb5e5b5b6b60fb502,0x3483b611b57eb604,0x360ab54135b6b5e5,0x3604357e360fb502,0xb502360f357e3604,0xb5cf35cf80003612,0xb5cfb5cfb6121b21
.quad 0xb57eb604b60fb502,0x360fb502357eb604,0x3611b483357eb604,0xb541360a35b635e5,0xb502360f35e535b6,0xb5b6b5e5b60f3502,0xb5f8b59cb5e535b6,0x3611b4833502b60f
.quad 0x35e5b5b6b57eb604,0xb57e360435e535b6,0x3541360a360fb502,0xb59cb5f8b604357e,0xb6121b2180003612,0x36129bf29ba1b612,0x3541b60ab60fb502,0xb59c35f83604357e
.quad 0x35e535b6357eb604,0xb57eb604b5e535b6,0xb5f8359c35e535b6,0x36113483b502b60f,0xb502b60fb5e535b6,0xb5b635e5360f3502,0x36113483b57eb604,0xb541b60ab5b635e5
.quad 0xb57e3604360fb502,0x360f3502b57eb604,0xb5cfb5cf80003612,0xb5cf35cf36129bf2,0x3604b57eb60fb502,0xb502b60fb57e3604,0x34833611357eb604,0x360a3541b5b6b5e5
.quad 0xb60fb50235e535b6,0xb5e535b6360fb502,0x359cb5f8b5e535b6,0xb483b611b502360f,0x35b635e5b57eb604,0x3604357eb5e5b5b6,0xb60a3541360fb502,0xb5f8359c3604b57e
.quad 0x9ba1b61280003612,0x9ba1b61280003612,0x360a3541b60fb502,0x35f8359cb604b57e,0xb5b635e5357eb604,0xb604357e35e5b5b6,0xb59cb5f835e535b6,0x3483b6113502360f
.quad 0x8000361280003612,0x8000361280003612,0xb5cfb5cfb5e5b5b6,0xb59cb5f8b5b6b5e5,0x36129bf2360fb502,0x3604357e360f3502,0xb5cf35cfb57e3604,0xb6113483b604357e
.quad 0x9ba1b612b57eb604,0x35e5b5b6357eb604,0x35cf35cf360f3502,0xb541360a3502360f,0xb6121b21b5e535b6,0xb502b60fb5e5b5b6,0x35cfb5cf9ba1b612,0x35cf35cf36129bf2
.quad 0x8000361235e535b6,0xb60fb502b5e535b6,0xb5cfb5cfb60f3502,0x360ab5413502b60f,0x36129bf2357eb604,0xb5b635e5357e3604,0xb5cf35cf357e3604,0x3483b611b604b57e
.quad 0x9ba1b612b60fb502,0x357e3604360fb502,0x35cf35cf35e5b5b6,0xb5f8b59cb5b635e5,0xb6121b2180003612,0x36129bf29ba1b612,0x35cfb5cfb5e5b5b6,0xb5f8359c35b635e5
.quad 0x80003612360fb502,0x357eb604b60fb502,0xb5cfb5cfb57e3604,0x348336113604b57e,0x36129bf2b57eb604,0xb5b6b5e5b57e3604,0xb5cf35cf360f3502,0x360a3541b502b60f
.quad 0x9ba1b612b5e535b6,0xb60f350235e535b6,0x35cf35cf9ba1b612,0x35cfb5cfb6121b21,0xb6121b2135e535b6,0xb502360f35e5b5b6,0x35cfb5cfb60f3502,0xb541b60ab502360f
.quad 0x80003612357eb604,0x35e535b6b57eb604,0xb5cfb5cf357e3604,0xb611b4833604357e,0x36129bf2b60fb502,0x3604b57eb60f3502,0xb5cf35cf35e5b5b6,0xb59c35f835b6b5e5
.quad 0x9ba1b61280003612,0x9ba1b61280003612,0x35cf35cfb5e5b5b6,0x359c35f8b5b6b5e5,0xb6121b21360fb502,0xb604b57e360f3502,0x35cfb5cfb57e3604,0x3611b483b604357e
.quad 0x8000361280003612,0x8000361280003612,0xb541b60ab57eb604,0xb483b611b502b60f,0x35b635e535e535b6,0x3502360f357e3604,0xb5f8b59cb60fb502,0xb541b60ab5b6b5e5
.quad 0x360f3502360fb502,0x357e360435e535b6,0xb6113483b5e535b6,0xb59cb5f8b604b57e,0x3604b57e357eb604,0x35b635e5360f3502,0xb5cf35cf80003612,0xb5cfb5cfb6121b21
.quad 0x357eb604b57eb604,0x35e535b6360fb502,0xb483361135e535b6,0xb5f8b59cb604357e,0xb502b60fb60fb502,0x3604357e35e5b5b6,0x359c35f8360fb502,0xb60ab541b5b635e5
.quad 0xb5e5b5b6b5e535b6,0x360f3502357eb604,0x360a3541357eb604,0xb611b483b502360f,0xb6121b2180003612,0x36129bf29ba1b612,0x360ab541b57eb604,0xb61134833502360f
.quad 0xb5e535b635e535b6,0x360fb502b57eb604,0x359cb5f8b60fb502,0xb60a354135b635e5,0xb502360f360fb502,0x3604b57eb5e5b5b6,0xb483b611b5e535b6,0xb5f8359c3604357e
.quad 0x357e3604357eb604,0x35e5b5b6b60fb502,0xb5cfb5cf80003612,0xb5cf35cf36129bf2,0x3604357eb57eb604,0x35b6b5e5b60f3502,0xb611b48335e535b6,0xb59c35f83604b57e
.quad 0x360fb502b60fb502,0x357eb604b5e535b6,0xb5f8359c360fb502,0xb541360a35b6b5e5,0x35b6b5e5b5e535b6,0x3502b60fb57e3604,0xb541360a357eb604,0xb48336113502b60f
.quad 0x9ba1b61280003612,0x9ba1b61280003612,0x3541360ab57eb604,0x34833611b502b60f,0xb5b6b5e535e535b6,0xb502b60f357e3604,0x35f8359cb60fb502,0x3541360ab5b6b5e5
.quad 0x80003592,0x0,0x9b21b592,0x0,0x80003592,0x0,0x9b21b592,0x0
.quad 0x80003592,0x0,0x9b21b592,0x0,0x80003592,0x0,0x9b21b592,0x0
.quad 0x80003592,0x0,0x9b21b592,0x0,0x80003592,0x0,0x9b21b592,0x0
.quad 0x80003592,0x0,0x9b21b592,0x0,0x80003592,0x0,0x9b21b592,0x0
.quad 0x80003592,0x0,0x9b21b592,0x0,0x80003592,0x0,0x9b21b592,0x0
.quad 0x80003592,0x0,0x9b21b592,0x0,0x80003592,0x0,0x9b21b592,0x0
.quad 0x80003592,0x0,0x9b21b592,0x0,0x80003592,0x0,0x9b21b592,0x0
.quad 0x80003592,0x0,0x9b21b592,0x0,0x80003592,0x0,0x9b21b592,0x0
.quad 0x357eb60480003592,0x360fb502b5e535b6,0x359cb5f880003592,0x36113483b604357e,0x35b6b5e580003592,0x3604357eb60f3502,0x35cfb5cf80003592,0x35cf35cfb6121b21
.quad 0x35e5b5b680003592,0x357e3604b60fb502,0x35f8b59c80003592,0x34833611b604b57e,0x3604b57e80003592,0xb502360fb5e5b5b6,0x360ab54180003592,0xb59c35f8b5b6b5e5
.quad 0x360fb50280003592,0xb5e535b6b57eb604,0x3611b48380003592,0xb60a3541b502b60f,0x36129bf280003592,0xb6121b219ba1b612,0x3611348380003592,0xb60ab5413502b60f
.quad 0x360f350280003592,0xb5e5b5b6357eb604,0x360a354180003592,0xb59cb5f835b6b5e5,0x3604357e80003592,0xb502b60f35e5b5b6,0x35f8359c80003592,0x3483b6113604b57e
.quad 0x35e535b680003592,0x357eb604360fb502,0x35cf35cf80003592,0x35cfb5cf36129bf2,0x35b635e580003592,0x3604b57e360f3502,0x359c35f880003592,0x3611b4833604357e
.quad 0x357e360480003592,0x360f350235e535b6,0x3541360a80003592,0x35f8359c35b635e5,0x3502360f80003592,0x35b635e5357e3604,0x3483361180003592,0x3541360a3502360f
.quad 0x0,0x0,0x0,0x0,0x0,0x0,0x0,0x0
.quad 0x0,0x0,0x0,0x0,0x0,0x0,0x0,0x0
.quad 0x35e535b6b60fb502,0x80003612b57eb604,0x3541360ab5e5b5b6,0xb5cf35cf3502b60f,0xb502360fb57eb604,0xb6121b2135e5b5b6,0xb5cf35cf9ba1b612,0xb5cfb5cf36129bf2
.quad 0xb60f3502357eb604,0x9ba1b61235e535b6,0xb60ab54135e5b5b6,0x35cfb5cf3502360f,0xb5b6b5e5360fb502,0x36129bf2b57e3604,0xb483b611360f3502,0x35cf35cfb604357e
.quad 0x357eb60435e535b6,0x80003612b60fb502,0x35f8b59c357e3604,0xb5cf35cfb5b6b5e5,0x36129bf280003612,0xb6121b219ba1b612,0x35f8359cb57e3604,0xb5cfb5cf35b6b5e5
.quad 0x357e3604b5e535b6,0x9ba1b612360fb502,0xb4833611b60f3502,0x35cfb5cf3604357e,0xb5b635e5b60fb502,0x36129bf2357e3604,0xb60a3541b5e5b5b6,0x35cf35cfb502360f
.quad 0xb60fb502b57eb604,0x80003612b5e535b6,0xb5cfb5cf9ba1b612,0xb5cf35cfb6121b21,0xb502b60f357eb604,0xb6121b21b5e5b5b6,0x3541b60a35e5b5b6,0xb5cfb5cfb502b60f
.quad 0x35e5b5b6360fb502,0x9ba1b612357eb604,0x3611b483360f3502,0x35cfb5cf3604b57e,0x3604357e35e535b6,0x36129bf2360f3502,0x359c35f8357e3604,0x35cf35cf35b635e5
.quad 0x0,0x0,0x0,0x0,0x0,0x0,0x0,0x0
.quad 0x0,0x0,0x0,0x0,0x0,0x0,0x0,0x0
.quad 0xb5e535b6357eb604,0xb60fb502360fb502,0xb60ab541360fb502,0xb483b61135b635e5,0xb502b60f35e535b6,0x3604b57eb57e3604,0x35cfb5cf80003612,0x35cf35cfb6121b21
.quad 0x360f3502b5e535b6,0xb57e3604b57eb604,0x3541360ab60fb502,0xb611b48335b6b5e5,0xb5b635e5b57eb604,0xb502b60f360f3502,0xb611b483357eb604,0x35f8b59c3502360f
.quad 0xb57eb604360fb502,0x35e535b6b5e535b6,0x359cb5f835e535b6,0xb541360ab604b57e,0x36129bf280003612,0xb6121b219ba1b612,0x359c35f8b5e535b6,0xb541b60a3604b57e
.quad 0xb57e3604b60fb502,0x35e5b5b635e535b6,0xb6113483b57eb604,0x35f8359cb502360f,0xb5b6b5e5357eb604,0xb502360fb60f3502,0x3541b60a360fb502,0xb6113483b5b6b5e5
.quad 0x360fb50235e535b6,0xb57eb604357eb604,0x35cf35cf80003612,0x35cfb5cf36129bf2,0xb502360fb5e535b6,0x3604357e357e3604,0xb60a3541b60fb502,0xb4833611b5b635e5
.quad 0xb5e5b5b6b57eb604,0xb60f3502b60fb502,0x3483b611357eb604,0xb59cb5f8b502b60f,0x3604b57e360fb502,0x35b6b5e535e5b5b6,0x35f8359c35e535b6,0x360a35413604357e
.quad 0x0,0x0,0x0,0x0,0x0,0x0,0x0,0x0
.quad 0x0,0x0,0x0,0x0,0x0,0x0,0x0,0x0
.quad 0xb57eb60435e535b6,0x357eb60480003612,0x35f8b59cb57e3604,0x35f8359cb6121b21,0x35b635e5b60fb502,0xb5b635e59ba1b612,0xb5cf35cf9ba1b612,0xb5cfb5cf36129bf2
.quad 0xb5e5b5b6360fb502,0x35e5b5b680003612,0x359cb5f8357e3604,0x359c35f8b6121b21,0x3604357eb5e535b6,0xb604357e9ba1b612,0xb541360ab5e5b5b6,0xb541b60a36129bf2
.quad 0xb60fb502357eb604,0x360fb50280003612,0x3483b611360f3502,0x34833611b6121b21,0x36129bf280003612,0xb6121b219ba1b612,0x34833611b60f3502,0x3483b61136129bf2
.quad 0xb60f3502b57eb604,0x360f350280003612,0xb541b60a35e5b5b6,0xb541360ab6121b21,0x3604b57e35e535b6,0xb604b57e9ba1b612,0x359c35f8b57e3604,0x359cb5f836129bf2
.quad 0xb5e535b6b60fb502,0x35e535b680003612,0xb5cfb5cf9ba1b612,0xb5cf35cfb6121b21,0x35b6b5e5360fb502,0xb5b6b5e59ba1b612,0x35f8359c357e3604,0x35f8b59c36129bf2
.quad 0xb57e3604b5e535b6,0x357e360480003612,0xb60ab541b5e5b5b6,0xb60a3541b6121b21,0x3502b60f357eb604,0xb502b60f9ba1b612,0x36113483360f3502,0x3611b48336129bf2
.quad 0x0,0x0,0x0,0x0,0x0,0x0,0x0,0x0
.quad 0x0,0x0,0x0,0x0,0x0,0x0,0x0,0x0
.quad 0x360fb502b5e535b6,0x35e535b6b60fb502,0xb4833611b57eb604,0xb60a354135b6b5e5,0xb604b57e360fb502,0x3502b60f357e3604,0x35cfb5cf80003612,0x35cf35cfb6121b21
.quad 0x357e3604b60fb502,0xb60f3502357eb604,0xb6113483357eb604,0x3541b60a35b635e5,0x3502b60f35e535b6,0x35b635e5b60f3502,0x35f8359cb5e535b6,0xb61134833502b60f
.quad 0xb5e535b6b57eb604,0x357eb60435e535b6,0xb541b60a360fb502,0x359c35f8b604357e,0x36129bf280003612,0xb6121b219ba1b612,0xb541360ab60fb502,0x359cb5f83604357e
.quad 0xb5e5b5b6357eb604,0x357e3604b5e535b6,0x35f8b59c35e535b6,0xb611b483b502b60f,0x3502360fb5e535b6,0x35b6b5e5360f3502,0xb611b483b57eb604,0x3541360ab5b635e5
.quad 0x357eb604360fb502,0xb60fb502b57eb604,0x35cf35cf80003612,0x35cfb5cf36129bf2,0xb604357eb60fb502,0x3502360fb57e3604,0xb483b611357eb604,0xb60ab541b5b6b5e5
.quad 0x360f350235e535b6,0x35e5b5b6360fb502,0xb59c35f8b5e535b6,0x34833611b502360f,0xb5b6b5e5b57eb604,0xb604b57eb5e5b5b6,0x360ab541360fb502,0x35f8b59c3604b57e
.quad 0x0,0x0,0x0,0x0,0x0,0x0,0x0,0x0
.quad 0x0,0x0,0x0,0x0,0x0,0x0,0x0,0x0
.quad 0x80003612b57eb604,0xb5e535b6357eb604,0xb5cfb5cf360f3502,0x3541b60a3502360f,0x36129bf2b5e535b6,0x3502360fb5e5b5b6,0xb5cf35cf9ba1b612,0xb5cfb5cf36129bf2
.quad 0x9ba1b61235e535b6,0x360f3502b5e535b6,0x35cf35cfb60f3502,0xb60a35413502b60f,0xb6121b21357eb604,0x35b6b5e5357e3604,0x35cfb5cf357e3604,0xb4833611b604b57e
.quad 0x80003612b60fb502,0xb57eb604360fb502,0xb5cfb5cf35e5b5b6,0x35f8359cb5b635e5,0x36129bf280003612,0xb6121b219ba1b612,0xb5cf35cfb5e5b5b6,0x35f8b59c35b635e5
.quad 0x9ba1b612360fb502,0xb57e3604b60fb502,0x35cf35cfb57e3604,0xb483b6113604b57e,0xb6121b21b57eb604,0x35b635e5b57e3604,0x35cfb5cf360f3502,0xb60ab541b502b60f
.quad 0x80003612b5e535b6,0x360fb50235e535b6,0xb5cfb5cf9ba1b612,0xb5cf35cfb6121b21,0x36129bf235e535b6,0x3502b60f35e5b5b6,0xb5cf35cfb60f3502,0x3541360ab502360f
.quad 0x9ba1b612357eb604,0xb5e5b5b6b57eb604,0x35cf35cf357e3604,0x361134833604357e,0xb6121b21b60fb502,0xb604357eb60f3502,0x35cfb5cf35e5b5b6,0x359cb5f835b6b5e5
.quad 0x0,0x0,0x0,0x0,0x0,0x0,0x0,0x0
.quad 0x0,0x0,0x0,0x0,0x0,0x0,0x0,0x0
.quad 0xb60fb502360fb502,0xb57eb60435e535b6,0x3611b483b5e535b6,0x359c35f8b604b57e,0xb604357e357eb604,0xb5b6b5e5360f3502,0x35cfb5cf80003612,0x35cf35cfb6121b21
.quad 0xb57e3604b57eb604,0xb5e5b5b6360fb502,0x3483b61135e535b6,0x35f8359cb604357e,0x3502360fb60fb502,0xb604b57e35e5b5b6,0xb59cb5f8360fb502,0x360a3541b5b635e5
.quad 0x35e535b6b5e535b6,0xb60fb502357eb604,0xb60ab541357eb604,0x36113483b502360f,0x36129bf280003612,0xb6121b219ba1b612,0xb60a3541b57eb604,0x3611b4833502360f
.quad 0x35e5b5b635e535b6,0xb60f3502b57eb604,0xb59c35f8b60fb502,0x360ab54135b635e5,0x3502b60f360fb502,0xb604357eb5e5b5b6,0x34833611b5e535b6,0x35f8b59c3604357e
.quad 0xb57eb604357eb604,0xb5e535b6b60fb502,0x35cf35cf80003612,0x35cfb5cf36129bf2,0xb604b57eb57eb604,0xb5b635e5b60f3502,0x3611348335e535b6,0x359cb5f83604b57e
.quad 0xb60f3502b60fb502,0xb57e3604b5e535b6,0x35f8b59c360fb502,0x3541b60a35b6b5e5,0xb5b635e5b5e535b6,0xb502360fb57e3604,0x3541b60a357eb604,0x3483b6113502b60f
.quad 0x0,0x0,0x0,0x0,0x0,0x0,0x0,0x0
.quad 0x0,0x0,0x0,0x0,0x0,0x0,0x0,0x0
.quad 0x80003592,0x0,0x9b21b592,0x0,0x80003592,0x0,0x9b21b592,0x0
.quad 0x80003592,0x0,0x9b21b592,0x0,0x80003592,0x0,0x9b21b592,0x0
.quad 0x80003592,0x0,0x9b21b592,0x0,0x80003592,0x0,0x9b21b592,0x0
.quad 0x80003592,0x0,0x9b21b592,0x0,0x80003592,0x0,0x9b21b592,0x0
.quad 0x80003592,0x0,0x9b21b592,0x0,0x80003592,0x0,0x9b21b592,0x0
.quad 0x80003592,0x0,0x9b21b592,0x0,0x80003592,0x0,0x9b21b592,0x0
.quad 0x0,0x0,0x0,0x0,0x0,0x0,0x0,0x0
.quad 0x0,0x0,0x0,0x0,0x0,0x0,0x0,0x0
.quad 0x3f7ff98e3f800000,0x3f7fc6003f7fe638,0xbc65c70c80000000,0xbd2c49b7bce5c143,0x3f7fe6383f800000,0x3f7f181a3f7f98e6,0xbce5c14380000000,0xbdac22aebd65aa20
.quad 0x3f7fc6003f800000,0x3f7df69c3f7f181a,0xbd2c49b780000000,0xbe00e941bdac22ae,0x3f7f98e63f800000,0x3f7c620b3f7e63ec,0xbd65aa2080000000,0xbe2b86c0bde54da2
.quad 0x3f7f5eee3f800000,0x3f7a5b1d3f7d7c83,0xbd8f7f7c80000000,0xbe55d687be0f2533,0x3f7f181a3f800000,0x3f77e2bd3f7c620b,0xbdac22ae80000000,0xbe7fc568be2b86c0
.quad 0x3f7ec46d3f800000,0x3f74fa0b3f7b14be,0xbdc8bd3680000000,0xbe94a031be47c5c2,0x0,0x0,0x0,0x0
.quad 0x3f7f5eee3f7f98e6,0x3f7ec46d3f7f181a,0xbd8f7f7cbd65aa20,0xbdc8bd36bdac22ae,0x3f7d7c833f7e63ec,0x3f7b14be3f7c620b,0xbe0f2533bde54da2,0xbe47c5c2be2b86c0
.quad 0x3f7a5b1d3f7c620b,0x3f74fa0b3f77e2bd,0xbe55d687be2b86c0,0xbe94a031be7fc568,0x3f75fead3f7994e0,0x3f6c835e3f71a257,0xbe8dbd62be63dc87,0xbec3ef15bea91a56
.quad 0x3f706cb13f75fead,0x3f61c5983f69ac2a,0xbeafdd25be8dbd62,0xbef15aeabed11f9b,0x3f69ac2a3f71a257,0x3f54db313f600ea4,0xbed11f9bbea91a56,0xbf0e39dabef7aa01
.quad 0x3f61c5983f6c835e,0x3f45e4033f54db31,0xbef15aeabec3ef15,0xbf226799bf0e39da,0x0,0x0,0x0,0x0
.quad 0x3f7df69c3f7e63ec,0x3f7cf5a53f7d7c83,0xbe00e941bde54da2,0xbe1d59f0be0f2533,0x3f77e2bd3f7994e0,0x3f73e9123f75fead,0xbe7fc568be63dc87,0xbe9b7b85be8dbd62
.quad 0x3f6ddd243f71a257,0x3f65114d3f69ac2a,0xbebd47dbbea91a56,0xbee49898bed11f9b,0x3f600ea43f66a5e5,0x3f50c8993f58c2eb,0xbef7aa01bede2602,0xbf1423cdbf083341
.quad 0x3f4eaf7a3f58c2eb,0x3f378a4d3f4397f4,0xbf170daabf083341,0xbf32767cbf2529fe,0x3f3a06693f48261c,0x3f19efeb3f2a95b0,0xbf2fdf08bf1f9d07,0xbf4c8bf3bf3ee268
.quad 0x3f2267993f3504f3,0x3ef15aea3f0e39da,0xbf45e403bf3504f3,0xbf61c598bf54db31,0x0,0x0,0x0,0x0
.quad 0x3f7bc1bb3f7c620b,0x3f7a5b1d3f7b14be,0xbe39aaeebe2b86c0,0xbe55d687be47c5c2,0x3f6f2af03f71a257,0x3f69ac2a3f6c835e,0xbeb69719bea91a56,0xbed11f9bbec3ef15
.quad 0x3f5aa6753f600ea4,0x3f4eaf7a3f54db31,0xbf052598bef7aa01,0xbf170daabf0e39da,0x3f3ee2683f48261c,0x3f2a95b03f3504f3,0xbf2a95b0bf1f9d07,0xbf3ee268bf3504f3
.quad 0x3f1cca6b3f2a95b0,0x3efdec9f3f0e39da,0xbf4a5e20bf3ee268,0xbf5e4c69bf54db31,0x3eeaffac3f083341,0x3e9b7b853ec3ef15,0xbf63712cbf58c2eb,0xbf73e912bf6c835e
.quad 0x3e94a0313ec3ef15,0x3dc8bd363e47c5c2,0xbf74fa0bbf6c835e,0xbf7ec46dbf7b14be,0x0,0x0,0x0,0x0
.quad 0x3f78c2123f7994e0,0x3f76f6ed3f77e2bd,0xbe71d70ebe63dc87,0xbe86d370be7fc568,0x3f63712c3f66a5e5,0x3f5c7efc3f600ea4,0xbeeaffacbede2602,0xbf02113abef7aa01
.quad 0x3f41420b3f48261c,0x3f32767c3f3a0669,0xbf27e411bf1f9d07,0xbf378a4dbf2fdf08,0x3f1423cd3f1f9d07,0x3ef7aa013f083341,0xbf50c899bf48261c,0xbf600ea4bf58c2eb
.quad 0x3ebd47db3ede2602,0x3e71d70e3e9b7b85,0xbf6ddd24bf66a5e5,0xbf78c212bf73e912,0x3e0f25333e63dc87,0xbce5c1433d65aa20,0xbf7d7c83bf7994e0,0xbf7fe638bf7f98e6
.quad 0xbdc8bd36248d3132,0xbe94a031be47c5c2,0xbf7ec46dbf800000,0xbf74fa0bbf7b14be,0x0,0x0,0x0,0x0
.quad 0x3f74fa0b3f75fead,0x3f72cbd13f73e912,0xbe94a031be8dbd62,0xbea24f04be9b7b85,0x3f54db313f58c2eb,0x3f4c8bf33f50c899,0xbf0e39dabf083341,0xbf19efebbf1423cd
.quad 0x3f2267993f2a95b0,0x3f11327b3f19efeb,0xbf45e403bf3ee268,0xbf52d734bf4c8bf3,0x3ec3ef153ede2602,0x3e8dbd623ea91a56,0xbf6c835ebf66a5e5,0xbf75feadbf71a257
.quad 0x3dc8bd363e2b86c0,0xbd2c49b73ce5c143,0xbf7ec46dbf7c620b,0xbf7fc600bf7fe638,0xbe47c5c2bde54da2,0xbeb69719be8dbd62,0xbf7b14bebf7e63ec,0xbf6f2af0bf75fead
.quad 0xbef15aeabec3ef15,0xbf226799bf0e39da,0xbf61c598bf6c835e,0xbf45e403bf54db31,0x0,0x0,0x0,0x0
.quad 0x3f706cb13f71a257,0x3f6ddd243f6f2af0,0xbeafdd25bea91a56,0xbebd47dbbeb69719,0x3f4397f43f48261c,0x3f3a06693f3ee268,0xbf2529febf1f9d07,0xbf2fdf08bf2a95b0
.quad 0x3efdec9f3f083341,0x3ed7a83d3eeaffac,0xbf5e4c69bf58c2eb,0xbf682ee0bf63712c,0x3e2b86c03e63dc87,0x3d65aa203de54da2,0xbf7c620bbf7994e0,0xbf7f98e6bf7e63ec
.quad 0xbe39aaeebde54da2,0xbea24f04be7fc568,0xbf7bc1bbbf7e63ec,0xbf72cbd1bf77e2bd,0xbf02113abede2602,0xbf2529febf1423cd,0xbf5c7efcbf66a5e5,0xbf4397f4bf50c899
.quad 0xbf45e403bf3504f3,0xbf61c598bf54db31,0xbf226799bf3504f3,0xbef15aeabf0e39da,0x0,0x0,0x0,0x0
.quad 0x3f6b1db03f6c835e,0x3f682ee03f69ac2a,0xbeca8c72bec3ef15,0xbed7a83dbed11f9b,0x3f2fdf083f3504f3,0x3f2529fe3f2a95b0,0xbf3a0669bf3504f3,0xbf4397f4bf3ee268
.quad 0x3eafdd253ec3ef15,0x3e86d3703e9b7b85,0xbf706cb1bf6c835e,0xbf76f6edbf73e912,0xbd65aa20248d3132,0xbe2b86c0bde54da2,0xbf7f98e6bf800000,0xbf7c620bbf7e63ec
.quad 0xbee49898bec3ef15,0xbf11327bbf02113a,0xbf65114dbf6c835e,0xbf52d734bf5c7efc,0xbf4397f4bf3504f3,0xbf5c7efcbf50c899,0xbf2529febf3504f3,0xbf02113abf1423cd
.quad 0xbf74fa0bbf6c835e,0xbf7ec46dbf7b14be,0xbe94a031bec3ef15,0xbdc8bd36be47c5c2,0x0,0x0,0x0,0x0
.size ctab, 75776
.text
```
